```python
import torch

def _softmax(x, axis=-1):
    return torch.softmax(x, dim=axis)
def _gelu(x):
    return torch.nn.functional.gelu(x, approximate="tanh")
def _silu(x):
    return torch.nn.functional.silu(x)
def _sigmoid(x):
    return torch.sigmoid(x)
def _layernorm(x, axis=-1, eps=1e-5):
    m = x.mean(dim=axis, keepdim=True)
    v = x.var(dim=axis, keepdim=True, unbiased=False)
    return (x - m) / torch.sqrt(v + eps)
def _scatter_add(tgt, idx, src, axis=0):
    return tgt.clone().index_add_(axis, idx, src)
def _segment_sum(src, seg, n):
    out = torch.zeros((n,) + src.shape[1:], dtype=src.dtype)
    return out.index_add_(0, seg, src)
def _pad(x, pw):
    flat = tuple(v for pair in reversed(pw) for v in pair)
    return torch.nn.functional.pad(x, flat)

kernel_name = 'interleave_layers__softmax_full_mha__mixer_token_mlp__prompt'

def setup_inputs():

    _w = (lambda a: (lambda t: t.to(torch.bfloat16) if t.is_floating_point() else t)(torch.as_tensor(a)))
    def _A_setup():
        B, S, D = 1, 2048, 640
        return {
            "x": _w((lambda *s: torch.randn(*s, dtype=torch.bfloat16) * 0.05)(B, S, D)),
            "wqkv": _w((lambda *s: torch.randn(*s, dtype=torch.bfloat16) * 0.05)(D, 3 * D)),
            "wo": _w((lambda *s: torch.randn(*s, dtype=torch.bfloat16) * 0.05)(D, D)),
        }
    _A_in = _A_setup()

    def _B_setup():
        B, S, D, F = 1, 2048, 640, 1536
        return {
            "x": _w((lambda *s: torch.randn(*s, dtype=torch.bfloat16) * 0.05)(B, S, D)),
            "w1": _w((lambda *s: torch.randn(*s, dtype=torch.bfloat16) * 0.8)(S, F) * (S ** -0.5)),
            "b1": _w((lambda *s: torch.randn(*s, dtype=torch.bfloat16) * 12.8)(F) * 0.02),
            "w2": _w((lambda *s: torch.randn(*s, dtype=torch.bfloat16) * 0.4)(F, S) * (F ** -0.5)),
            "b2": _w((lambda *s: torch.randn(*s, dtype=torch.bfloat16) * 6.4)(S) * 0.02),
        }
    _B_in = _B_setup()

    return {
        "A_x": _A_in["x"],
        "A_wqkv": _A_in["wqkv"],
        "A_wo": _A_in["wo"],
        "B_x": _B_in["x"],
        "B_w1": _B_in["w1"],
        "B_b1": _B_in["b1"],
        "B_w2": _B_in["w2"],
        "B_b2": _B_in["b2"],
    }

def reference(A_x, A_wqkv, A_wo, B_x, B_w1, B_b1, B_w2, B_b2):
    def _A_ref(x, wqkv, wo):
        B, S, D = x.shape
        H = 32; Dh = D // H
        qkv = (lambda x, *d: x.permute(*d))((x @ wqkv).reshape(B, S, 3, H, Dh), 2, 0, 3, 1, 4)
        q, k, v = qkv[0], qkv[1], qkv[2]
        scale = Dh ** -0.5
        scores = torch.einsum("bhqd,bhkd->bhqk", q, k) * scale
        p = _softmax(scores, axis=-1)
        o = torch.einsum("bhqk,bhkd->bhqd", p, v)
        return (lambda x, *d: x.permute(*d))(o, 0, 2, 1, 3).reshape(B, S, D) @ wo

    def _B_ref(x, w1, b1, w2, b2):
        B, S, D = x.shape
        h = _layernorm(x, axis=-1)
        u = torch.einsum("bsd,sf->bdf", h, w1) + b1
        u = _gelu(u)
        y = torch.einsum("bdf,fs->bds", u, w2) + b2
        return (lambda x, *d: x.permute(*d))(y, 0, 2, 1)

    x = A_x
    x = x + _A_ref(_layernorm(x, axis=-1), A_wqkv, A_wo)
    x = x + _B_ref(_layernorm(x, axis=-1), B_w1, B_b1, B_w2, B_b2)
    x = x + _A_ref(_layernorm(x, axis=-1), A_wqkv, A_wo)
    x = x + _B_ref(_layernorm(x, axis=-1), B_w1, B_b1, B_w2, B_b2)
    return x
```

```asm
; @launch grid=(256,1,1) block=(512,1,1) lds=163840
.amdgcn_target "amdgcn-amd-amdhsa--gfx950"
.text
.globl interleave_layers__softmax_full_mha__mixer_token_mlp__prompt_kernel
.p2align 8
.type interleave_layers__softmax_full_mha__mixer_token_mlp__prompt_kernel,@function
interleave_layers__softmax_full_mha__mixer_token_mlp__prompt_kernel:
    s_cmp_ge_u32 s2, 256
    s_cbranch_scc1 attn_exit
    s_load_dwordx4 s[4:7], s[0:1], 0
    s_load_dwordx4 s[8:11], s[0:1], 72
    s_mov_b32 s3, 0
    v_lshrrev_b32 v2, 6, v0
    v_and_b32 v1, 63, v0
    s_and_b32 s34, s2, 7
    v_readfirstlane_b32 s24, v2
    s_lshr_b32 s35, s2, 3
    s_lshr_b32 s25, s34, 1
    s_lshl_b32 s25, s25, 2
    s_and_b32 s36, s35, 3
    s_add_u32 s25, s25, s36
    s_and_b32 s26, s34, 1
    s_lshl_b32 s26, s26, 3
    s_lshr_b32 s36, s35, 2
    s_add_u32 s26, s26, s36
    v_lshrrev_b32 v5, 5, v1
    s_cmp_lt_u32 s26, 15
    s_cbranch_scc0 qkv_spare
    s_cmp_lt_u32 s24, 4
    s_cbranch_scc1 qkv_cons
    s_mul_i32 s39, s25, 3
    s_add_u32 s39, s39, s26
    s_mul_i32 s36, s39, 205
    s_lshr_b32 s36, s36, 11
    s_mul_i32 s36, s36, 10
    s_sub_u32 s39, s39, s36
    s_cmp_lt_u32 s24, 6
    s_cbranch_scc1 qkv_stat
    s_setprio 0
    s_and_b32 s27, s24, 1
    v_lshrrev_b32 v2, 2, v1
    v_and_b32 v2, 7, v2
    v_lshrrev_b32 v3, 2, v2
    v_and_b32 v6, 3, v1
    v_xor_b32 v4, v6, v3
    v_lshlrev_b32 v4, 4, v4
    v_lshl_add_u32 v4, v5, 6, v4
    s_lshl_b32 s36, s25, 7
    s_lshl_b32 s37, s27, 6
    s_add_u32 s36, s36, s37
    v_add_u32 v2, s36, v2
    v_mul_u32_u24 v2, 1280, v2
    v_add_u32 v7, v2, v4
    v_xor_b32 v4, 32, v4
    v_add_u32 v8, v2, v4
    v_add_u32 v8, 10240, v8
    v_bfe_u32 v2, v1, 2, 2
    v_lshl_add_u32 v3, v5, 2, v2
    s_lshl_b32 s36, s27, 5
    v_add_u32 v3, s36, v3
    v_mul_u32_u24 v3, 3840, v3
    v_bfe_u32 v4, v1, 4, 1
    v_lshlrev_b32 v9, 4, v6
    v_lshl_add_u32 v9, v4, 6, v9
    s_lshl_b32 s36, s26, 8
    v_add3_u32 v9, v9, v3, s36
    s_mov_b32 s36, s39
    s_lshl_b32 s30, s36, 7
    s_mul_i32 s31, s36, 245760
    s_lshl_b32 s40, s27, 13
    s_mov_b32 s32, s40
    s_mov_b32 s29, 0
    s_waitcnt lgkmcnt(0)
    s_mov_b32 s12, s4
    s_mov_b32 s13, s5
    s_mov_b32 s14, 2621440
    s_mov_b32 s15, 0x00020000
    s_mov_b32 s16, s6
    s_mov_b32 s17, s7
    s_mov_b32 s18, 2457600
    s_mov_b32 s19, 0x00020000
qkv_lloop:
    s_add_u32 m0, s32, 0
    s_add_u32 s36, s30, 0
    buffer_load_dwordx4 v7, s[12:15], s36 offen lds
    s_add_u32 m0, s32, 16384
    s_add_u32 s36, s31, 0
    buffer_load_dwordx4 v9, s[16:19], s36 offen lds
    s_add_u32 m0, s32, 1024
    s_add_u32 s36, s30, 0
    buffer_load_dwordx4 v8, s[12:15], s36 offen lds
    s_add_u32 m0, s32, 17408
    s_add_u32 s36, s31, 128
    buffer_load_dwordx4 v9, s[16:19], s36 offen lds
    s_add_u32 m0, s32, 2048
    s_add_u32 s36, s30, 20480
    buffer_load_dwordx4 v7, s[12:15], s36 offen lds
    s_add_u32 m0, s32, 18432
    s_add_u32 s36, s31, 30720
    buffer_load_dwordx4 v9, s[16:19], s36 offen lds
    s_add_u32 m0, s32, 3072
    s_add_u32 s36, s30, 20480
    buffer_load_dwordx4 v8, s[12:15], s36 offen lds
    s_add_u32 m0, s32, 19456
    s_add_u32 s36, s31, 30848
    buffer_load_dwordx4 v9, s[16:19], s36 offen lds
    s_add_u32 m0, s32, 4096
    s_add_u32 s36, s30, 40960
    buffer_load_dwordx4 v7, s[12:15], s36 offen lds
    s_add_u32 m0, s32, 20480
    s_add_u32 s36, s31, 61440
    buffer_load_dwordx4 v9, s[16:19], s36 offen lds
    s_add_u32 m0, s32, 5120
    s_add_u32 s36, s30, 40960
    buffer_load_dwordx4 v8, s[12:15], s36 offen lds
    s_add_u32 m0, s32, 21504
    s_add_u32 s36, s31, 61568
    buffer_load_dwordx4 v9, s[16:19], s36 offen lds
    s_add_u32 m0, s32, 6144
    s_add_u32 s36, s30, 61440
    buffer_load_dwordx4 v7, s[12:15], s36 offen lds
    s_add_u32 m0, s32, 22528
    s_add_u32 s36, s31, 92160
    buffer_load_dwordx4 v9, s[16:19], s36 offen lds
    s_add_u32 m0, s32, 7168
    s_add_u32 s36, s30, 61440
    buffer_load_dwordx4 v8, s[12:15], s36 offen lds
    s_add_u32 m0, s32, 23552
    s_add_u32 s36, s31, 92288
    buffer_load_dwordx4 v9, s[16:19], s36 offen lds
    s_add_u32 s30, s30, 128
    s_add_u32 s31, s31, 245760
    s_cmp_eq_u32 s30, 1280
    s_cselect_b32 s31, 0, s31
    s_cselect_b32 s30, 0, s30
    s_add_u32 s32, s32, 32768
    s_and_b32 s32, s32, 131071
    s_add_u32 s29, s29, 1
    s_cmp_eq_u32 s29, 2
    s_cbranch_scc0 qkv_l2
    s_waitcnt vmcnt(16)
    s_barrier
qkv_l2:
    s_cmp_lt_u32 s29, 4
    s_cbranch_scc1 qkv_lloop
    s_cmp_eq_u32 s29, 10
    s_cbranch_scc1 qkv_ltail
    s_waitcnt vmcnt(32)
    s_barrier
    s_branch qkv_lloop
qkv_ltail:
    s_waitcnt vmcnt(32)
    s_barrier
    s_waitcnt vmcnt(16)
    s_barrier
    s_waitcnt vmcnt(0)
    s_barrier
    s_barrier
    s_branch aw_body
qkv_stat:
    s_setprio 0
    v_mov_b32 v14, 0x3f803f80
    v_mov_b32 v16, 0
    v_mov_b32 v17, 0
    v_mov_b32 v18, 0
    v_mov_b32 v19, 0
    v_mov_b32 v20, 0
    v_mov_b32 v21, 0
    v_mov_b32 v22, 0
    v_mov_b32 v23, 0
    s_mov_b32 s28, 0
    s_waitcnt lgkmcnt(0)
    s_mov_b32 s12, s10
    s_mov_b32 s13, s11
    s_mov_b32 s14, 30932992
    s_mov_b32 s15, 0x00020000
    s_mov_b32 s16, s8
    s_mov_b32 s17, s9
    s_mov_b32 s18, 256
    s_mov_b32 s19, 0x00020000
    s_cmp_eq_u32 s24, 5
    s_cbranch_scc1 qkv_cols
    v_lshrrev_b32 v2, 3, v1
    v_lshlrev_b32 v7, 10, v2
    v_and_b32 v2, 7, v1
    v_lshl_add_u32 v7, v2, 6, v7
    v_bfe_u32 v2, v1, 2, 2
    v_lshl_add_u32 v7, v2, 4, v7
    v_xor_b32 v8, 16, v7
    v_xor_b32 v9, 32, v7
    v_xor_b32 v10, 48, v7
    s_mov_b32 s36, s39
    s_sub_u32 s33, s39, s36
    s_and_b32 s36, s33, 3
    s_lshl_b32 s36, s36, 15
    v_add_u32 v7, s36, v7
    v_add_u32 v8, s36, v8
    v_add_u32 v9, s36, v9
    v_add_u32 v10, s36, v10
L_ts_1:
    s_barrier
    s_add_u32 s28, s28, 1
    s_cmp_le_u32 s28, s33
    s_cbranch_scc1 L_ts_1
    v_and_b32 v2, 15, v1
    v_lshlrev_b32 v2, 2, v2
    buffer_load_dword v3, v2, s[16:19], 0 offen sc1
    ds_read_b128 v[32:35], v7 offset:0
    ds_read_b128 v[36:39], v8 offset:0
    ds_read_b128 v[40:43], v9 offset:0
    ds_read_b128 v[44:47], v10 offset:0
    ds_read_b128 v[48:51], v7 offset:512
    ds_read_b128 v[52:55], v8 offset:512
    ds_read_b128 v[56:59], v9 offset:512
    ds_read_b128 v[60:63], v10 offset:512
    ds_read_b128 v[64:67], v7 offset:8192
    ds_read_b128 v[68:71], v8 offset:8192
    ds_read_b128 v[72:75], v9 offset:8192
    ds_read_b128 v[76:79], v10 offset:8192
    ds_read_b128 v[80:83], v7 offset:8704
    ds_read_b128 v[84:87], v8 offset:8704
    ds_read_b128 v[88:91], v9 offset:8704
    ds_read_b128 v[92:95], v10 offset:8704
    s_waitcnt lgkmcnt(0)
    v_dot2c_f32_bf16 v16, v32, v14
    v_dot2c_f32_bf16 v17, v32, v32
    v_dot2c_f32_bf16 v16, v33, v14
    v_dot2c_f32_bf16 v17, v33, v33
    v_dot2c_f32_bf16 v16, v34, v14
    v_dot2c_f32_bf16 v17, v34, v34
    v_dot2c_f32_bf16 v16, v35, v14
    v_dot2c_f32_bf16 v17, v35, v35
    v_dot2c_f32_bf16 v16, v36, v14
    v_dot2c_f32_bf16 v17, v36, v36
    v_dot2c_f32_bf16 v16, v37, v14
    v_dot2c_f32_bf16 v17, v37, v37
    v_dot2c_f32_bf16 v16, v38, v14
    v_dot2c_f32_bf16 v17, v38, v38
    v_dot2c_f32_bf16 v16, v39, v14
    v_dot2c_f32_bf16 v17, v39, v39
    v_dot2c_f32_bf16 v16, v40, v14
    v_dot2c_f32_bf16 v17, v40, v40
    v_dot2c_f32_bf16 v16, v41, v14
    v_dot2c_f32_bf16 v17, v41, v41
    v_dot2c_f32_bf16 v16, v42, v14
    v_dot2c_f32_bf16 v17, v42, v42
    v_dot2c_f32_bf16 v16, v43, v14
    v_dot2c_f32_bf16 v17, v43, v43
    v_dot2c_f32_bf16 v16, v44, v14
    v_dot2c_f32_bf16 v17, v44, v44
    v_dot2c_f32_bf16 v16, v45, v14
    v_dot2c_f32_bf16 v17, v45, v45
    v_dot2c_f32_bf16 v16, v46, v14
    v_dot2c_f32_bf16 v17, v46, v46
    v_dot2c_f32_bf16 v16, v47, v14
    v_dot2c_f32_bf16 v17, v47, v47
    v_dot2c_f32_bf16 v16, v48, v14
    v_dot2c_f32_bf16 v17, v48, v48
    v_dot2c_f32_bf16 v16, v49, v14
    v_dot2c_f32_bf16 v17, v49, v49
    v_dot2c_f32_bf16 v16, v50, v14
    v_dot2c_f32_bf16 v17, v50, v50
    v_dot2c_f32_bf16 v16, v51, v14
    v_dot2c_f32_bf16 v17, v51, v51
    v_dot2c_f32_bf16 v16, v52, v14
    v_dot2c_f32_bf16 v17, v52, v52
    v_dot2c_f32_bf16 v16, v53, v14
    v_dot2c_f32_bf16 v17, v53, v53
    v_dot2c_f32_bf16 v16, v54, v14
    v_dot2c_f32_bf16 v17, v54, v54
    v_dot2c_f32_bf16 v16, v55, v14
    v_dot2c_f32_bf16 v17, v55, v55
    v_dot2c_f32_bf16 v16, v56, v14
    v_dot2c_f32_bf16 v17, v56, v56
    v_dot2c_f32_bf16 v16, v57, v14
    v_dot2c_f32_bf16 v17, v57, v57
    v_dot2c_f32_bf16 v16, v58, v14
    v_dot2c_f32_bf16 v17, v58, v58
    v_dot2c_f32_bf16 v16, v59, v14
    v_dot2c_f32_bf16 v17, v59, v59
    v_dot2c_f32_bf16 v16, v60, v14
    v_dot2c_f32_bf16 v17, v60, v60
    v_dot2c_f32_bf16 v16, v61, v14
    v_dot2c_f32_bf16 v17, v61, v61
    v_dot2c_f32_bf16 v16, v62, v14
    v_dot2c_f32_bf16 v17, v62, v62
    v_dot2c_f32_bf16 v16, v63, v14
    v_dot2c_f32_bf16 v17, v63, v63
    s_cmp_ge_u32 s28, 10
    s_cbranch_scc1 L_qb_2
    s_barrier
    s_add_u32 s28, s28, 1
L_qb_2:
    v_dot2c_f32_bf16 v18, v64, v14
    v_dot2c_f32_bf16 v19, v64, v64
    v_dot2c_f32_bf16 v18, v65, v14
    v_dot2c_f32_bf16 v19, v65, v65
    v_dot2c_f32_bf16 v18, v66, v14
    v_dot2c_f32_bf16 v19, v66, v66
    v_dot2c_f32_bf16 v18, v67, v14
    v_dot2c_f32_bf16 v19, v67, v67
    v_dot2c_f32_bf16 v18, v68, v14
    v_dot2c_f32_bf16 v19, v68, v68
    v_dot2c_f32_bf16 v18, v69, v14
    v_dot2c_f32_bf16 v19, v69, v69
    v_dot2c_f32_bf16 v18, v70, v14
    v_dot2c_f32_bf16 v19, v70, v70
    v_dot2c_f32_bf16 v18, v71, v14
    v_dot2c_f32_bf16 v19, v71, v71
    v_dot2c_f32_bf16 v18, v72, v14
    v_dot2c_f32_bf16 v19, v72, v72
    v_dot2c_f32_bf16 v18, v73, v14
    v_dot2c_f32_bf16 v19, v73, v73
    v_dot2c_f32_bf16 v18, v74, v14
    v_dot2c_f32_bf16 v19, v74, v74
    v_dot2c_f32_bf16 v18, v75, v14
    v_dot2c_f32_bf16 v19, v75, v75
    v_dot2c_f32_bf16 v18, v76, v14
    v_dot2c_f32_bf16 v19, v76, v76
    v_dot2c_f32_bf16 v18, v77, v14
    v_dot2c_f32_bf16 v19, v77, v77
    v_dot2c_f32_bf16 v18, v78, v14
    v_dot2c_f32_bf16 v19, v78, v78
    v_dot2c_f32_bf16 v18, v79, v14
    v_dot2c_f32_bf16 v19, v79, v79
    v_dot2c_f32_bf16 v18, v80, v14
    v_dot2c_f32_bf16 v19, v80, v80
    v_dot2c_f32_bf16 v18, v81, v14
    v_dot2c_f32_bf16 v19, v81, v81
    v_dot2c_f32_bf16 v18, v82, v14
    v_dot2c_f32_bf16 v19, v82, v82
    v_dot2c_f32_bf16 v18, v83, v14
    v_dot2c_f32_bf16 v19, v83, v83
    v_dot2c_f32_bf16 v18, v84, v14
    v_dot2c_f32_bf16 v19, v84, v84
    v_dot2c_f32_bf16 v18, v85, v14
    v_dot2c_f32_bf16 v19, v85, v85
    v_dot2c_f32_bf16 v18, v86, v14
    v_dot2c_f32_bf16 v19, v86, v86
    v_dot2c_f32_bf16 v18, v87, v14
    v_dot2c_f32_bf16 v19, v87, v87
    v_dot2c_f32_bf16 v18, v88, v14
    v_dot2c_f32_bf16 v19, v88, v88
    v_dot2c_f32_bf16 v18, v89, v14
    v_dot2c_f32_bf16 v19, v89, v89
    v_dot2c_f32_bf16 v18, v90, v14
    v_dot2c_f32_bf16 v19, v90, v90
    v_dot2c_f32_bf16 v18, v91, v14
    v_dot2c_f32_bf16 v19, v91, v91
    v_dot2c_f32_bf16 v18, v92, v14
    v_dot2c_f32_bf16 v19, v92, v92
    v_dot2c_f32_bf16 v18, v93, v14
    v_dot2c_f32_bf16 v19, v93, v93
    v_dot2c_f32_bf16 v18, v94, v14
    v_dot2c_f32_bf16 v19, v94, v94
    v_dot2c_f32_bf16 v18, v95, v14
    v_dot2c_f32_bf16 v19, v95, v95
    s_mov_b32 s35, 0
    s_branch qkv_iw0c
qkv_iw0:
    buffer_load_dword v3, v2, s[16:19], 0 offen sc1
    s_cmp_ge_u32 s28, 10
    s_cbranch_scc1 L_qb_3
    s_barrier
    s_add_u32 s28, s28, 1
L_qb_3:
qkv_iw0c:
    s_add_u32 s35, s35, 1
    s_waitcnt vmcnt(0)
    v_cmp_eq_u32 vcc, 0, v3
    s_cmp_gt_u32 s35, 524288
    s_cbranch_scc1 qkv_iw0x
    s_cmp_lg_u64 vcc, 0
    s_cbranch_scc1 qkv_iw0
qkv_iw0x:
    v_and_b32 v17, 0x7fffffff, v17
    v_and_b32 v19, 0x7fffffff, v19
    v_lshlrev_b32 v7, 3, v1
    s_mul_i32 s31, s25, 10240
    s_add_u32 s31, s31, 21233664
    s_lshl_b32 s36, s39, 10
    s_add_u32 s36, s36, s31
    s_cmp_ge_u32 s26, 10
    s_cbranch_scc1 qkv_r1
    buffer_store_dwordx2 v[16:17], v7, s[12:15], s36 offen sc1
    buffer_store_dwordx2 v[18:19], v7, s[12:15], s36 offen offset:512 sc1
qkv_r1:
L_un_4:
    s_cmp_ge_u32 s28, 6
    s_cbranch_scc1 L_un_4x
    s_barrier
    s_add_u32 s28, s28, 1
    s_branch L_un_4
L_un_4x:
    s_mov_b32 s35, 0
qkv_rg:
    s_add_u32 s36, s31, 0
    buffer_load_dwordx2 v[32:33], v7, s[12:15], s36 offen offset:0 sc1
    buffer_load_dwordx2 v[52:53], v7, s[12:15], s36 offen offset:512 sc1
    buffer_load_dwordx2 v[34:35], v7, s[12:15], s36 offen offset:1024 sc1
    buffer_load_dwordx2 v[54:55], v7, s[12:15], s36 offen offset:1536 sc1
    buffer_load_dwordx2 v[36:37], v7, s[12:15], s36 offen offset:2048 sc1
    buffer_load_dwordx2 v[56:57], v7, s[12:15], s36 offen offset:2560 sc1
    buffer_load_dwordx2 v[38:39], v7, s[12:15], s36 offen offset:3072 sc1
    buffer_load_dwordx2 v[58:59], v7, s[12:15], s36 offen offset:3584 sc1
    s_add_u32 s36, s31, 4096
    buffer_load_dwordx2 v[40:41], v7, s[12:15], s36 offen offset:0 sc1
    buffer_load_dwordx2 v[60:61], v7, s[12:15], s36 offen offset:512 sc1
    buffer_load_dwordx2 v[42:43], v7, s[12:15], s36 offen offset:1024 sc1
    buffer_load_dwordx2 v[62:63], v7, s[12:15], s36 offen offset:1536 sc1
    buffer_load_dwordx2 v[44:45], v7, s[12:15], s36 offen offset:2048 sc1
    buffer_load_dwordx2 v[64:65], v7, s[12:15], s36 offen offset:2560 sc1
    buffer_load_dwordx2 v[46:47], v7, s[12:15], s36 offen offset:3072 sc1
    buffer_load_dwordx2 v[66:67], v7, s[12:15], s36 offen offset:3584 sc1
    s_add_u32 s36, s31, 8192
    buffer_load_dwordx2 v[48:49], v7, s[12:15], s36 offen offset:0 sc1
    buffer_load_dwordx2 v[68:69], v7, s[12:15], s36 offen offset:512 sc1
    buffer_load_dwordx2 v[50:51], v7, s[12:15], s36 offen offset:1024 sc1
    buffer_load_dwordx2 v[70:71], v7, s[12:15], s36 offen offset:1536 sc1
    s_cmp_ge_u32 s28, 10
    s_cbranch_scc1 L_qb_5
    s_barrier
    s_add_u32 s28, s28, 1
L_qb_5:
    s_add_u32 s35, s35, 1
    s_waitcnt vmcnt(0)
    v_max_u32 v2, v33, v35
    v_max3_u32 v2, v37, v39, v2
    v_max3_u32 v2, v41, v43, v2
    v_max3_u32 v2, v45, v47, v2
    v_max3_u32 v2, v49, v51, v2
    v_max3_u32 v2, v53, v55, v2
    v_max3_u32 v2, v57, v59, v2
    v_max3_u32 v2, v61, v63, v2
    v_max3_u32 v2, v65, v67, v2
    v_max3_u32 v2, v69, v71, v2
    v_cmp_eq_u32 vcc, -1, v2
    s_cmp_gt_u32 s35, 524288
    s_cbranch_scc1 qkv_rgx
    s_cmp_lg_u64 vcc, 0
    s_cbranch_scc1 qkv_rg
qkv_rgx:
    s_cmp_lt_u32 s26, 5
    s_cselect_b32 s36, 0x3ea52b5c, 1.0
    v_lshlrev_b32 v8, 2, v1
    v_add_u32 v8, 131072, v8
    v_add_f32 v32, v32, v34
    v_add_f32 v33, v33, v35
    v_add_f32 v32, v32, v36
    v_add_f32 v33, v33, v37
    v_add_f32 v32, v32, v38
    v_add_f32 v33, v33, v39
    v_add_f32 v32, v32, v40
    v_add_f32 v33, v33, v41
    v_add_f32 v32, v32, v42
    v_add_f32 v33, v33, v43
    v_add_f32 v32, v32, v44
    v_add_f32 v33, v33, v45
    v_add_f32 v32, v32, v46
    v_add_f32 v33, v33, v47
    v_add_f32 v32, v32, v48
    v_add_f32 v33, v33, v49
    v_add_f32 v32, v32, v50
    v_add_f32 v33, v33, v51
    v_mul_f32 v32, 0x3acccccd, v32
    v_mul_f32 v33, 0x3acccccd, v33
    v_fma_f32 v33, -v32, v32, v33
    v_max_f32 v33, 0, v33
    v_add_f32 v33, 0x3727c5ac, v33
    v_rsq_f32 v33, v33
    s_nop 0
    v_mul_f32 v33, s36, v33
    ds_write_b32 v8, v33 offset:0
    ds_write_b32 v8, v32 offset:512
    v_add_f32 v52, v52, v54
    v_add_f32 v53, v53, v55
    v_add_f32 v52, v52, v56
    v_add_f32 v53, v53, v57
    v_add_f32 v52, v52, v58
    v_add_f32 v53, v53, v59
    v_add_f32 v52, v52, v60
    v_add_f32 v53, v53, v61
    v_add_f32 v52, v52, v62
    v_add_f32 v53, v53, v63
    v_add_f32 v52, v52, v64
    v_add_f32 v53, v53, v65
    v_add_f32 v52, v52, v66
    v_add_f32 v53, v53, v67
    v_add_f32 v52, v52, v68
    v_add_f32 v53, v53, v69
    v_add_f32 v52, v52, v70
    v_add_f32 v53, v53, v71
    v_mul_f32 v52, 0x3acccccd, v52
    v_mul_f32 v53, 0x3acccccd, v53
    v_fma_f32 v53, -v52, v52, v53
    v_max_f32 v53, 0, v53
    v_add_f32 v53, 0x3727c5ac, v53
    v_rsq_f32 v53, v53
    s_nop 0
    v_mul_f32 v53, s36, v53
    ds_write_b32 v8, v53 offset:256
    ds_write_b32 v8, v52 offset:768
    s_waitcnt lgkmcnt(0)
L_qf_6:
    s_barrier
    s_add_u32 s28, s28, 1
    s_cmp_le_u32 s28, 10
    s_cbranch_scc1 L_qf_6
    s_branch aw_body
qkv_cols:
    v_mov_b32 v7, 159824
    ds_write_b32 v7, v16
    s_lshl_b32 s36, s35, 13
    s_cmp_ge_u32 s36, tail_start - qkv_pc
    s_cbranch_scc1 qkv_pcx
    s_getpc_b64 s[48:49]
qkv_pc:
    v_lshl_add_u32 v2, v1, 7, s36
    v_min_u32 v2, tail_start - qkv_pc - 4, v2
    global_load_dword v15, v2, s[48:49]
qkv_pcx:
    v_and_b32 v7, 3, v1
    v_lshlrev_b32 v7, 3, v7
    v_bfe_u32 v2, v1, 4, 1
    v_lshl_add_u32 v7, v2, 5, v7
    v_bfe_u32 v2, v1, 2, 2
    v_lshl_add_u32 v7, v2, 6, v7
    v_lshl_add_u32 v7, v5, 11, v7
    s_waitcnt lgkmcnt(0)
    s_mov_b32 s36, s39
    s_sub_u32 s33, s39, s36
    s_and_b32 s36, s33, 3
    s_lshl_b32 s36, s36, 15
    v_add_u32 v7, s36, v7
L_ts_7:
    s_barrier
    s_add_u32 s28, s28, 1
    s_cmp_le_u32 s28, s33
    s_cbranch_scc1 L_ts_7
    v_and_b32 v2, 15, v1
    v_lshlrev_b32 v2, 2, v2
    buffer_load_dword v3, v2, s[16:19], 0 offen sc1
    ds_read_b64_tr_b16 v[32:33], v7 offset:16384
    ds_read_b64_tr_b16 v[34:35], v7 offset:16896
    ds_read_b64_tr_b16 v[36:37], v7 offset:20480
    ds_read_b64_tr_b16 v[38:39], v7 offset:20992
    ds_read_b64_tr_b16 v[40:41], v7 offset:24576
    ds_read_b64_tr_b16 v[42:43], v7 offset:25088
    ds_read_b64_tr_b16 v[44:45], v7 offset:28672
    ds_read_b64_tr_b16 v[46:47], v7 offset:29184
    ds_read_b64_tr_b16 v[48:49], v7 offset:16640
    ds_read_b64_tr_b16 v[50:51], v7 offset:17152
    ds_read_b64_tr_b16 v[52:53], v7 offset:20736
    ds_read_b64_tr_b16 v[54:55], v7 offset:21248
    ds_read_b64_tr_b16 v[56:57], v7 offset:24832
    ds_read_b64_tr_b16 v[58:59], v7 offset:25344
    ds_read_b64_tr_b16 v[60:61], v7 offset:28928
    ds_read_b64_tr_b16 v[62:63], v7 offset:29440
    ds_read_b64_tr_b16 v[64:65], v7 offset:17408
    ds_read_b64_tr_b16 v[66:67], v7 offset:17920
    ds_read_b64_tr_b16 v[68:69], v7 offset:21504
    ds_read_b64_tr_b16 v[70:71], v7 offset:22016
    ds_read_b64_tr_b16 v[72:73], v7 offset:25600
    ds_read_b64_tr_b16 v[74:75], v7 offset:26112
    ds_read_b64_tr_b16 v[76:77], v7 offset:29696
    ds_read_b64_tr_b16 v[78:79], v7 offset:30208
    ds_read_b64_tr_b16 v[80:81], v7 offset:17664
    ds_read_b64_tr_b16 v[82:83], v7 offset:18176
    ds_read_b64_tr_b16 v[84:85], v7 offset:21760
    ds_read_b64_tr_b16 v[86:87], v7 offset:22272
    ds_read_b64_tr_b16 v[88:89], v7 offset:25856
    ds_read_b64_tr_b16 v[90:91], v7 offset:26368
    ds_read_b64_tr_b16 v[92:93], v7 offset:29952
    ds_read_b64_tr_b16 v[94:95], v7 offset:30464
    s_waitcnt lgkmcnt(0)
    v_dot2c_f32_bf16 v16, v32, v14
    v_dot2c_f32_bf16 v17, v48, v14
    v_dot2c_f32_bf16 v18, v64, v14
    v_dot2c_f32_bf16 v19, v80, v14
    v_dot2c_f32_bf16 v16, v33, v14
    v_dot2c_f32_bf16 v17, v49, v14
    v_dot2c_f32_bf16 v18, v65, v14
    v_dot2c_f32_bf16 v19, v81, v14
    v_dot2c_f32_bf16 v16, v34, v14
    v_dot2c_f32_bf16 v17, v50, v14
    v_dot2c_f32_bf16 v18, v66, v14
    v_dot2c_f32_bf16 v19, v82, v14
    v_dot2c_f32_bf16 v16, v35, v14
    v_dot2c_f32_bf16 v17, v51, v14
    v_dot2c_f32_bf16 v18, v67, v14
    v_dot2c_f32_bf16 v19, v83, v14
    v_dot2c_f32_bf16 v16, v36, v14
    v_dot2c_f32_bf16 v17, v52, v14
    v_dot2c_f32_bf16 v18, v68, v14
    v_dot2c_f32_bf16 v19, v84, v14
    v_dot2c_f32_bf16 v16, v37, v14
    v_dot2c_f32_bf16 v17, v53, v14
    v_dot2c_f32_bf16 v18, v69, v14
    v_dot2c_f32_bf16 v19, v85, v14
    v_dot2c_f32_bf16 v16, v38, v14
    v_dot2c_f32_bf16 v17, v54, v14
    v_dot2c_f32_bf16 v18, v70, v14
    v_dot2c_f32_bf16 v19, v86, v14
    v_dot2c_f32_bf16 v16, v39, v14
    v_dot2c_f32_bf16 v17, v55, v14
    v_dot2c_f32_bf16 v18, v71, v14
    v_dot2c_f32_bf16 v19, v87, v14
    v_dot2c_f32_bf16 v16, v40, v14
    v_dot2c_f32_bf16 v17, v56, v14
    v_dot2c_f32_bf16 v18, v72, v14
    v_dot2c_f32_bf16 v19, v88, v14
    v_dot2c_f32_bf16 v16, v41, v14
    v_dot2c_f32_bf16 v17, v57, v14
    v_dot2c_f32_bf16 v18, v73, v14
    v_dot2c_f32_bf16 v19, v89, v14
    v_dot2c_f32_bf16 v16, v42, v14
    v_dot2c_f32_bf16 v17, v58, v14
    v_dot2c_f32_bf16 v18, v74, v14
    v_dot2c_f32_bf16 v19, v90, v14
    v_dot2c_f32_bf16 v16, v43, v14
    v_dot2c_f32_bf16 v17, v59, v14
    v_dot2c_f32_bf16 v18, v75, v14
    v_dot2c_f32_bf16 v19, v91, v14
    v_dot2c_f32_bf16 v16, v44, v14
    v_dot2c_f32_bf16 v17, v60, v14
    v_dot2c_f32_bf16 v18, v76, v14
    v_dot2c_f32_bf16 v19, v92, v14
    v_dot2c_f32_bf16 v16, v45, v14
    v_dot2c_f32_bf16 v17, v61, v14
    v_dot2c_f32_bf16 v18, v77, v14
    v_dot2c_f32_bf16 v19, v93, v14
    v_dot2c_f32_bf16 v16, v46, v14
    v_dot2c_f32_bf16 v17, v62, v14
    v_dot2c_f32_bf16 v18, v78, v14
    v_dot2c_f32_bf16 v19, v94, v14
    v_dot2c_f32_bf16 v16, v47, v14
    v_dot2c_f32_bf16 v17, v63, v14
    v_dot2c_f32_bf16 v18, v79, v14
    v_dot2c_f32_bf16 v19, v95, v14
    s_nop 2
    v_permlane32_swap_b32 v16, v17
    v_permlane32_swap_b32 v18, v19
    s_nop 1
    v_add_f32 v16, v16, v17
    v_add_f32 v18, v18, v19
    v_min_u32 v16, -2, v16
    v_min_u32 v18, -2, v18
    s_mov_b32 s35, 0
    s_branch qkv_iw1c
qkv_iw1:
    buffer_load_dword v3, v2, s[16:19], 0 offen sc1
    s_cmp_ge_u32 s28, 10
    s_cbranch_scc1 L_qb_8
    s_barrier
    s_add_u32 s28, s28, 1
L_qb_8:
qkv_iw1c:
    s_add_u32 s35, s35, 1
    s_waitcnt vmcnt(0)
    v_cmp_eq_u32 vcc, 0, v3
    s_cmp_gt_u32 s35, 524288
    s_cbranch_scc1 qkv_iw1x
    s_cmp_lg_u64 vcc, 0
    s_cbranch_scc1 qkv_iw1
qkv_iw1x:
    v_lshlrev_b32 v7, 2, v1
    s_mul_i32 s31, s26, 5120
    s_add_u32 s31, s31, 21397504
    s_lshl_b32 s36, s39, 9
    s_add_u32 s36, s36, s31
    s_cmp_ge_u32 s25, 10
    s_cbranch_scc1 qkv_c1
    buffer_store_dword v16, v7, s[12:15], s36 offen sc1
    buffer_store_dword v18, v7, s[12:15], s36 offen offset:256 sc1
qkv_c1:
    v_lshlrev_b32 v7, 3, v1
    s_add_u32 s32, s31, 4096
L_un_9:
    s_cmp_ge_u32 s28, 6
    s_cbranch_scc1 L_un_9x
    s_barrier
    s_add_u32 s28, s28, 1
    s_branch L_un_9
L_un_9x:
    s_mov_b32 s35, 0
qkv_cg:
    buffer_load_dwordx2 v[32:33], v7, s[12:15], s31 offen offset:0 sc1
    buffer_load_dwordx2 v[34:35], v7, s[12:15], s31 offen offset:512 sc1
    buffer_load_dwordx2 v[36:37], v7, s[12:15], s31 offen offset:1024 sc1
    buffer_load_dwordx2 v[38:39], v7, s[12:15], s31 offen offset:1536 sc1
    buffer_load_dwordx2 v[40:41], v7, s[12:15], s31 offen offset:2048 sc1
    buffer_load_dwordx2 v[42:43], v7, s[12:15], s31 offen offset:2560 sc1
    buffer_load_dwordx2 v[44:45], v7, s[12:15], s31 offen offset:3072 sc1
    buffer_load_dwordx2 v[46:47], v7, s[12:15], s31 offen offset:3584 sc1
    buffer_load_dwordx2 v[48:49], v7, s[12:15], s32 offen offset:0 sc1
    buffer_load_dwordx2 v[50:51], v7, s[12:15], s32 offen offset:512 sc1
    s_cmp_ge_u32 s28, 10
    s_cbranch_scc1 L_qb_10
    s_barrier
    s_add_u32 s28, s28, 1
L_qb_10:
    s_add_u32 s35, s35, 1
    s_waitcnt vmcnt(0)
    v_max_u32 v2, v32, v33
    v_max3_u32 v2, v34, v35, v2
    v_max3_u32 v2, v36, v37, v2
    v_max3_u32 v2, v38, v39, v2
    v_max3_u32 v2, v40, v41, v2
    v_max3_u32 v2, v42, v43, v2
    v_max3_u32 v2, v44, v45, v2
    v_max3_u32 v2, v46, v47, v2
    v_max3_u32 v2, v48, v49, v2
    v_max3_u32 v2, v50, v51, v2
    v_cmp_eq_u32 vcc, -1, v2
    s_cmp_gt_u32 s35, 524288
    s_cbranch_scc1 qkv_cgx
    s_cmp_lg_u64 vcc, 0
    s_cbranch_scc1 qkv_cg
qkv_cgx:
    v_add_f32 v32, v32, v34
    v_add_f32 v33, v33, v35
    v_add_f32 v32, v32, v36
    v_add_f32 v33, v33, v37
    v_add_f32 v32, v32, v38
    v_add_f32 v33, v33, v39
    v_add_f32 v32, v32, v40
    v_add_f32 v33, v33, v41
    v_add_f32 v32, v32, v42
    v_add_f32 v33, v33, v43
    v_add_f32 v32, v32, v44
    v_add_f32 v33, v33, v45
    v_add_f32 v32, v32, v46
    v_add_f32 v33, v33, v47
    v_add_f32 v32, v32, v48
    v_add_f32 v33, v33, v49
    v_add_f32 v32, v32, v50
    v_add_f32 v33, v33, v51
    v_mov_b32 v250, v32
    v_mov_b32 v251, v33
    v_add_u32 v7, 132096, v7
    ds_write_b64 v7, v[32:33]
    s_waitcnt lgkmcnt(0)
L_qf_11:
    s_barrier
    s_add_u32 s28, s28, 1
    s_cmp_le_u32 s28, 10
    s_cbranch_scc1 L_qf_11
    s_branch aw_body
qkv_spare:
    v_mov_b32 v4, -1
    v_mov_b32 v8, 0
    v_mov_b32 v5, -1
    v_mov_b32 v9, 0
    v_mov_b32 v6, -1
    v_mov_b32 v10, 0
    v_mov_b32 v7, -1
    v_mov_b32 v11, 0
    v_lshlrev_b32 v2, 4, v0
    v_mov_b32 v12, 0
    v_mov_b32 v13, 1
    v_mov_b32 v14, 159824
    v_mov_b32 v15, 4
    ds_write_b32 v14, v15
    s_waitcnt lgkmcnt(0)
    s_mov_b32 s12, s10
    s_mov_b32 s13, s11
    s_mov_b32 s14, 30932992
    s_mov_b32 s15, 0x00020000
    s_mov_b32 s16, s8
    s_mov_b32 s17, s9
    s_mov_b32 s18, 256
    s_mov_b32 s19, 0x00020000
    s_mul_i32 s36, s25, 16384
    s_add_u32 s36, s36, 21233664
    buffer_store_dwordx4 v[4:7], v2, s[12:15], s36 offen sc1
    s_add_u32 s36, s36, 8192
    buffer_store_dwordx4 v[4:7], v2, s[12:15], s36 offen sc1
    s_add_u32 s36, s36, 8192
    s_mul_i32 s36, s25, 8192
    s_add_u32 s36, s36, 21102592
    buffer_store_dwordx4 v[8:11], v2, s[12:15], s36 offen sc1
    s_add_u32 s36, s36, 8192
    s_waitcnt vmcnt(0)
    s_barrier
    s_cmp_lg_u32 s24, 0
    s_cbranch_scc1 L_qd_12
    s_lshl_b32 s36, s25, 2
    s_mov_b64 exec, 1
    buffer_store_dword v13, v12, s[16:19], s36 offen offset:0 sc1
    s_mov_b64 exec, -1
L_qd_12:
    s_mul_i32 s36, s25, 24576
    s_add_u32 s36, s36, 20316160
    buffer_store_dwordx4 v[4:7], v2, s[12:15], s36 offen sc1
    s_add_u32 s36, s36, 8192
    buffer_store_dwordx4 v[4:7], v2, s[12:15], s36 offen sc1
    s_add_u32 s36, s36, 8192
    buffer_store_dwordx4 v[4:7], v2, s[12:15], s36 offen sc1
    s_add_u32 s36, s36, 8192
    s_mul_i32 s36, s25, 24576
    s_add_u32 s36, s36, 20709376
    buffer_store_dwordx4 v[8:11], v2, s[12:15], s36 offen sc1
    s_add_u32 s36, s36, 8192
    buffer_store_dwordx4 v[8:11], v2, s[12:15], s36 offen sc1
    s_add_u32 s36, s36, 8192
    buffer_store_dwordx4 v[8:11], v2, s[12:15], s36 offen sc1
    s_add_u32 s36, s36, 8192
    s_waitcnt vmcnt(0)
    s_barrier
    s_cmp_lg_u32 s24, 0
    s_cbranch_scc1 L_qd_13
    s_lshl_b32 s36, s25, 2
    s_mov_b64 exec, 1
    buffer_store_dword v13, v12, s[16:19], s36 offen offset:128 sc1
    s_mov_b64 exec, -1
L_qd_13:
    s_branch aw_body
qkv_cons:
    s_lshr_b32 s27, s24, 1
    s_and_b32 s28, s24, 1
    v_and_b32 v6, 31, v1
    v_and_b32 v8, 3, v1
    v_lshlrev_b32 v8, 3, v8
    v_bfe_u32 v2, v1, 4, 1
    v_lshl_add_u32 v8, v2, 5, v8
    v_bfe_u32 v4, v1, 2, 2
    v_lshl_add_u32 v8, v4, 6, v8
    v_lshl_add_u32 v8, v5, 11, v8
    s_lshl_b32 s36, s28, 10
    s_add_u32 s36, s36, 16384
    v_add_u32 v8, s36, v8
    v_bfe_u32 v2, v1, 3, 2
    v_and_b32 v3, 7, v1
    v_xor_b32 v4, v4, v5
    v_lshlrev_b32 v7, 4, v4
    v_lshl_add_u32 v7, v3, 6, v7
    v_lshl_add_u32 v7, v2, 10, v7
    s_lshl_b32 s36, s27, 13
    v_add_u32 v7, s36, v7
    v_mov_b32 v9, v7
    v_xor_b32 v10, 32, v7
    v_mov_b32 v11, v8
    v_mov_b32 v20, 0
    v_mov_b32 v21, 0
    v_mov_b32 v22, 0
    v_mov_b32 v23, 0
    v_mov_b32 v24, 0
    v_mov_b32 v25, 0
    v_mov_b32 v26, 0
    v_mov_b32 v27, 0
    v_mov_b32 v28, 0
    v_mov_b32 v29, 0
    v_mov_b32 v30, 0
    v_mov_b32 v31, 0
    v_mov_b32 v32, 0
    v_mov_b32 v33, 0
    v_mov_b32 v34, 0
    v_mov_b32 v35, 0
    v_mov_b32 v36, 0
    v_mov_b32 v37, 0
    v_mov_b32 v38, 0
    v_mov_b32 v39, 0
    v_mov_b32 v40, 0
    v_mov_b32 v41, 0
    v_mov_b32 v42, 0
    v_mov_b32 v43, 0
    v_mov_b32 v44, 0
    v_mov_b32 v45, 0
    v_mov_b32 v46, 0
    v_mov_b32 v47, 0
    v_mov_b32 v48, 0
    v_mov_b32 v49, 0
    v_mov_b32 v50, 0
    v_mov_b32 v51, 0
    v_mov_b32 v52, 0
    v_mov_b32 v53, 0
    v_mov_b32 v54, 0
    v_mov_b32 v55, 0
    v_mov_b32 v56, 0
    v_mov_b32 v57, 0
    v_mov_b32 v58, 0
    v_mov_b32 v59, 0
    v_mov_b32 v60, 0
    v_mov_b32 v61, 0
    v_mov_b32 v62, 0
    v_mov_b32 v63, 0
    v_mov_b32 v64, 0
    v_mov_b32 v65, 0
    v_mov_b32 v66, 0
    v_mov_b32 v67, 0
    v_mov_b32 v68, 0
    v_mov_b32 v69, 0
    v_mov_b32 v70, 0
    v_mov_b32 v71, 0
    v_mov_b32 v72, 0
    v_mov_b32 v73, 0
    v_mov_b32 v74, 0
    v_mov_b32 v75, 0
    v_mov_b32 v76, 0
    v_mov_b32 v77, 0
    v_mov_b32 v78, 0
    v_mov_b32 v79, 0
    v_mov_b32 v80, 0
    v_mov_b32 v81, 0
    v_mov_b32 v82, 0
    v_mov_b32 v83, 0
    s_lshl_b32 s41, s25, 2
    s_lshl_b32 s36, s27, 1
    s_add_u32 s41, s41, s36
    s_waitcnt lgkmcnt(0)
    s_mov_b32 s12, s10
    s_mov_b32 s13, s11
    s_mov_b32 s14, 30932992
    s_mov_b32 s15, 0x00020000
    s_mov_b32 s29, 0
    s_mov_b32 s33, 0
    s_cmp_ge_u32 s26, 10
    s_cbranch_scc1 qkv_preV
    s_cmp_lt_u32 s26, 5
    s_movk_i32 s42, 2560
    s_cselect_b32 s42, 1280, s42
    s_cselect_b32 s43, 0, 2621440
    s_cselect_b32 s36, 0, 5
    s_sub_u32 s36, s26, s36
    s_lshl_b32 s36, s36, 4
    s_lshl_b32 s37, s28, 3
    s_add_u32 s45, s36, s37
    s_mul_i32 s37, s41, s42
    s_add_u32 s43, s43, s37
    s_add_u32 s44, s43, s42
    s_lshl_b32 s42, s42, 6
    v_lshlrev_b32 v14, 4, v1
    v_lshl_add_u32 v12, v5, 30, v14
    v_mul_lo_u32 v13, v5, s42
    v_lshl_add_u32 v13, v6, 3, v13
    s_barrier
    ds_read_b64_tr_b16 v[92:93], v11 offset:0
    ds_read_b64_tr_b16 v[94:95], v11 offset:512
    ds_read_b128 v[84:87], v9 offset:0
    ds_read_b128 v[88:91], v9 offset:4096
    ds_read_b64_tr_b16 v[96:97], v11 offset:256
    ds_read_b64_tr_b16 v[98:99], v11 offset:768
    ds_read_b64_tr_b16 v[108:109], v11 offset:4096
    ds_read_b64_tr_b16 v[110:111], v11 offset:4608
    ds_read_b128 v[100:103], v10 offset:0
    ds_read_b128 v[104:107], v10 offset:4096
    ds_read_b64_tr_b16 v[112:113], v11 offset:4352
    ds_read_b64_tr_b16 v[114:115], v11 offset:4864
qkv_cloopQK:
    s_waitcnt lgkmcnt(6)
    v_mfma_f32_32x32x16_bf16 v[20:35], v[92:95], v[84:87], v[20:35]
    ds_read_b64_tr_b16 v[124:125], v11 offset:8192
    ds_read_b64_tr_b16 v[126:127], v11 offset:8704
    v_mfma_f32_32x32x16_bf16 v[52:67], v[92:95], v[88:91], v[52:67]
    ds_read_b128 v[116:119], v9 offset:512
    ds_read_b128 v[120:123], v9 offset:4608
    v_mfma_f32_32x32x16_bf16 v[36:51], v[96:99], v[84:87], v[36:51]
    ds_read_b64_tr_b16 v[128:129], v11 offset:8448
    ds_read_b64_tr_b16 v[130:131], v11 offset:8960
    v_mfma_f32_32x32x16_bf16 v[68:83], v[96:99], v[88:91], v[68:83]
    s_add_u32 s33, s33, 32768
    s_and_b32 s33, s33, 131071
    s_waitcnt lgkmcnt(6)
    v_mfma_f32_32x32x16_bf16 v[20:35], v[108:111], v[100:103], v[20:35]
    ds_read_b64_tr_b16 v[140:141], v11 offset:12288
    ds_read_b64_tr_b16 v[142:143], v11 offset:12800
    v_mfma_f32_32x32x16_bf16 v[52:67], v[108:111], v[104:107], v[52:67]
    ds_read_b128 v[132:135], v10 offset:512
    v_mfma_f32_32x32x16_bf16 v[36:51], v[112:115], v[100:103], v[36:51]
    ds_read_b128 v[136:139], v10 offset:4608
    ds_read_b64_tr_b16 v[144:145], v11 offset:12544
    v_mfma_f32_32x32x16_bf16 v[68:83], v[112:115], v[104:107], v[68:83]
    ds_read_b64_tr_b16 v[146:147], v11 offset:13056
    s_waitcnt lgkmcnt(6)
    v_mfma_f32_32x32x16_bf16 v[20:35], v[124:127], v[116:119], v[20:35]
    v_add_u32 v9, s33, v7
    v_add_u32 v11, s33, v8
    v_xor_b32 v10, 32, v9
    s_add_u32 s29, s29, 1
    s_cmp_eq_u32 s29, 10
    v_mfma_f32_32x32x16_bf16 v[52:67], v[124:127], v[120:123], v[52:67]
    s_waitcnt lgkmcnt(0)
    s_barrier
    s_cbranch_scc1 qkv_cdoneQK
    v_mfma_f32_32x32x16_bf16 v[36:51], v[128:131], v[116:119], v[36:51]
    ds_read_b64_tr_b16 v[92:93], v11 offset:0
    ds_read_b64_tr_b16 v[94:95], v11 offset:512
    ds_read_b128 v[84:87], v9 offset:0
    v_mfma_f32_32x32x16_bf16 v[68:83], v[128:131], v[120:123], v[68:83]
    ds_read_b128 v[88:91], v9 offset:4096
    ds_read_b64_tr_b16 v[96:97], v11 offset:256
    ds_read_b64_tr_b16 v[98:99], v11 offset:768
    v_mfma_f32_32x32x16_bf16 v[20:35], v[140:143], v[132:135], v[20:35]
    ds_read_b64_tr_b16 v[108:109], v11 offset:4096
    ds_read_b64_tr_b16 v[110:111], v11 offset:4608
    v_mfma_f32_32x32x16_bf16 v[52:67], v[140:143], v[136:139], v[52:67]
    ds_read_b128 v[100:103], v10 offset:0
    v_mfma_f32_32x32x16_bf16 v[36:51], v[144:147], v[132:135], v[36:51]
    ds_read_b128 v[104:107], v10 offset:4096
    ds_read_b64_tr_b16 v[112:113], v11 offset:4352
    v_mfma_f32_32x32x16_bf16 v[68:83], v[144:147], v[136:139], v[68:83]
    ds_read_b64_tr_b16 v[114:115], v11 offset:4864
    s_branch qkv_cloopQK
qkv_cdoneQK:
    s_lshl_b32 s36, s27, 8
    s_add_u32 s36, s36, 131072
    v_lshl_add_u32 v2, v6, 2, s36
    s_lshl_b32 s36, s28, 8
    s_add_u32 s36, s36, 132096
    v_lshl_add_u32 v3, v5, 4, s36
    ds_read_b32 v148, v2 offset:0
    ds_read_b32 v150, v2 offset:512
    ds_read_b32 v149, v2 offset:128
    ds_read_b32 v151, v2 offset:640
    ds_read_b128 v[84:87], v3 offset:0
    ds_read_b128 v[88:91], v3 offset:32
    ds_read_b128 v[92:95], v3 offset:64
    ds_read_b128 v[96:99], v3 offset:96
    ds_read_b128 v[100:103], v3 offset:128
    ds_read_b128 v[104:107], v3 offset:160
    ds_read_b128 v[108:111], v3 offset:192
    ds_read_b128 v[112:115], v3 offset:224
    v_mfma_f32_32x32x16_bf16 v[36:51], v[128:131], v[116:119], v[36:51]
    v_mfma_f32_32x32x16_bf16 v[68:83], v[128:131], v[120:123], v[68:83]
    v_mfma_f32_32x32x16_bf16 v[20:35], v[140:143], v[132:135], v[20:35]
    v_mfma_f32_32x32x16_bf16 v[52:67], v[140:143], v[136:139], v[52:67]
    v_mfma_f32_32x32x16_bf16 v[36:51], v[144:147], v[132:135], v[36:51]
    v_mfma_f32_32x32x16_bf16 v[68:83], v[144:147], v[136:139], v[68:83]
    s_waitcnt lgkmcnt(0)
    s_nop 7
    s_mul_i32 s36, s45, 205
    s_lshr_b32 s36, s36, 10
    s_mul_i32 s37, s36, 5
    s_sub_u32 s35, s45, s37
    s_mul_i32 s36, s36, s42
    s_lshl_b32 s36, s36, 1
    s_add_u32 s43, s43, s36
    s_add_u32 s44, s44, s36
    s_cmp_eq_u32 s35, 1
    s_cbranch_scc1 qkv_qs_1
    s_cmp_eq_u32 s35, 2
    s_cbranch_scc1 qkv_qs_2
    s_cmp_eq_u32 s35, 3
    s_cbranch_scc1 qkv_qs_3
    s_cmp_eq_u32 s35, 4
    s_cbranch_scc1 qkv_qs_4
    v_pk_fma_f32 v[20:21], v[150:151], v[84:85], v[20:21] op_sel:[0,0,0] op_sel_hi:[0,1,1] neg_lo:[1,0,0] neg_hi:[1,0,0]
    v_pk_fma_f32 v[22:23], v[150:151], v[86:87], v[22:23] op_sel:[0,0,0] op_sel_hi:[0,1,1] neg_lo:[1,0,0] neg_hi:[1,0,0]
    v_pk_fma_f32 v[24:25], v[150:151], v[88:89], v[24:25] op_sel:[0,0,0] op_sel_hi:[0,1,1] neg_lo:[1,0,0] neg_hi:[1,0,0]
    v_pk_fma_f32 v[26:27], v[150:151], v[90:91], v[26:27] op_sel:[0,0,0] op_sel_hi:[0,1,1] neg_lo:[1,0,0] neg_hi:[1,0,0]
    v_pk_fma_f32 v[28:29], v[150:151], v[92:93], v[28:29] op_sel:[0,0,0] op_sel_hi:[0,1,1] neg_lo:[1,0,0] neg_hi:[1,0,0]
    v_pk_fma_f32 v[30:31], v[150:151], v[94:95], v[30:31] op_sel:[0,0,0] op_sel_hi:[0,1,1] neg_lo:[1,0,0] neg_hi:[1,0,0]
    v_pk_fma_f32 v[32:33], v[150:151], v[96:97], v[32:33] op_sel:[0,0,0] op_sel_hi:[0,1,1] neg_lo:[1,0,0] neg_hi:[1,0,0]
    v_pk_fma_f32 v[34:35], v[150:151], v[98:99], v[34:35] op_sel:[0,0,0] op_sel_hi:[0,1,1] neg_lo:[1,0,0] neg_hi:[1,0,0]
    v_pk_mul_f32 v[20:21], v[148:149], v[20:21] op_sel:[0,0] op_sel_hi:[0,1]
    v_pk_mul_f32 v[22:23], v[148:149], v[22:23] op_sel:[0,0] op_sel_hi:[0,1]
    v_pk_mul_f32 v[24:25], v[148:149], v[24:25] op_sel:[0,0] op_sel_hi:[0,1]
    v_pk_mul_f32 v[26:27], v[148:149], v[26:27] op_sel:[0,0] op_sel_hi:[0,1]
    v_pk_mul_f32 v[28:29], v[148:149], v[28:29] op_sel:[0,0] op_sel_hi:[0,1]
    v_pk_mul_f32 v[30:31], v[148:149], v[30:31] op_sel:[0,0] op_sel_hi:[0,1]
    v_pk_mul_f32 v[32:33], v[148:149], v[32:33] op_sel:[0,0] op_sel_hi:[0,1]
    v_pk_mul_f32 v[34:35], v[148:149], v[34:35] op_sel:[0,0] op_sel_hi:[0,1]
    v_cvt_pk_bf16_f32 v116, v20, v21
    v_cvt_pk_bf16_f32 v117, v22, v23
    v_cvt_pk_bf16_f32 v118, v24, v25
    v_cvt_pk_bf16_f32 v119, v26, v27
    v_cvt_pk_bf16_f32 v120, v28, v29
    v_cvt_pk_bf16_f32 v121, v30, v31
    v_cvt_pk_bf16_f32 v122, v32, v33
    v_cvt_pk_bf16_f32 v123, v34, v35
    v_pk_fma_f32 v[52:53], v[150:151], v[84:85], v[52:53] op_sel:[1,0,0] op_sel_hi:[1,1,1] neg_lo:[1,0,0] neg_hi:[1,0,0]
    v_pk_fma_f32 v[54:55], v[150:151], v[86:87], v[54:55] op_sel:[1,0,0] op_sel_hi:[1,1,1] neg_lo:[1,0,0] neg_hi:[1,0,0]
    v_pk_fma_f32 v[56:57], v[150:151], v[88:89], v[56:57] op_sel:[1,0,0] op_sel_hi:[1,1,1] neg_lo:[1,0,0] neg_hi:[1,0,0]
    v_pk_fma_f32 v[58:59], v[150:151], v[90:91], v[58:59] op_sel:[1,0,0] op_sel_hi:[1,1,1] neg_lo:[1,0,0] neg_hi:[1,0,0]
    v_pk_fma_f32 v[60:61], v[150:151], v[92:93], v[60:61] op_sel:[1,0,0] op_sel_hi:[1,1,1] neg_lo:[1,0,0] neg_hi:[1,0,0]
    v_pk_fma_f32 v[62:63], v[150:151], v[94:95], v[62:63] op_sel:[1,0,0] op_sel_hi:[1,1,1] neg_lo:[1,0,0] neg_hi:[1,0,0]
    v_pk_fma_f32 v[64:65], v[150:151], v[96:97], v[64:65] op_sel:[1,0,0] op_sel_hi:[1,1,1] neg_lo:[1,0,0] neg_hi:[1,0,0]
    v_pk_fma_f32 v[66:67], v[150:151], v[98:99], v[66:67] op_sel:[1,0,0] op_sel_hi:[1,1,1] neg_lo:[1,0,0] neg_hi:[1,0,0]
    v_pk_mul_f32 v[52:53], v[148:149], v[52:53] op_sel:[1,0] op_sel_hi:[1,1]
    v_pk_mul_f32 v[54:55], v[148:149], v[54:55] op_sel:[1,0] op_sel_hi:[1,1]
    v_pk_mul_f32 v[56:57], v[148:149], v[56:57] op_sel:[1,0] op_sel_hi:[1,1]
    v_pk_mul_f32 v[58:59], v[148:149], v[58:59] op_sel:[1,0] op_sel_hi:[1,1]
    v_pk_mul_f32 v[60:61], v[148:149], v[60:61] op_sel:[1,0] op_sel_hi:[1,1]
    v_pk_mul_f32 v[62:63], v[148:149], v[62:63] op_sel:[1,0] op_sel_hi:[1,1]
    v_pk_mul_f32 v[64:65], v[148:149], v[64:65] op_sel:[1,0] op_sel_hi:[1,1]
    v_pk_mul_f32 v[66:67], v[148:149], v[66:67] op_sel:[1,0] op_sel_hi:[1,1]
    v_cvt_pk_bf16_f32 v132, v52, v53
    v_cvt_pk_bf16_f32 v133, v54, v55
    v_cvt_pk_bf16_f32 v134, v56, v57
    v_cvt_pk_bf16_f32 v135, v58, v59
    v_cvt_pk_bf16_f32 v136, v60, v61
    v_cvt_pk_bf16_f32 v137, v62, v63
    v_cvt_pk_bf16_f32 v138, v64, v65
    v_cvt_pk_bf16_f32 v139, v66, v67
    s_mul_i32 s36, s42, 0
    s_add_u32 s37, s43, s36
    v_permlane32_swap_b32 v116, v118
    v_permlane32_swap_b32 v117, v119
    buffer_store_dwordx4 v[116:119], v14, s[12:15], s37 offen sc1
    s_add_u32 s37, s44, s36
    v_permlane32_swap_b32 v132, v134
    v_permlane32_swap_b32 v133, v135
    buffer_store_dwordx4 v[132:135], v14, s[12:15], s37 offen sc1
    s_mul_i32 s36, s42, 0
    s_add_u32 s37, s43, s36
    buffer_store_dwordx2 v[120:121], v13, s[12:15], s37 offen offset:1024 sc1
    s_add_u32 s37, s44, s36
    buffer_store_dwordx2 v[136:137], v13, s[12:15], s37 offen offset:1024 sc1
    v_pk_fma_f32 v[36:37], v[150:151], v[100:101], v[36:37] op_sel:[0,0,0] op_sel_hi:[0,1,1] neg_lo:[1,0,0] neg_hi:[1,0,0]
    v_pk_fma_f32 v[38:39], v[150:151], v[102:103], v[38:39] op_sel:[0,0,0] op_sel_hi:[0,1,1] neg_lo:[1,0,0] neg_hi:[1,0,0]
    v_pk_fma_f32 v[40:41], v[150:151], v[104:105], v[40:41] op_sel:[0,0,0] op_sel_hi:[0,1,1] neg_lo:[1,0,0] neg_hi:[1,0,0]
    v_pk_fma_f32 v[42:43], v[150:151], v[106:107], v[42:43] op_sel:[0,0,0] op_sel_hi:[0,1,1] neg_lo:[1,0,0] neg_hi:[1,0,0]
    v_pk_fma_f32 v[44:45], v[150:151], v[108:109], v[44:45] op_sel:[0,0,0] op_sel_hi:[0,1,1] neg_lo:[1,0,0] neg_hi:[1,0,0]
    v_pk_fma_f32 v[46:47], v[150:151], v[110:111], v[46:47] op_sel:[0,0,0] op_sel_hi:[0,1,1] neg_lo:[1,0,0] neg_hi:[1,0,0]
    v_pk_fma_f32 v[48:49], v[150:151], v[112:113], v[48:49] op_sel:[0,0,0] op_sel_hi:[0,1,1] neg_lo:[1,0,0] neg_hi:[1,0,0]
    v_pk_fma_f32 v[50:51], v[150:151], v[114:115], v[50:51] op_sel:[0,0,0] op_sel_hi:[0,1,1] neg_lo:[1,0,0] neg_hi:[1,0,0]
    v_pk_mul_f32 v[36:37], v[148:149], v[36:37] op_sel:[0,0] op_sel_hi:[0,1]
    v_pk_mul_f32 v[38:39], v[148:149], v[38:39] op_sel:[0,0] op_sel_hi:[0,1]
    v_pk_mul_f32 v[40:41], v[148:149], v[40:41] op_sel:[0,0] op_sel_hi:[0,1]
    v_pk_mul_f32 v[42:43], v[148:149], v[42:43] op_sel:[0,0] op_sel_hi:[0,1]
    v_pk_mul_f32 v[44:45], v[148:149], v[44:45] op_sel:[0,0] op_sel_hi:[0,1]
    v_pk_mul_f32 v[46:47], v[148:149], v[46:47] op_sel:[0,0] op_sel_hi:[0,1]
    v_pk_mul_f32 v[48:49], v[148:149], v[48:49] op_sel:[0,0] op_sel_hi:[0,1]
    v_pk_mul_f32 v[50:51], v[148:149], v[50:51] op_sel:[0,0] op_sel_hi:[0,1]
    v_cvt_pk_bf16_f32 v124, v36, v37
    v_cvt_pk_bf16_f32 v125, v38, v39
    v_cvt_pk_bf16_f32 v126, v40, v41
    v_cvt_pk_bf16_f32 v127, v42, v43
    v_cvt_pk_bf16_f32 v128, v44, v45
    v_cvt_pk_bf16_f32 v129, v46, v47
    v_cvt_pk_bf16_f32 v130, v48, v49
    v_cvt_pk_bf16_f32 v131, v50, v51
    v_pk_fma_f32 v[68:69], v[150:151], v[100:101], v[68:69] op_sel:[1,0,0] op_sel_hi:[1,1,1] neg_lo:[1,0,0] neg_hi:[1,0,0]
    v_pk_fma_f32 v[70:71], v[150:151], v[102:103], v[70:71] op_sel:[1,0,0] op_sel_hi:[1,1,1] neg_lo:[1,0,0] neg_hi:[1,0,0]
    v_pk_fma_f32 v[72:73], v[150:151], v[104:105], v[72:73] op_sel:[1,0,0] op_sel_hi:[1,1,1] neg_lo:[1,0,0] neg_hi:[1,0,0]
    v_pk_fma_f32 v[74:75], v[150:151], v[106:107], v[74:75] op_sel:[1,0,0] op_sel_hi:[1,1,1] neg_lo:[1,0,0] neg_hi:[1,0,0]
    v_pk_fma_f32 v[76:77], v[150:151], v[108:109], v[76:77] op_sel:[1,0,0] op_sel_hi:[1,1,1] neg_lo:[1,0,0] neg_hi:[1,0,0]
    v_pk_fma_f32 v[78:79], v[150:151], v[110:111], v[78:79] op_sel:[1,0,0] op_sel_hi:[1,1,1] neg_lo:[1,0,0] neg_hi:[1,0,0]
    v_pk_fma_f32 v[80:81], v[150:151], v[112:113], v[80:81] op_sel:[1,0,0] op_sel_hi:[1,1,1] neg_lo:[1,0,0] neg_hi:[1,0,0]
    v_pk_fma_f32 v[82:83], v[150:151], v[114:115], v[82:83] op_sel:[1,0,0] op_sel_hi:[1,1,1] neg_lo:[1,0,0] neg_hi:[1,0,0]
    v_pk_mul_f32 v[68:69], v[148:149], v[68:69] op_sel:[1,0] op_sel_hi:[1,1]
    v_pk_mul_f32 v[70:71], v[148:149], v[70:71] op_sel:[1,0] op_sel_hi:[1,1]
    v_pk_mul_f32 v[72:73], v[148:149], v[72:73] op_sel:[1,0] op_sel_hi:[1,1]
    v_pk_mul_f32 v[74:75], v[148:149], v[74:75] op_sel:[1,0] op_sel_hi:[1,1]
    v_pk_mul_f32 v[76:77], v[148:149], v[76:77] op_sel:[1,0] op_sel_hi:[1,1]
    v_pk_mul_f32 v[78:79], v[148:149], v[78:79] op_sel:[1,0] op_sel_hi:[1,1]
    v_pk_mul_f32 v[80:81], v[148:149], v[80:81] op_sel:[1,0] op_sel_hi:[1,1]
    v_pk_mul_f32 v[82:83], v[148:149], v[82:83] op_sel:[1,0] op_sel_hi:[1,1]
    v_cvt_pk_bf16_f32 v140, v68, v69
    v_cvt_pk_bf16_f32 v141, v70, v71
    v_cvt_pk_bf16_f32 v142, v72, v73
    v_cvt_pk_bf16_f32 v143, v74, v75
    v_cvt_pk_bf16_f32 v144, v76, v77
    v_cvt_pk_bf16_f32 v145, v78, v79
    v_cvt_pk_bf16_f32 v146, v80, v81
    v_cvt_pk_bf16_f32 v147, v82, v83
    s_mul_i32 s36, s42, 1
    s_add_u32 s37, s43, s36
    v_permlane32_swap_b32 v122, v124
    v_permlane32_swap_b32 v123, v125
    buffer_store_dwordx4 v[122:125], v14, s[12:15], s37 offen sc1
    s_add_u32 s37, s44, s36
    v_permlane32_swap_b32 v138, v140
    v_permlane32_swap_b32 v139, v141
    buffer_store_dwordx4 v[138:141], v14, s[12:15], s37 offen sc1
    s_mul_i32 s36, s42, 2
    s_add_u32 s37, s43, s36
    v_permlane32_swap_b32 v126, v128
    v_permlane32_swap_b32 v127, v129
    buffer_store_dwordx4 v[126:129], v14, s[12:15], s37 offen sc1
    s_add_u32 s37, s44, s36
    v_permlane32_swap_b32 v142, v144
    v_permlane32_swap_b32 v143, v145
    buffer_store_dwordx4 v[142:145], v14, s[12:15], s37 offen sc1
    s_mul_i32 s36, s42, 2
    s_add_u32 s37, s43, s36
    buffer_store_dwordx2 v[130:131], v13, s[12:15], s37 offen offset:1024 sc1
    s_add_u32 s37, s44, s36
    buffer_store_dwordx2 v[146:147], v13, s[12:15], s37 offen offset:1024 sc1
    s_branch qkv_done
qkv_qs_1:
    v_pk_fma_f32 v[20:21], v[150:151], v[84:85], v[20:21] op_sel:[0,0,0] op_sel_hi:[0,1,1] neg_lo:[1,0,0] neg_hi:[1,0,0]
    v_pk_fma_f32 v[22:23], v[150:151], v[86:87], v[22:23] op_sel:[0,0,0] op_sel_hi:[0,1,1] neg_lo:[1,0,0] neg_hi:[1,0,0]
    v_pk_fma_f32 v[24:25], v[150:151], v[88:89], v[24:25] op_sel:[0,0,0] op_sel_hi:[0,1,1] neg_lo:[1,0,0] neg_hi:[1,0,0]
    v_pk_fma_f32 v[26:27], v[150:151], v[90:91], v[26:27] op_sel:[0,0,0] op_sel_hi:[0,1,1] neg_lo:[1,0,0] neg_hi:[1,0,0]
    v_pk_fma_f32 v[28:29], v[150:151], v[92:93], v[28:29] op_sel:[0,0,0] op_sel_hi:[0,1,1] neg_lo:[1,0,0] neg_hi:[1,0,0]
    v_pk_fma_f32 v[30:31], v[150:151], v[94:95], v[30:31] op_sel:[0,0,0] op_sel_hi:[0,1,1] neg_lo:[1,0,0] neg_hi:[1,0,0]
    v_pk_fma_f32 v[32:33], v[150:151], v[96:97], v[32:33] op_sel:[0,0,0] op_sel_hi:[0,1,1] neg_lo:[1,0,0] neg_hi:[1,0,0]
    v_pk_fma_f32 v[34:35], v[150:151], v[98:99], v[34:35] op_sel:[0,0,0] op_sel_hi:[0,1,1] neg_lo:[1,0,0] neg_hi:[1,0,0]
    v_pk_mul_f32 v[20:21], v[148:149], v[20:21] op_sel:[0,0] op_sel_hi:[0,1]
    v_pk_mul_f32 v[22:23], v[148:149], v[22:23] op_sel:[0,0] op_sel_hi:[0,1]
    v_pk_mul_f32 v[24:25], v[148:149], v[24:25] op_sel:[0,0] op_sel_hi:[0,1]
    v_pk_mul_f32 v[26:27], v[148:149], v[26:27] op_sel:[0,0] op_sel_hi:[0,1]
    v_pk_mul_f32 v[28:29], v[148:149], v[28:29] op_sel:[0,0] op_sel_hi:[0,1]
    v_pk_mul_f32 v[30:31], v[148:149], v[30:31] op_sel:[0,0] op_sel_hi:[0,1]
    v_pk_mul_f32 v[32:33], v[148:149], v[32:33] op_sel:[0,0] op_sel_hi:[0,1]
    v_pk_mul_f32 v[34:35], v[148:149], v[34:35] op_sel:[0,0] op_sel_hi:[0,1]
    v_cvt_pk_bf16_f32 v116, v20, v21
    v_cvt_pk_bf16_f32 v117, v22, v23
    v_cvt_pk_bf16_f32 v118, v24, v25
    v_cvt_pk_bf16_f32 v119, v26, v27
    v_cvt_pk_bf16_f32 v120, v28, v29
    v_cvt_pk_bf16_f32 v121, v30, v31
    v_cvt_pk_bf16_f32 v122, v32, v33
    v_cvt_pk_bf16_f32 v123, v34, v35
    v_pk_fma_f32 v[52:53], v[150:151], v[84:85], v[52:53] op_sel:[1,0,0] op_sel_hi:[1,1,1] neg_lo:[1,0,0] neg_hi:[1,0,0]
    v_pk_fma_f32 v[54:55], v[150:151], v[86:87], v[54:55] op_sel:[1,0,0] op_sel_hi:[1,1,1] neg_lo:[1,0,0] neg_hi:[1,0,0]
    v_pk_fma_f32 v[56:57], v[150:151], v[88:89], v[56:57] op_sel:[1,0,0] op_sel_hi:[1,1,1] neg_lo:[1,0,0] neg_hi:[1,0,0]
    v_pk_fma_f32 v[58:59], v[150:151], v[90:91], v[58:59] op_sel:[1,0,0] op_sel_hi:[1,1,1] neg_lo:[1,0,0] neg_hi:[1,0,0]
    v_pk_fma_f32 v[60:61], v[150:151], v[92:93], v[60:61] op_sel:[1,0,0] op_sel_hi:[1,1,1] neg_lo:[1,0,0] neg_hi:[1,0,0]
    v_pk_fma_f32 v[62:63], v[150:151], v[94:95], v[62:63] op_sel:[1,0,0] op_sel_hi:[1,1,1] neg_lo:[1,0,0] neg_hi:[1,0,0]
    v_pk_fma_f32 v[64:65], v[150:151], v[96:97], v[64:65] op_sel:[1,0,0] op_sel_hi:[1,1,1] neg_lo:[1,0,0] neg_hi:[1,0,0]
    v_pk_fma_f32 v[66:67], v[150:151], v[98:99], v[66:67] op_sel:[1,0,0] op_sel_hi:[1,1,1] neg_lo:[1,0,0] neg_hi:[1,0,0]
    v_pk_mul_f32 v[52:53], v[148:149], v[52:53] op_sel:[1,0] op_sel_hi:[1,1]
    v_pk_mul_f32 v[54:55], v[148:149], v[54:55] op_sel:[1,0] op_sel_hi:[1,1]
    v_pk_mul_f32 v[56:57], v[148:149], v[56:57] op_sel:[1,0] op_sel_hi:[1,1]
    v_pk_mul_f32 v[58:59], v[148:149], v[58:59] op_sel:[1,0] op_sel_hi:[1,1]
    v_pk_mul_f32 v[60:61], v[148:149], v[60:61] op_sel:[1,0] op_sel_hi:[1,1]
    v_pk_mul_f32 v[62:63], v[148:149], v[62:63] op_sel:[1,0] op_sel_hi:[1,1]
    v_pk_mul_f32 v[64:65], v[148:149], v[64:65] op_sel:[1,0] op_sel_hi:[1,1]
    v_pk_mul_f32 v[66:67], v[148:149], v[66:67] op_sel:[1,0] op_sel_hi:[1,1]
    v_cvt_pk_bf16_f32 v132, v52, v53
    v_cvt_pk_bf16_f32 v133, v54, v55
    v_cvt_pk_bf16_f32 v134, v56, v57
    v_cvt_pk_bf16_f32 v135, v58, v59
    v_cvt_pk_bf16_f32 v136, v60, v61
    v_cvt_pk_bf16_f32 v137, v62, v63
    v_cvt_pk_bf16_f32 v138, v64, v65
    v_cvt_pk_bf16_f32 v139, v66, v67
    s_mul_i32 s36, s42, 0
    s_add_u32 s37, s43, s36
    v_mov_b32 v152, v116
    v_mov_b32 v153, v117
    v_mov_b32 v154, v116
    v_mov_b32 v155, v117
    s_nop 1
    v_permlane32_swap_b32 v152, v154
    v_permlane32_swap_b32 v153, v155
    buffer_store_dwordx4 v[152:155], v12, s[12:15], s37 offen offset:512 sc1
    s_add_u32 s37, s44, s36
    v_mov_b32 v160, v132
    v_mov_b32 v161, v133
    v_mov_b32 v162, v132
    v_mov_b32 v163, v133
    s_nop 1
    v_permlane32_swap_b32 v160, v162
    v_permlane32_swap_b32 v161, v163
    buffer_store_dwordx4 v[160:163], v12, s[12:15], s37 offen offset:512 sc1
    s_mul_i32 s36, s42, 0
    s_add_u32 s37, s43, s36
    buffer_store_dwordx2 v[118:119], v13, s[12:15], s37 offen offset:1024 sc1
    s_add_u32 s37, s44, s36
    buffer_store_dwordx2 v[134:135], v13, s[12:15], s37 offen offset:1024 sc1
    s_mul_i32 s36, s42, 1
    s_add_u32 s37, s43, s36
    v_permlane32_swap_b32 v120, v122
    v_permlane32_swap_b32 v121, v123
    buffer_store_dwordx4 v[120:123], v14, s[12:15], s37 offen sc1
    s_add_u32 s37, s44, s36
    v_permlane32_swap_b32 v136, v138
    v_permlane32_swap_b32 v137, v139
    buffer_store_dwordx4 v[136:139], v14, s[12:15], s37 offen sc1
    v_pk_fma_f32 v[36:37], v[150:151], v[100:101], v[36:37] op_sel:[0,0,0] op_sel_hi:[0,1,1] neg_lo:[1,0,0] neg_hi:[1,0,0]
    v_pk_fma_f32 v[38:39], v[150:151], v[102:103], v[38:39] op_sel:[0,0,0] op_sel_hi:[0,1,1] neg_lo:[1,0,0] neg_hi:[1,0,0]
    v_pk_fma_f32 v[40:41], v[150:151], v[104:105], v[40:41] op_sel:[0,0,0] op_sel_hi:[0,1,1] neg_lo:[1,0,0] neg_hi:[1,0,0]
    v_pk_fma_f32 v[42:43], v[150:151], v[106:107], v[42:43] op_sel:[0,0,0] op_sel_hi:[0,1,1] neg_lo:[1,0,0] neg_hi:[1,0,0]
    v_pk_fma_f32 v[44:45], v[150:151], v[108:109], v[44:45] op_sel:[0,0,0] op_sel_hi:[0,1,1] neg_lo:[1,0,0] neg_hi:[1,0,0]
    v_pk_fma_f32 v[46:47], v[150:151], v[110:111], v[46:47] op_sel:[0,0,0] op_sel_hi:[0,1,1] neg_lo:[1,0,0] neg_hi:[1,0,0]
    v_pk_fma_f32 v[48:49], v[150:151], v[112:113], v[48:49] op_sel:[0,0,0] op_sel_hi:[0,1,1] neg_lo:[1,0,0] neg_hi:[1,0,0]
    v_pk_fma_f32 v[50:51], v[150:151], v[114:115], v[50:51] op_sel:[0,0,0] op_sel_hi:[0,1,1] neg_lo:[1,0,0] neg_hi:[1,0,0]
    v_pk_mul_f32 v[36:37], v[148:149], v[36:37] op_sel:[0,0] op_sel_hi:[0,1]
    v_pk_mul_f32 v[38:39], v[148:149], v[38:39] op_sel:[0,0] op_sel_hi:[0,1]
    v_pk_mul_f32 v[40:41], v[148:149], v[40:41] op_sel:[0,0] op_sel_hi:[0,1]
    v_pk_mul_f32 v[42:43], v[148:149], v[42:43] op_sel:[0,0] op_sel_hi:[0,1]
    v_pk_mul_f32 v[44:45], v[148:149], v[44:45] op_sel:[0,0] op_sel_hi:[0,1]
    v_pk_mul_f32 v[46:47], v[148:149], v[46:47] op_sel:[0,0] op_sel_hi:[0,1]
    v_pk_mul_f32 v[48:49], v[148:149], v[48:49] op_sel:[0,0] op_sel_hi:[0,1]
    v_pk_mul_f32 v[50:51], v[148:149], v[50:51] op_sel:[0,0] op_sel_hi:[0,1]
    v_cvt_pk_bf16_f32 v124, v36, v37
    v_cvt_pk_bf16_f32 v125, v38, v39
    v_cvt_pk_bf16_f32 v126, v40, v41
    v_cvt_pk_bf16_f32 v127, v42, v43
    v_cvt_pk_bf16_f32 v128, v44, v45
    v_cvt_pk_bf16_f32 v129, v46, v47
    v_cvt_pk_bf16_f32 v130, v48, v49
    v_cvt_pk_bf16_f32 v131, v50, v51
    v_pk_fma_f32 v[68:69], v[150:151], v[100:101], v[68:69] op_sel:[1,0,0] op_sel_hi:[1,1,1] neg_lo:[1,0,0] neg_hi:[1,0,0]
    v_pk_fma_f32 v[70:71], v[150:151], v[102:103], v[70:71] op_sel:[1,0,0] op_sel_hi:[1,1,1] neg_lo:[1,0,0] neg_hi:[1,0,0]
    v_pk_fma_f32 v[72:73], v[150:151], v[104:105], v[72:73] op_sel:[1,0,0] op_sel_hi:[1,1,1] neg_lo:[1,0,0] neg_hi:[1,0,0]
    v_pk_fma_f32 v[74:75], v[150:151], v[106:107], v[74:75] op_sel:[1,0,0] op_sel_hi:[1,1,1] neg_lo:[1,0,0] neg_hi:[1,0,0]
    v_pk_fma_f32 v[76:77], v[150:151], v[108:109], v[76:77] op_sel:[1,0,0] op_sel_hi:[1,1,1] neg_lo:[1,0,0] neg_hi:[1,0,0]
    v_pk_fma_f32 v[78:79], v[150:151], v[110:111], v[78:79] op_sel:[1,0,0] op_sel_hi:[1,1,1] neg_lo:[1,0,0] neg_hi:[1,0,0]
    v_pk_fma_f32 v[80:81], v[150:151], v[112:113], v[80:81] op_sel:[1,0,0] op_sel_hi:[1,1,1] neg_lo:[1,0,0] neg_hi:[1,0,0]
    v_pk_fma_f32 v[82:83], v[150:151], v[114:115], v[82:83] op_sel:[1,0,0] op_sel_hi:[1,1,1] neg_lo:[1,0,0] neg_hi:[1,0,0]
    v_pk_mul_f32 v[68:69], v[148:149], v[68:69] op_sel:[1,0] op_sel_hi:[1,1]
    v_pk_mul_f32 v[70:71], v[148:149], v[70:71] op_sel:[1,0] op_sel_hi:[1,1]
    v_pk_mul_f32 v[72:73], v[148:149], v[72:73] op_sel:[1,0] op_sel_hi:[1,1]
    v_pk_mul_f32 v[74:75], v[148:149], v[74:75] op_sel:[1,0] op_sel_hi:[1,1]
    v_pk_mul_f32 v[76:77], v[148:149], v[76:77] op_sel:[1,0] op_sel_hi:[1,1]
    v_pk_mul_f32 v[78:79], v[148:149], v[78:79] op_sel:[1,0] op_sel_hi:[1,1]
    v_pk_mul_f32 v[80:81], v[148:149], v[80:81] op_sel:[1,0] op_sel_hi:[1,1]
    v_pk_mul_f32 v[82:83], v[148:149], v[82:83] op_sel:[1,0] op_sel_hi:[1,1]
    v_cvt_pk_bf16_f32 v140, v68, v69
    v_cvt_pk_bf16_f32 v141, v70, v71
    v_cvt_pk_bf16_f32 v142, v72, v73
    v_cvt_pk_bf16_f32 v143, v74, v75
    v_cvt_pk_bf16_f32 v144, v76, v77
    v_cvt_pk_bf16_f32 v145, v78, v79
    v_cvt_pk_bf16_f32 v146, v80, v81
    v_cvt_pk_bf16_f32 v147, v82, v83
    s_mul_i32 s36, s42, 2
    s_add_u32 s37, s43, s36
    v_permlane32_swap_b32 v124, v126
    v_permlane32_swap_b32 v125, v127
    buffer_store_dwordx4 v[124:127], v14, s[12:15], s37 offen sc1
    s_add_u32 s37, s44, s36
    v_permlane32_swap_b32 v140, v142
    v_permlane32_swap_b32 v141, v143
    buffer_store_dwordx4 v[140:143], v14, s[12:15], s37 offen sc1
    s_mul_i32 s36, s42, 2
    s_add_u32 s37, s43, s36
    buffer_store_dwordx2 v[128:129], v13, s[12:15], s37 offen offset:1024 sc1
    s_add_u32 s37, s44, s36
    buffer_store_dwordx2 v[144:145], v13, s[12:15], s37 offen offset:1024 sc1
    s_mul_i32 s36, s42, 3
    s_add_u32 s37, s43, s36
    v_mov_b32 v156, v130
    v_mov_b32 v157, v131
    v_mov_b32 v158, v130
    v_mov_b32 v159, v131
    s_nop 1
    v_permlane32_swap_b32 v156, v158
    v_permlane32_swap_b32 v157, v159
    buffer_store_dwordx4 v[156:159], v12, s[12:15], s37 offen offset:0 sc1
    s_add_u32 s37, s44, s36
    v_mov_b32 v164, v146
    v_mov_b32 v165, v147
    v_mov_b32 v166, v146
    v_mov_b32 v167, v147
    s_nop 1
    v_permlane32_swap_b32 v164, v166
    v_permlane32_swap_b32 v165, v167
    buffer_store_dwordx4 v[164:167], v12, s[12:15], s37 offen offset:0 sc1
    s_branch qkv_done
qkv_qs_2:
    v_pk_fma_f32 v[20:21], v[150:151], v[84:85], v[20:21] op_sel:[0,0,0] op_sel_hi:[0,1,1] neg_lo:[1,0,0] neg_hi:[1,0,0]
    v_pk_fma_f32 v[22:23], v[150:151], v[86:87], v[22:23] op_sel:[0,0,0] op_sel_hi:[0,1,1] neg_lo:[1,0,0] neg_hi:[1,0,0]
    v_pk_fma_f32 v[24:25], v[150:151], v[88:89], v[24:25] op_sel:[0,0,0] op_sel_hi:[0,1,1] neg_lo:[1,0,0] neg_hi:[1,0,0]
    v_pk_fma_f32 v[26:27], v[150:151], v[90:91], v[26:27] op_sel:[0,0,0] op_sel_hi:[0,1,1] neg_lo:[1,0,0] neg_hi:[1,0,0]
    v_pk_fma_f32 v[28:29], v[150:151], v[92:93], v[28:29] op_sel:[0,0,0] op_sel_hi:[0,1,1] neg_lo:[1,0,0] neg_hi:[1,0,0]
    v_pk_fma_f32 v[30:31], v[150:151], v[94:95], v[30:31] op_sel:[0,0,0] op_sel_hi:[0,1,1] neg_lo:[1,0,0] neg_hi:[1,0,0]
    v_pk_fma_f32 v[32:33], v[150:151], v[96:97], v[32:33] op_sel:[0,0,0] op_sel_hi:[0,1,1] neg_lo:[1,0,0] neg_hi:[1,0,0]
    v_pk_fma_f32 v[34:35], v[150:151], v[98:99], v[34:35] op_sel:[0,0,0] op_sel_hi:[0,1,1] neg_lo:[1,0,0] neg_hi:[1,0,0]
    v_pk_mul_f32 v[20:21], v[148:149], v[20:21] op_sel:[0,0] op_sel_hi:[0,1]
    v_pk_mul_f32 v[22:23], v[148:149], v[22:23] op_sel:[0,0] op_sel_hi:[0,1]
    v_pk_mul_f32 v[24:25], v[148:149], v[24:25] op_sel:[0,0] op_sel_hi:[0,1]
    v_pk_mul_f32 v[26:27], v[148:149], v[26:27] op_sel:[0,0] op_sel_hi:[0,1]
    v_pk_mul_f32 v[28:29], v[148:149], v[28:29] op_sel:[0,0] op_sel_hi:[0,1]
    v_pk_mul_f32 v[30:31], v[148:149], v[30:31] op_sel:[0,0] op_sel_hi:[0,1]
    v_pk_mul_f32 v[32:33], v[148:149], v[32:33] op_sel:[0,0] op_sel_hi:[0,1]
    v_pk_mul_f32 v[34:35], v[148:149], v[34:35] op_sel:[0,0] op_sel_hi:[0,1]
    v_cvt_pk_bf16_f32 v116, v20, v21
    v_cvt_pk_bf16_f32 v117, v22, v23
    v_cvt_pk_bf16_f32 v118, v24, v25
    v_cvt_pk_bf16_f32 v119, v26, v27
    v_cvt_pk_bf16_f32 v120, v28, v29
    v_cvt_pk_bf16_f32 v121, v30, v31
    v_cvt_pk_bf16_f32 v122, v32, v33
    v_cvt_pk_bf16_f32 v123, v34, v35
    v_pk_fma_f32 v[52:53], v[150:151], v[84:85], v[52:53] op_sel:[1,0,0] op_sel_hi:[1,1,1] neg_lo:[1,0,0] neg_hi:[1,0,0]
    v_pk_fma_f32 v[54:55], v[150:151], v[86:87], v[54:55] op_sel:[1,0,0] op_sel_hi:[1,1,1] neg_lo:[1,0,0] neg_hi:[1,0,0]
    v_pk_fma_f32 v[56:57], v[150:151], v[88:89], v[56:57] op_sel:[1,0,0] op_sel_hi:[1,1,1] neg_lo:[1,0,0] neg_hi:[1,0,0]
    v_pk_fma_f32 v[58:59], v[150:151], v[90:91], v[58:59] op_sel:[1,0,0] op_sel_hi:[1,1,1] neg_lo:[1,0,0] neg_hi:[1,0,0]
    v_pk_fma_f32 v[60:61], v[150:151], v[92:93], v[60:61] op_sel:[1,0,0] op_sel_hi:[1,1,1] neg_lo:[1,0,0] neg_hi:[1,0,0]
    v_pk_fma_f32 v[62:63], v[150:151], v[94:95], v[62:63] op_sel:[1,0,0] op_sel_hi:[1,1,1] neg_lo:[1,0,0] neg_hi:[1,0,0]
    v_pk_fma_f32 v[64:65], v[150:151], v[96:97], v[64:65] op_sel:[1,0,0] op_sel_hi:[1,1,1] neg_lo:[1,0,0] neg_hi:[1,0,0]
    v_pk_fma_f32 v[66:67], v[150:151], v[98:99], v[66:67] op_sel:[1,0,0] op_sel_hi:[1,1,1] neg_lo:[1,0,0] neg_hi:[1,0,0]
    v_pk_mul_f32 v[52:53], v[148:149], v[52:53] op_sel:[1,0] op_sel_hi:[1,1]
    v_pk_mul_f32 v[54:55], v[148:149], v[54:55] op_sel:[1,0] op_sel_hi:[1,1]
    v_pk_mul_f32 v[56:57], v[148:149], v[56:57] op_sel:[1,0] op_sel_hi:[1,1]
    v_pk_mul_f32 v[58:59], v[148:149], v[58:59] op_sel:[1,0] op_sel_hi:[1,1]
    v_pk_mul_f32 v[60:61], v[148:149], v[60:61] op_sel:[1,0] op_sel_hi:[1,1]
    v_pk_mul_f32 v[62:63], v[148:149], v[62:63] op_sel:[1,0] op_sel_hi:[1,1]
    v_pk_mul_f32 v[64:65], v[148:149], v[64:65] op_sel:[1,0] op_sel_hi:[1,1]
    v_pk_mul_f32 v[66:67], v[148:149], v[66:67] op_sel:[1,0] op_sel_hi:[1,1]
    v_cvt_pk_bf16_f32 v132, v52, v53
    v_cvt_pk_bf16_f32 v133, v54, v55
    v_cvt_pk_bf16_f32 v134, v56, v57
    v_cvt_pk_bf16_f32 v135, v58, v59
    v_cvt_pk_bf16_f32 v136, v60, v61
    v_cvt_pk_bf16_f32 v137, v62, v63
    v_cvt_pk_bf16_f32 v138, v64, v65
    v_cvt_pk_bf16_f32 v139, v66, v67
    s_mul_i32 s36, s42, 0
    s_add_u32 s37, s43, s36
    buffer_store_dwordx2 v[116:117], v13, s[12:15], s37 offen offset:1024 sc1
    s_add_u32 s37, s44, s36
    buffer_store_dwordx2 v[132:133], v13, s[12:15], s37 offen offset:1024 sc1
    s_mul_i32 s36, s42, 1
    s_add_u32 s37, s43, s36
    v_permlane32_swap_b32 v118, v120
    v_permlane32_swap_b32 v119, v121
    buffer_store_dwordx4 v[118:121], v14, s[12:15], s37 offen sc1
    s_add_u32 s37, s44, s36
    v_permlane32_swap_b32 v134, v136
    v_permlane32_swap_b32 v135, v137
    buffer_store_dwordx4 v[134:137], v14, s[12:15], s37 offen sc1
    v_pk_fma_f32 v[36:37], v[150:151], v[100:101], v[36:37] op_sel:[0,0,0] op_sel_hi:[0,1,1] neg_lo:[1,0,0] neg_hi:[1,0,0]
    v_pk_fma_f32 v[38:39], v[150:151], v[102:103], v[38:39] op_sel:[0,0,0] op_sel_hi:[0,1,1] neg_lo:[1,0,0] neg_hi:[1,0,0]
    v_pk_fma_f32 v[40:41], v[150:151], v[104:105], v[40:41] op_sel:[0,0,0] op_sel_hi:[0,1,1] neg_lo:[1,0,0] neg_hi:[1,0,0]
    v_pk_fma_f32 v[42:43], v[150:151], v[106:107], v[42:43] op_sel:[0,0,0] op_sel_hi:[0,1,1] neg_lo:[1,0,0] neg_hi:[1,0,0]
    v_pk_fma_f32 v[44:45], v[150:151], v[108:109], v[44:45] op_sel:[0,0,0] op_sel_hi:[0,1,1] neg_lo:[1,0,0] neg_hi:[1,0,0]
    v_pk_fma_f32 v[46:47], v[150:151], v[110:111], v[46:47] op_sel:[0,0,0] op_sel_hi:[0,1,1] neg_lo:[1,0,0] neg_hi:[1,0,0]
    v_pk_fma_f32 v[48:49], v[150:151], v[112:113], v[48:49] op_sel:[0,0,0] op_sel_hi:[0,1,1] neg_lo:[1,0,0] neg_hi:[1,0,0]
    v_pk_fma_f32 v[50:51], v[150:151], v[114:115], v[50:51] op_sel:[0,0,0] op_sel_hi:[0,1,1] neg_lo:[1,0,0] neg_hi:[1,0,0]
    v_pk_mul_f32 v[36:37], v[148:149], v[36:37] op_sel:[0,0] op_sel_hi:[0,1]
    v_pk_mul_f32 v[38:39], v[148:149], v[38:39] op_sel:[0,0] op_sel_hi:[0,1]
    v_pk_mul_f32 v[40:41], v[148:149], v[40:41] op_sel:[0,0] op_sel_hi:[0,1]
    v_pk_mul_f32 v[42:43], v[148:149], v[42:43] op_sel:[0,0] op_sel_hi:[0,1]
    v_pk_mul_f32 v[44:45], v[148:149], v[44:45] op_sel:[0,0] op_sel_hi:[0,1]
    v_pk_mul_f32 v[46:47], v[148:149], v[46:47] op_sel:[0,0] op_sel_hi:[0,1]
    v_pk_mul_f32 v[48:49], v[148:149], v[48:49] op_sel:[0,0] op_sel_hi:[0,1]
    v_pk_mul_f32 v[50:51], v[148:149], v[50:51] op_sel:[0,0] op_sel_hi:[0,1]
    v_cvt_pk_bf16_f32 v124, v36, v37
    v_cvt_pk_bf16_f32 v125, v38, v39
    v_cvt_pk_bf16_f32 v126, v40, v41
    v_cvt_pk_bf16_f32 v127, v42, v43
    v_cvt_pk_bf16_f32 v128, v44, v45
    v_cvt_pk_bf16_f32 v129, v46, v47
    v_cvt_pk_bf16_f32 v130, v48, v49
    v_cvt_pk_bf16_f32 v131, v50, v51
    v_pk_fma_f32 v[68:69], v[150:151], v[100:101], v[68:69] op_sel:[1,0,0] op_sel_hi:[1,1,1] neg_lo:[1,0,0] neg_hi:[1,0,0]
    v_pk_fma_f32 v[70:71], v[150:151], v[102:103], v[70:71] op_sel:[1,0,0] op_sel_hi:[1,1,1] neg_lo:[1,0,0] neg_hi:[1,0,0]
    v_pk_fma_f32 v[72:73], v[150:151], v[104:105], v[72:73] op_sel:[1,0,0] op_sel_hi:[1,1,1] neg_lo:[1,0,0] neg_hi:[1,0,0]
    v_pk_fma_f32 v[74:75], v[150:151], v[106:107], v[74:75] op_sel:[1,0,0] op_sel_hi:[1,1,1] neg_lo:[1,0,0] neg_hi:[1,0,0]
    v_pk_fma_f32 v[76:77], v[150:151], v[108:109], v[76:77] op_sel:[1,0,0] op_sel_hi:[1,1,1] neg_lo:[1,0,0] neg_hi:[1,0,0]
    v_pk_fma_f32 v[78:79], v[150:151], v[110:111], v[78:79] op_sel:[1,0,0] op_sel_hi:[1,1,1] neg_lo:[1,0,0] neg_hi:[1,0,0]
    v_pk_fma_f32 v[80:81], v[150:151], v[112:113], v[80:81] op_sel:[1,0,0] op_sel_hi:[1,1,1] neg_lo:[1,0,0] neg_hi:[1,0,0]
    v_pk_fma_f32 v[82:83], v[150:151], v[114:115], v[82:83] op_sel:[1,0,0] op_sel_hi:[1,1,1] neg_lo:[1,0,0] neg_hi:[1,0,0]
    v_pk_mul_f32 v[68:69], v[148:149], v[68:69] op_sel:[1,0] op_sel_hi:[1,1]
    v_pk_mul_f32 v[70:71], v[148:149], v[70:71] op_sel:[1,0] op_sel_hi:[1,1]
    v_pk_mul_f32 v[72:73], v[148:149], v[72:73] op_sel:[1,0] op_sel_hi:[1,1]
    v_pk_mul_f32 v[74:75], v[148:149], v[74:75] op_sel:[1,0] op_sel_hi:[1,1]
    v_pk_mul_f32 v[76:77], v[148:149], v[76:77] op_sel:[1,0] op_sel_hi:[1,1]
    v_pk_mul_f32 v[78:79], v[148:149], v[78:79] op_sel:[1,0] op_sel_hi:[1,1]
    v_pk_mul_f32 v[80:81], v[148:149], v[80:81] op_sel:[1,0] op_sel_hi:[1,1]
    v_pk_mul_f32 v[82:83], v[148:149], v[82:83] op_sel:[1,0] op_sel_hi:[1,1]
    v_cvt_pk_bf16_f32 v140, v68, v69
    v_cvt_pk_bf16_f32 v141, v70, v71
    v_cvt_pk_bf16_f32 v142, v72, v73
    v_cvt_pk_bf16_f32 v143, v74, v75
    v_cvt_pk_bf16_f32 v144, v76, v77
    v_cvt_pk_bf16_f32 v145, v78, v79
    v_cvt_pk_bf16_f32 v146, v80, v81
    v_cvt_pk_bf16_f32 v147, v82, v83
    s_mul_i32 s36, s42, 2
    s_add_u32 s37, s43, s36
    v_permlane32_swap_b32 v122, v124
    v_permlane32_swap_b32 v123, v125
    buffer_store_dwordx4 v[122:125], v14, s[12:15], s37 offen sc1
    s_add_u32 s37, s44, s36
    v_permlane32_swap_b32 v138, v140
    v_permlane32_swap_b32 v139, v141
    buffer_store_dwordx4 v[138:141], v14, s[12:15], s37 offen sc1
    s_mul_i32 s36, s42, 2
    s_add_u32 s37, s43, s36
    buffer_store_dwordx2 v[126:127], v13, s[12:15], s37 offen offset:1024 sc1
    s_add_u32 s37, s44, s36
    buffer_store_dwordx2 v[142:143], v13, s[12:15], s37 offen offset:1024 sc1
    s_mul_i32 s36, s42, 3
    s_add_u32 s37, s43, s36
    v_permlane32_swap_b32 v128, v130
    v_permlane32_swap_b32 v129, v131
    buffer_store_dwordx4 v[128:131], v14, s[12:15], s37 offen sc1
    s_add_u32 s37, s44, s36
    v_permlane32_swap_b32 v144, v146
    v_permlane32_swap_b32 v145, v147
    buffer_store_dwordx4 v[144:147], v14, s[12:15], s37 offen sc1
    s_branch qkv_done
qkv_qs_3:
    v_pk_fma_f32 v[20:21], v[150:151], v[84:85], v[20:21] op_sel:[0,0,0] op_sel_hi:[0,1,1] neg_lo:[1,0,0] neg_hi:[1,0,0]
    v_pk_fma_f32 v[22:23], v[150:151], v[86:87], v[22:23] op_sel:[0,0,0] op_sel_hi:[0,1,1] neg_lo:[1,0,0] neg_hi:[1,0,0]
    v_pk_fma_f32 v[24:25], v[150:151], v[88:89], v[24:25] op_sel:[0,0,0] op_sel_hi:[0,1,1] neg_lo:[1,0,0] neg_hi:[1,0,0]
    v_pk_fma_f32 v[26:27], v[150:151], v[90:91], v[26:27] op_sel:[0,0,0] op_sel_hi:[0,1,1] neg_lo:[1,0,0] neg_hi:[1,0,0]
    v_pk_fma_f32 v[28:29], v[150:151], v[92:93], v[28:29] op_sel:[0,0,0] op_sel_hi:[0,1,1] neg_lo:[1,0,0] neg_hi:[1,0,0]
    v_pk_fma_f32 v[30:31], v[150:151], v[94:95], v[30:31] op_sel:[0,0,0] op_sel_hi:[0,1,1] neg_lo:[1,0,0] neg_hi:[1,0,0]
    v_pk_fma_f32 v[32:33], v[150:151], v[96:97], v[32:33] op_sel:[0,0,0] op_sel_hi:[0,1,1] neg_lo:[1,0,0] neg_hi:[1,0,0]
    v_pk_fma_f32 v[34:35], v[150:151], v[98:99], v[34:35] op_sel:[0,0,0] op_sel_hi:[0,1,1] neg_lo:[1,0,0] neg_hi:[1,0,0]
    v_pk_mul_f32 v[20:21], v[148:149], v[20:21] op_sel:[0,0] op_sel_hi:[0,1]
    v_pk_mul_f32 v[22:23], v[148:149], v[22:23] op_sel:[0,0] op_sel_hi:[0,1]
    v_pk_mul_f32 v[24:25], v[148:149], v[24:25] op_sel:[0,0] op_sel_hi:[0,1]
    v_pk_mul_f32 v[26:27], v[148:149], v[26:27] op_sel:[0,0] op_sel_hi:[0,1]
    v_pk_mul_f32 v[28:29], v[148:149], v[28:29] op_sel:[0,0] op_sel_hi:[0,1]
    v_pk_mul_f32 v[30:31], v[148:149], v[30:31] op_sel:[0,0] op_sel_hi:[0,1]
    v_pk_mul_f32 v[32:33], v[148:149], v[32:33] op_sel:[0,0] op_sel_hi:[0,1]
    v_pk_mul_f32 v[34:35], v[148:149], v[34:35] op_sel:[0,0] op_sel_hi:[0,1]
    v_cvt_pk_bf16_f32 v116, v20, v21
    v_cvt_pk_bf16_f32 v117, v22, v23
    v_cvt_pk_bf16_f32 v118, v24, v25
    v_cvt_pk_bf16_f32 v119, v26, v27
    v_cvt_pk_bf16_f32 v120, v28, v29
    v_cvt_pk_bf16_f32 v121, v30, v31
    v_cvt_pk_bf16_f32 v122, v32, v33
    v_cvt_pk_bf16_f32 v123, v34, v35
    v_pk_fma_f32 v[52:53], v[150:151], v[84:85], v[52:53] op_sel:[1,0,0] op_sel_hi:[1,1,1] neg_lo:[1,0,0] neg_hi:[1,0,0]
    v_pk_fma_f32 v[54:55], v[150:151], v[86:87], v[54:55] op_sel:[1,0,0] op_sel_hi:[1,1,1] neg_lo:[1,0,0] neg_hi:[1,0,0]
    v_pk_fma_f32 v[56:57], v[150:151], v[88:89], v[56:57] op_sel:[1,0,0] op_sel_hi:[1,1,1] neg_lo:[1,0,0] neg_hi:[1,0,0]
    v_pk_fma_f32 v[58:59], v[150:151], v[90:91], v[58:59] op_sel:[1,0,0] op_sel_hi:[1,1,1] neg_lo:[1,0,0] neg_hi:[1,0,0]
    v_pk_fma_f32 v[60:61], v[150:151], v[92:93], v[60:61] op_sel:[1,0,0] op_sel_hi:[1,1,1] neg_lo:[1,0,0] neg_hi:[1,0,0]
    v_pk_fma_f32 v[62:63], v[150:151], v[94:95], v[62:63] op_sel:[1,0,0] op_sel_hi:[1,1,1] neg_lo:[1,0,0] neg_hi:[1,0,0]
    v_pk_fma_f32 v[64:65], v[150:151], v[96:97], v[64:65] op_sel:[1,0,0] op_sel_hi:[1,1,1] neg_lo:[1,0,0] neg_hi:[1,0,0]
    v_pk_fma_f32 v[66:67], v[150:151], v[98:99], v[66:67] op_sel:[1,0,0] op_sel_hi:[1,1,1] neg_lo:[1,0,0] neg_hi:[1,0,0]
    v_pk_mul_f32 v[52:53], v[148:149], v[52:53] op_sel:[1,0] op_sel_hi:[1,1]
    v_pk_mul_f32 v[54:55], v[148:149], v[54:55] op_sel:[1,0] op_sel_hi:[1,1]
    v_pk_mul_f32 v[56:57], v[148:149], v[56:57] op_sel:[1,0] op_sel_hi:[1,1]
    v_pk_mul_f32 v[58:59], v[148:149], v[58:59] op_sel:[1,0] op_sel_hi:[1,1]
    v_pk_mul_f32 v[60:61], v[148:149], v[60:61] op_sel:[1,0] op_sel_hi:[1,1]
    v_pk_mul_f32 v[62:63], v[148:149], v[62:63] op_sel:[1,0] op_sel_hi:[1,1]
    v_pk_mul_f32 v[64:65], v[148:149], v[64:65] op_sel:[1,0] op_sel_hi:[1,1]
    v_pk_mul_f32 v[66:67], v[148:149], v[66:67] op_sel:[1,0] op_sel_hi:[1,1]
    v_cvt_pk_bf16_f32 v132, v52, v53
    v_cvt_pk_bf16_f32 v133, v54, v55
    v_cvt_pk_bf16_f32 v134, v56, v57
    v_cvt_pk_bf16_f32 v135, v58, v59
    v_cvt_pk_bf16_f32 v136, v60, v61
    v_cvt_pk_bf16_f32 v137, v62, v63
    v_cvt_pk_bf16_f32 v138, v64, v65
    v_cvt_pk_bf16_f32 v139, v66, v67
    s_mul_i32 s36, s42, 1
    s_add_u32 s37, s43, s36
    v_permlane32_swap_b32 v116, v118
    v_permlane32_swap_b32 v117, v119
    buffer_store_dwordx4 v[116:119], v14, s[12:15], s37 offen sc1
    s_add_u32 s37, s44, s36
    v_permlane32_swap_b32 v132, v134
    v_permlane32_swap_b32 v133, v135
    buffer_store_dwordx4 v[132:135], v14, s[12:15], s37 offen sc1
    s_mul_i32 s36, s42, 2
    s_add_u32 s37, s43, s36
    v_permlane32_swap_b32 v120, v122
    v_permlane32_swap_b32 v121, v123
    buffer_store_dwordx4 v[120:123], v14, s[12:15], s37 offen sc1
    s_add_u32 s37, s44, s36
    v_permlane32_swap_b32 v136, v138
    v_permlane32_swap_b32 v137, v139
    buffer_store_dwordx4 v[136:139], v14, s[12:15], s37 offen sc1
    v_pk_fma_f32 v[36:37], v[150:151], v[100:101], v[36:37] op_sel:[0,0,0] op_sel_hi:[0,1,1] neg_lo:[1,0,0] neg_hi:[1,0,0]
    v_pk_fma_f32 v[38:39], v[150:151], v[102:103], v[38:39] op_sel:[0,0,0] op_sel_hi:[0,1,1] neg_lo:[1,0,0] neg_hi:[1,0,0]
    v_pk_fma_f32 v[40:41], v[150:151], v[104:105], v[40:41] op_sel:[0,0,0] op_sel_hi:[0,1,1] neg_lo:[1,0,0] neg_hi:[1,0,0]
    v_pk_fma_f32 v[42:43], v[150:151], v[106:107], v[42:43] op_sel:[0,0,0] op_sel_hi:[0,1,1] neg_lo:[1,0,0] neg_hi:[1,0,0]
    v_pk_fma_f32 v[44:45], v[150:151], v[108:109], v[44:45] op_sel:[0,0,0] op_sel_hi:[0,1,1] neg_lo:[1,0,0] neg_hi:[1,0,0]
    v_pk_fma_f32 v[46:47], v[150:151], v[110:111], v[46:47] op_sel:[0,0,0] op_sel_hi:[0,1,1] neg_lo:[1,0,0] neg_hi:[1,0,0]
    v_pk_fma_f32 v[48:49], v[150:151], v[112:113], v[48:49] op_sel:[0,0,0] op_sel_hi:[0,1,1] neg_lo:[1,0,0] neg_hi:[1,0,0]
    v_pk_fma_f32 v[50:51], v[150:151], v[114:115], v[50:51] op_sel:[0,0,0] op_sel_hi:[0,1,1] neg_lo:[1,0,0] neg_hi:[1,0,0]
    v_pk_mul_f32 v[36:37], v[148:149], v[36:37] op_sel:[0,0] op_sel_hi:[0,1]
    v_pk_mul_f32 v[38:39], v[148:149], v[38:39] op_sel:[0,0] op_sel_hi:[0,1]
    v_pk_mul_f32 v[40:41], v[148:149], v[40:41] op_sel:[0,0] op_sel_hi:[0,1]
    v_pk_mul_f32 v[42:43], v[148:149], v[42:43] op_sel:[0,0] op_sel_hi:[0,1]
    v_pk_mul_f32 v[44:45], v[148:149], v[44:45] op_sel:[0,0] op_sel_hi:[0,1]
    v_pk_mul_f32 v[46:47], v[148:149], v[46:47] op_sel:[0,0] op_sel_hi:[0,1]
    v_pk_mul_f32 v[48:49], v[148:149], v[48:49] op_sel:[0,0] op_sel_hi:[0,1]
    v_pk_mul_f32 v[50:51], v[148:149], v[50:51] op_sel:[0,0] op_sel_hi:[0,1]
    v_cvt_pk_bf16_f32 v124, v36, v37
    v_cvt_pk_bf16_f32 v125, v38, v39
    v_cvt_pk_bf16_f32 v126, v40, v41
    v_cvt_pk_bf16_f32 v127, v42, v43
    v_cvt_pk_bf16_f32 v128, v44, v45
    v_cvt_pk_bf16_f32 v129, v46, v47
    v_cvt_pk_bf16_f32 v130, v48, v49
    v_cvt_pk_bf16_f32 v131, v50, v51
    v_pk_fma_f32 v[68:69], v[150:151], v[100:101], v[68:69] op_sel:[1,0,0] op_sel_hi:[1,1,1] neg_lo:[1,0,0] neg_hi:[1,0,0]
    v_pk_fma_f32 v[70:71], v[150:151], v[102:103], v[70:71] op_sel:[1,0,0] op_sel_hi:[1,1,1] neg_lo:[1,0,0] neg_hi:[1,0,0]
    v_pk_fma_f32 v[72:73], v[150:151], v[104:105], v[72:73] op_sel:[1,0,0] op_sel_hi:[1,1,1] neg_lo:[1,0,0] neg_hi:[1,0,0]
    v_pk_fma_f32 v[74:75], v[150:151], v[106:107], v[74:75] op_sel:[1,0,0] op_sel_hi:[1,1,1] neg_lo:[1,0,0] neg_hi:[1,0,0]
    v_pk_fma_f32 v[76:77], v[150:151], v[108:109], v[76:77] op_sel:[1,0,0] op_sel_hi:[1,1,1] neg_lo:[1,0,0] neg_hi:[1,0,0]
    v_pk_fma_f32 v[78:79], v[150:151], v[110:111], v[78:79] op_sel:[1,0,0] op_sel_hi:[1,1,1] neg_lo:[1,0,0] neg_hi:[1,0,0]
    v_pk_fma_f32 v[80:81], v[150:151], v[112:113], v[80:81] op_sel:[1,0,0] op_sel_hi:[1,1,1] neg_lo:[1,0,0] neg_hi:[1,0,0]
    v_pk_fma_f32 v[82:83], v[150:151], v[114:115], v[82:83] op_sel:[1,0,0] op_sel_hi:[1,1,1] neg_lo:[1,0,0] neg_hi:[1,0,0]
    v_pk_mul_f32 v[68:69], v[148:149], v[68:69] op_sel:[1,0] op_sel_hi:[1,1]
    v_pk_mul_f32 v[70:71], v[148:149], v[70:71] op_sel:[1,0] op_sel_hi:[1,1]
    v_pk_mul_f32 v[72:73], v[148:149], v[72:73] op_sel:[1,0] op_sel_hi:[1,1]
    v_pk_mul_f32 v[74:75], v[148:149], v[74:75] op_sel:[1,0] op_sel_hi:[1,1]
    v_pk_mul_f32 v[76:77], v[148:149], v[76:77] op_sel:[1,0] op_sel_hi:[1,1]
    v_pk_mul_f32 v[78:79], v[148:149], v[78:79] op_sel:[1,0] op_sel_hi:[1,1]
    v_pk_mul_f32 v[80:81], v[148:149], v[80:81] op_sel:[1,0] op_sel_hi:[1,1]
    v_pk_mul_f32 v[82:83], v[148:149], v[82:83] op_sel:[1,0] op_sel_hi:[1,1]
    v_cvt_pk_bf16_f32 v140, v68, v69
    v_cvt_pk_bf16_f32 v141, v70, v71
    v_cvt_pk_bf16_f32 v142, v72, v73
    v_cvt_pk_bf16_f32 v143, v74, v75
    v_cvt_pk_bf16_f32 v144, v76, v77
    v_cvt_pk_bf16_f32 v145, v78, v79
    v_cvt_pk_bf16_f32 v146, v80, v81
    v_cvt_pk_bf16_f32 v147, v82, v83
    s_mul_i32 s36, s42, 2
    s_add_u32 s37, s43, s36
    buffer_store_dwordx2 v[124:125], v13, s[12:15], s37 offen offset:1024 sc1
    s_add_u32 s37, s44, s36
    buffer_store_dwordx2 v[140:141], v13, s[12:15], s37 offen offset:1024 sc1
    s_mul_i32 s36, s42, 3
    s_add_u32 s37, s43, s36
    v_permlane32_swap_b32 v126, v128
    v_permlane32_swap_b32 v127, v129
    buffer_store_dwordx4 v[126:129], v14, s[12:15], s37 offen sc1
    s_add_u32 s37, s44, s36
    v_permlane32_swap_b32 v142, v144
    v_permlane32_swap_b32 v143, v145
    buffer_store_dwordx4 v[142:145], v14, s[12:15], s37 offen sc1
    s_mul_i32 s36, s42, 4
    s_add_u32 s37, s43, s36
    v_mov_b32 v156, v130
    v_mov_b32 v157, v131
    v_mov_b32 v158, v130
    v_mov_b32 v159, v131
    s_nop 1
    v_permlane32_swap_b32 v156, v158
    v_permlane32_swap_b32 v157, v159
    buffer_store_dwordx4 v[156:159], v12, s[12:15], s37 offen offset:0 sc1
    s_add_u32 s37, s44, s36
    v_mov_b32 v164, v146
    v_mov_b32 v165, v147
    v_mov_b32 v166, v146
    v_mov_b32 v167, v147
    s_nop 1
    v_permlane32_swap_b32 v164, v166
    v_permlane32_swap_b32 v165, v167
    buffer_store_dwordx4 v[164:167], v12, s[12:15], s37 offen offset:0 sc1
    s_branch qkv_done
qkv_qs_4:
    v_pk_fma_f32 v[20:21], v[150:151], v[84:85], v[20:21] op_sel:[0,0,0] op_sel_hi:[0,1,1] neg_lo:[1,0,0] neg_hi:[1,0,0]
    v_pk_fma_f32 v[22:23], v[150:151], v[86:87], v[22:23] op_sel:[0,0,0] op_sel_hi:[0,1,1] neg_lo:[1,0,0] neg_hi:[1,0,0]
    v_pk_fma_f32 v[24:25], v[150:151], v[88:89], v[24:25] op_sel:[0,0,0] op_sel_hi:[0,1,1] neg_lo:[1,0,0] neg_hi:[1,0,0]
    v_pk_fma_f32 v[26:27], v[150:151], v[90:91], v[26:27] op_sel:[0,0,0] op_sel_hi:[0,1,1] neg_lo:[1,0,0] neg_hi:[1,0,0]
    v_pk_fma_f32 v[28:29], v[150:151], v[92:93], v[28:29] op_sel:[0,0,0] op_sel_hi:[0,1,1] neg_lo:[1,0,0] neg_hi:[1,0,0]
    v_pk_fma_f32 v[30:31], v[150:151], v[94:95], v[30:31] op_sel:[0,0,0] op_sel_hi:[0,1,1] neg_lo:[1,0,0] neg_hi:[1,0,0]
    v_pk_fma_f32 v[32:33], v[150:151], v[96:97], v[32:33] op_sel:[0,0,0] op_sel_hi:[0,1,1] neg_lo:[1,0,0] neg_hi:[1,0,0]
    v_pk_fma_f32 v[34:35], v[150:151], v[98:99], v[34:35] op_sel:[0,0,0] op_sel_hi:[0,1,1] neg_lo:[1,0,0] neg_hi:[1,0,0]
    v_pk_mul_f32 v[20:21], v[148:149], v[20:21] op_sel:[0,0] op_sel_hi:[0,1]
    v_pk_mul_f32 v[22:23], v[148:149], v[22:23] op_sel:[0,0] op_sel_hi:[0,1]
    v_pk_mul_f32 v[24:25], v[148:149], v[24:25] op_sel:[0,0] op_sel_hi:[0,1]
    v_pk_mul_f32 v[26:27], v[148:149], v[26:27] op_sel:[0,0] op_sel_hi:[0,1]
    v_pk_mul_f32 v[28:29], v[148:149], v[28:29] op_sel:[0,0] op_sel_hi:[0,1]
    v_pk_mul_f32 v[30:31], v[148:149], v[30:31] op_sel:[0,0] op_sel_hi:[0,1]
    v_pk_mul_f32 v[32:33], v[148:149], v[32:33] op_sel:[0,0] op_sel_hi:[0,1]
    v_pk_mul_f32 v[34:35], v[148:149], v[34:35] op_sel:[0,0] op_sel_hi:[0,1]
    v_cvt_pk_bf16_f32 v116, v20, v21
    v_cvt_pk_bf16_f32 v117, v22, v23
    v_cvt_pk_bf16_f32 v118, v24, v25
    v_cvt_pk_bf16_f32 v119, v26, v27
    v_cvt_pk_bf16_f32 v120, v28, v29
    v_cvt_pk_bf16_f32 v121, v30, v31
    v_cvt_pk_bf16_f32 v122, v32, v33
    v_cvt_pk_bf16_f32 v123, v34, v35
    v_pk_fma_f32 v[52:53], v[150:151], v[84:85], v[52:53] op_sel:[1,0,0] op_sel_hi:[1,1,1] neg_lo:[1,0,0] neg_hi:[1,0,0]
    v_pk_fma_f32 v[54:55], v[150:151], v[86:87], v[54:55] op_sel:[1,0,0] op_sel_hi:[1,1,1] neg_lo:[1,0,0] neg_hi:[1,0,0]
    v_pk_fma_f32 v[56:57], v[150:151], v[88:89], v[56:57] op_sel:[1,0,0] op_sel_hi:[1,1,1] neg_lo:[1,0,0] neg_hi:[1,0,0]
    v_pk_fma_f32 v[58:59], v[150:151], v[90:91], v[58:59] op_sel:[1,0,0] op_sel_hi:[1,1,1] neg_lo:[1,0,0] neg_hi:[1,0,0]
    v_pk_fma_f32 v[60:61], v[150:151], v[92:93], v[60:61] op_sel:[1,0,0] op_sel_hi:[1,1,1] neg_lo:[1,0,0] neg_hi:[1,0,0]
    v_pk_fma_f32 v[62:63], v[150:151], v[94:95], v[62:63] op_sel:[1,0,0] op_sel_hi:[1,1,1] neg_lo:[1,0,0] neg_hi:[1,0,0]
    v_pk_fma_f32 v[64:65], v[150:151], v[96:97], v[64:65] op_sel:[1,0,0] op_sel_hi:[1,1,1] neg_lo:[1,0,0] neg_hi:[1,0,0]
    v_pk_fma_f32 v[66:67], v[150:151], v[98:99], v[66:67] op_sel:[1,0,0] op_sel_hi:[1,1,1] neg_lo:[1,0,0] neg_hi:[1,0,0]
    v_pk_mul_f32 v[52:53], v[148:149], v[52:53] op_sel:[1,0] op_sel_hi:[1,1]
    v_pk_mul_f32 v[54:55], v[148:149], v[54:55] op_sel:[1,0] op_sel_hi:[1,1]
    v_pk_mul_f32 v[56:57], v[148:149], v[56:57] op_sel:[1,0] op_sel_hi:[1,1]
    v_pk_mul_f32 v[58:59], v[148:149], v[58:59] op_sel:[1,0] op_sel_hi:[1,1]
    v_pk_mul_f32 v[60:61], v[148:149], v[60:61] op_sel:[1,0] op_sel_hi:[1,1]
    v_pk_mul_f32 v[62:63], v[148:149], v[62:63] op_sel:[1,0] op_sel_hi:[1,1]
    v_pk_mul_f32 v[64:65], v[148:149], v[64:65] op_sel:[1,0] op_sel_hi:[1,1]
    v_pk_mul_f32 v[66:67], v[148:149], v[66:67] op_sel:[1,0] op_sel_hi:[1,1]
    v_cvt_pk_bf16_f32 v132, v52, v53
    v_cvt_pk_bf16_f32 v133, v54, v55
    v_cvt_pk_bf16_f32 v134, v56, v57
    v_cvt_pk_bf16_f32 v135, v58, v59
    v_cvt_pk_bf16_f32 v136, v60, v61
    v_cvt_pk_bf16_f32 v137, v62, v63
    v_cvt_pk_bf16_f32 v138, v64, v65
    v_cvt_pk_bf16_f32 v139, v66, v67
    s_mul_i32 s36, s42, 1
    s_add_u32 s37, s43, s36
    v_mov_b32 v152, v116
    v_mov_b32 v153, v117
    v_mov_b32 v154, v116
    v_mov_b32 v155, v117
    s_nop 1
    v_permlane32_swap_b32 v152, v154
    v_permlane32_swap_b32 v153, v155
    buffer_store_dwordx4 v[152:155], v12, s[12:15], s37 offen offset:512 sc1
    s_add_u32 s37, s44, s36
    v_mov_b32 v160, v132
    v_mov_b32 v161, v133
    v_mov_b32 v162, v132
    v_mov_b32 v163, v133
    s_nop 1
    v_permlane32_swap_b32 v160, v162
    v_permlane32_swap_b32 v161, v163
    buffer_store_dwordx4 v[160:163], v12, s[12:15], s37 offen offset:512 sc1
    s_mul_i32 s36, s42, 2
    s_add_u32 s37, s43, s36
    v_permlane32_swap_b32 v118, v120
    v_permlane32_swap_b32 v119, v121
    buffer_store_dwordx4 v[118:121], v14, s[12:15], s37 offen sc1
    s_add_u32 s37, s44, s36
    v_permlane32_swap_b32 v134, v136
    v_permlane32_swap_b32 v135, v137
    buffer_store_dwordx4 v[134:137], v14, s[12:15], s37 offen sc1
    s_mul_i32 s36, s42, 2
    s_add_u32 s37, s43, s36
    buffer_store_dwordx2 v[122:123], v13, s[12:15], s37 offen offset:1024 sc1
    s_add_u32 s37, s44, s36
    buffer_store_dwordx2 v[138:139], v13, s[12:15], s37 offen offset:1024 sc1
    v_pk_fma_f32 v[36:37], v[150:151], v[100:101], v[36:37] op_sel:[0,0,0] op_sel_hi:[0,1,1] neg_lo:[1,0,0] neg_hi:[1,0,0]
    v_pk_fma_f32 v[38:39], v[150:151], v[102:103], v[38:39] op_sel:[0,0,0] op_sel_hi:[0,1,1] neg_lo:[1,0,0] neg_hi:[1,0,0]
    v_pk_fma_f32 v[40:41], v[150:151], v[104:105], v[40:41] op_sel:[0,0,0] op_sel_hi:[0,1,1] neg_lo:[1,0,0] neg_hi:[1,0,0]
    v_pk_fma_f32 v[42:43], v[150:151], v[106:107], v[42:43] op_sel:[0,0,0] op_sel_hi:[0,1,1] neg_lo:[1,0,0] neg_hi:[1,0,0]
    v_pk_fma_f32 v[44:45], v[150:151], v[108:109], v[44:45] op_sel:[0,0,0] op_sel_hi:[0,1,1] neg_lo:[1,0,0] neg_hi:[1,0,0]
    v_pk_fma_f32 v[46:47], v[150:151], v[110:111], v[46:47] op_sel:[0,0,0] op_sel_hi:[0,1,1] neg_lo:[1,0,0] neg_hi:[1,0,0]
    v_pk_fma_f32 v[48:49], v[150:151], v[112:113], v[48:49] op_sel:[0,0,0] op_sel_hi:[0,1,1] neg_lo:[1,0,0] neg_hi:[1,0,0]
    v_pk_fma_f32 v[50:51], v[150:151], v[114:115], v[50:51] op_sel:[0,0,0] op_sel_hi:[0,1,1] neg_lo:[1,0,0] neg_hi:[1,0,0]
    v_pk_mul_f32 v[36:37], v[148:149], v[36:37] op_sel:[0,0] op_sel_hi:[0,1]
    v_pk_mul_f32 v[38:39], v[148:149], v[38:39] op_sel:[0,0] op_sel_hi:[0,1]
    v_pk_mul_f32 v[40:41], v[148:149], v[40:41] op_sel:[0,0] op_sel_hi:[0,1]
    v_pk_mul_f32 v[42:43], v[148:149], v[42:43] op_sel:[0,0] op_sel_hi:[0,1]
    v_pk_mul_f32 v[44:45], v[148:149], v[44:45] op_sel:[0,0] op_sel_hi:[0,1]
    v_pk_mul_f32 v[46:47], v[148:149], v[46:47] op_sel:[0,0] op_sel_hi:[0,1]
    v_pk_mul_f32 v[48:49], v[148:149], v[48:49] op_sel:[0,0] op_sel_hi:[0,1]
    v_pk_mul_f32 v[50:51], v[148:149], v[50:51] op_sel:[0,0] op_sel_hi:[0,1]
    v_cvt_pk_bf16_f32 v124, v36, v37
    v_cvt_pk_bf16_f32 v125, v38, v39
    v_cvt_pk_bf16_f32 v126, v40, v41
    v_cvt_pk_bf16_f32 v127, v42, v43
    v_cvt_pk_bf16_f32 v128, v44, v45
    v_cvt_pk_bf16_f32 v129, v46, v47
    v_cvt_pk_bf16_f32 v130, v48, v49
    v_cvt_pk_bf16_f32 v131, v50, v51
    v_pk_fma_f32 v[68:69], v[150:151], v[100:101], v[68:69] op_sel:[1,0,0] op_sel_hi:[1,1,1] neg_lo:[1,0,0] neg_hi:[1,0,0]
    v_pk_fma_f32 v[70:71], v[150:151], v[102:103], v[70:71] op_sel:[1,0,0] op_sel_hi:[1,1,1] neg_lo:[1,0,0] neg_hi:[1,0,0]
    v_pk_fma_f32 v[72:73], v[150:151], v[104:105], v[72:73] op_sel:[1,0,0] op_sel_hi:[1,1,1] neg_lo:[1,0,0] neg_hi:[1,0,0]
    v_pk_fma_f32 v[74:75], v[150:151], v[106:107], v[74:75] op_sel:[1,0,0] op_sel_hi:[1,1,1] neg_lo:[1,0,0] neg_hi:[1,0,0]
    v_pk_fma_f32 v[76:77], v[150:151], v[108:109], v[76:77] op_sel:[1,0,0] op_sel_hi:[1,1,1] neg_lo:[1,0,0] neg_hi:[1,0,0]
    v_pk_fma_f32 v[78:79], v[150:151], v[110:111], v[78:79] op_sel:[1,0,0] op_sel_hi:[1,1,1] neg_lo:[1,0,0] neg_hi:[1,0,0]
    v_pk_fma_f32 v[80:81], v[150:151], v[112:113], v[80:81] op_sel:[1,0,0] op_sel_hi:[1,1,1] neg_lo:[1,0,0] neg_hi:[1,0,0]
    v_pk_fma_f32 v[82:83], v[150:151], v[114:115], v[82:83] op_sel:[1,0,0] op_sel_hi:[1,1,1] neg_lo:[1,0,0] neg_hi:[1,0,0]
    v_pk_mul_f32 v[68:69], v[148:149], v[68:69] op_sel:[1,0] op_sel_hi:[1,1]
    v_pk_mul_f32 v[70:71], v[148:149], v[70:71] op_sel:[1,0] op_sel_hi:[1,1]
    v_pk_mul_f32 v[72:73], v[148:149], v[72:73] op_sel:[1,0] op_sel_hi:[1,1]
    v_pk_mul_f32 v[74:75], v[148:149], v[74:75] op_sel:[1,0] op_sel_hi:[1,1]
    v_pk_mul_f32 v[76:77], v[148:149], v[76:77] op_sel:[1,0] op_sel_hi:[1,1]
    v_pk_mul_f32 v[78:79], v[148:149], v[78:79] op_sel:[1,0] op_sel_hi:[1,1]
    v_pk_mul_f32 v[80:81], v[148:149], v[80:81] op_sel:[1,0] op_sel_hi:[1,1]
    v_pk_mul_f32 v[82:83], v[148:149], v[82:83] op_sel:[1,0] op_sel_hi:[1,1]
    v_cvt_pk_bf16_f32 v140, v68, v69
    v_cvt_pk_bf16_f32 v141, v70, v71
    v_cvt_pk_bf16_f32 v142, v72, v73
    v_cvt_pk_bf16_f32 v143, v74, v75
    v_cvt_pk_bf16_f32 v144, v76, v77
    v_cvt_pk_bf16_f32 v145, v78, v79
    v_cvt_pk_bf16_f32 v146, v80, v81
    v_cvt_pk_bf16_f32 v147, v82, v83
    s_mul_i32 s36, s42, 3
    s_add_u32 s37, s43, s36
    v_permlane32_swap_b32 v124, v126
    v_permlane32_swap_b32 v125, v127
    buffer_store_dwordx4 v[124:127], v14, s[12:15], s37 offen sc1
    s_add_u32 s37, s44, s36
    v_permlane32_swap_b32 v140, v142
    v_permlane32_swap_b32 v141, v143
    buffer_store_dwordx4 v[140:143], v14, s[12:15], s37 offen sc1
    s_mul_i32 s36, s42, 4
    s_add_u32 s37, s43, s36
    v_permlane32_swap_b32 v128, v130
    v_permlane32_swap_b32 v129, v131
    buffer_store_dwordx4 v[128:131], v14, s[12:15], s37 offen sc1
    s_add_u32 s37, s44, s36
    v_permlane32_swap_b32 v144, v146
    v_permlane32_swap_b32 v145, v147
    buffer_store_dwordx4 v[144:147], v14, s[12:15], s37 offen sc1
    s_branch qkv_done
qkv_preV:
    s_sub_u32 s36, s26, 10
    s_lshl_b32 s36, s36, 7
    s_lshl_b32 s37, s28, 6
    s_add_u32 s36, s36, s37
    v_add_u32 v2, s36, v6
    v_mul_u32_u24 v4, 3277, v2
    v_lshrrev_b32 v4, 16, v4
    v_mul_u32_u24 v12, 20, v4
    v_sub_u32 v12, v2, v12
    v_mul_u32_u24 v4, 163840, v4
    v_lshl_add_u32 v12, v12, 4, v4
    v_mul_u32_u24 v4, 320, v5
    v_add_u32 v12, v12, v4
    v_add_u32 v2, s36, v6
    v_add_u32 v2, 32, v2
    v_mul_u32_u24 v4, 3277, v2
    v_lshrrev_b32 v4, 16, v4
    v_mul_u32_u24 v13, 20, v4
    v_sub_u32 v13, v2, v13
    v_mul_u32_u24 v4, 163840, v4
    v_lshl_add_u32 v13, v13, 4, v4
    v_mul_u32_u24 v4, 320, v5
    v_add_u32 v13, v13, v4
    s_mul_i32 s43, s41, 2560
    s_add_u32 s43, s43, 2622720
    s_add_u32 s44, s43, 2560
    s_barrier
    ds_read_b64_tr_b16 v[92:93], v11 offset:0
    ds_read_b64_tr_b16 v[94:95], v11 offset:512
    ds_read_b128 v[84:87], v9 offset:0
    ds_read_b128 v[88:91], v9 offset:4096
    ds_read_b64_tr_b16 v[96:97], v11 offset:256
    ds_read_b64_tr_b16 v[98:99], v11 offset:768
    ds_read_b64_tr_b16 v[108:109], v11 offset:4096
    ds_read_b64_tr_b16 v[110:111], v11 offset:4608
    ds_read_b128 v[100:103], v10 offset:0
    ds_read_b128 v[104:107], v10 offset:4096
    ds_read_b64_tr_b16 v[112:113], v11 offset:4352
    ds_read_b64_tr_b16 v[114:115], v11 offset:4864
qkv_cloopV:
    s_waitcnt lgkmcnt(6)
    v_mfma_f32_32x32x16_bf16 v[20:35], v[84:87], v[92:95], v[20:35]
    ds_read_b64_tr_b16 v[124:125], v11 offset:8192
    ds_read_b64_tr_b16 v[126:127], v11 offset:8704
    v_mfma_f32_32x32x16_bf16 v[52:67], v[88:91], v[92:95], v[52:67]
    ds_read_b128 v[116:119], v9 offset:512
    ds_read_b128 v[120:123], v9 offset:4608
    v_mfma_f32_32x32x16_bf16 v[36:51], v[84:87], v[96:99], v[36:51]
    ds_read_b64_tr_b16 v[128:129], v11 offset:8448
    ds_read_b64_tr_b16 v[130:131], v11 offset:8960
    v_mfma_f32_32x32x16_bf16 v[68:83], v[88:91], v[96:99], v[68:83]
    s_add_u32 s33, s33, 32768
    s_and_b32 s33, s33, 131071
    s_waitcnt lgkmcnt(6)
    v_mfma_f32_32x32x16_bf16 v[20:35], v[100:103], v[108:111], v[20:35]
    ds_read_b64_tr_b16 v[140:141], v11 offset:12288
    ds_read_b64_tr_b16 v[142:143], v11 offset:12800
    v_mfma_f32_32x32x16_bf16 v[52:67], v[104:107], v[108:111], v[52:67]
    ds_read_b128 v[132:135], v10 offset:512
    v_mfma_f32_32x32x16_bf16 v[36:51], v[100:103], v[112:115], v[36:51]
    ds_read_b128 v[136:139], v10 offset:4608
    ds_read_b64_tr_b16 v[144:145], v11 offset:12544
    v_mfma_f32_32x32x16_bf16 v[68:83], v[104:107], v[112:115], v[68:83]
    ds_read_b64_tr_b16 v[146:147], v11 offset:13056
    s_waitcnt lgkmcnt(6)
    v_mfma_f32_32x32x16_bf16 v[20:35], v[116:119], v[124:127], v[20:35]
    v_add_u32 v9, s33, v7
    v_add_u32 v11, s33, v8
    v_xor_b32 v10, 32, v9
    s_add_u32 s29, s29, 1
    s_cmp_eq_u32 s29, 10
    v_mfma_f32_32x32x16_bf16 v[52:67], v[120:123], v[124:127], v[52:67]
    s_waitcnt lgkmcnt(0)
    s_barrier
    s_cbranch_scc1 qkv_cdoneV
    v_mfma_f32_32x32x16_bf16 v[36:51], v[116:119], v[128:131], v[36:51]
    ds_read_b64_tr_b16 v[92:93], v11 offset:0
    ds_read_b64_tr_b16 v[94:95], v11 offset:512
    ds_read_b128 v[84:87], v9 offset:0
    v_mfma_f32_32x32x16_bf16 v[68:83], v[120:123], v[128:131], v[68:83]
    ds_read_b128 v[88:91], v9 offset:4096
    ds_read_b64_tr_b16 v[96:97], v11 offset:256
    ds_read_b64_tr_b16 v[98:99], v11 offset:768
    v_mfma_f32_32x32x16_bf16 v[20:35], v[132:135], v[140:143], v[20:35]
    ds_read_b64_tr_b16 v[108:109], v11 offset:4096
    ds_read_b64_tr_b16 v[110:111], v11 offset:4608
    v_mfma_f32_32x32x16_bf16 v[52:67], v[136:139], v[140:143], v[52:67]
    ds_read_b128 v[100:103], v10 offset:0
    v_mfma_f32_32x32x16_bf16 v[36:51], v[132:135], v[144:147], v[36:51]
    ds_read_b128 v[104:107], v10 offset:4096
    ds_read_b64_tr_b16 v[112:113], v11 offset:4352
    v_mfma_f32_32x32x16_bf16 v[68:83], v[136:139], v[144:147], v[68:83]
    ds_read_b64_tr_b16 v[114:115], v11 offset:4864
    s_branch qkv_cloopV
qkv_cdoneV:
    s_lshl_b32 s36, s28, 8
    s_add_u32 s36, s36, 132096
    v_lshl_add_u32 v2, v6, 2, s36
    s_lshl_b32 s36, s27, 8
    s_add_u32 s36, s36, 131072
    v_lshl_add_u32 v3, v5, 4, s36
    ds_read_b32 v148, v2 offset:0
    ds_read_b32 v149, v2 offset:128
    ds_read_b128 v[84:87], v3 offset:0
    ds_read_b128 v[100:103], v3 offset:512
    ds_read_b128 v[88:91], v3 offset:32
    ds_read_b128 v[104:107], v3 offset:544
    ds_read_b128 v[92:95], v3 offset:64
    ds_read_b128 v[108:111], v3 offset:576
    ds_read_b128 v[96:99], v3 offset:96
    ds_read_b128 v[112:115], v3 offset:608
    v_mfma_f32_32x32x16_bf16 v[36:51], v[116:119], v[128:131], v[36:51]
    v_mfma_f32_32x32x16_bf16 v[68:83], v[120:123], v[128:131], v[68:83]
    v_mfma_f32_32x32x16_bf16 v[20:35], v[132:135], v[140:143], v[20:35]
    v_mfma_f32_32x32x16_bf16 v[52:67], v[136:139], v[140:143], v[52:67]
    v_mfma_f32_32x32x16_bf16 v[36:51], v[132:135], v[144:147], v[36:51]
    v_mfma_f32_32x32x16_bf16 v[68:83], v[136:139], v[144:147], v[68:83]
    s_nop 7
    s_nop 3
    s_waitcnt lgkmcnt(0)
    v_pk_fma_f32 v[20:21], v[100:101], v[148:149], v[20:21] op_sel:[0,0,0] op_sel_hi:[1,0,1] neg_lo:[1,0,0] neg_hi:[1,0,0]
    v_pk_fma_f32 v[22:23], v[102:103], v[148:149], v[22:23] op_sel:[0,0,0] op_sel_hi:[1,0,1] neg_lo:[1,0,0] neg_hi:[1,0,0]
    v_pk_fma_f32 v[24:25], v[104:105], v[148:149], v[24:25] op_sel:[0,0,0] op_sel_hi:[1,0,1] neg_lo:[1,0,0] neg_hi:[1,0,0]
    v_pk_fma_f32 v[26:27], v[106:107], v[148:149], v[26:27] op_sel:[0,0,0] op_sel_hi:[1,0,1] neg_lo:[1,0,0] neg_hi:[1,0,0]
    v_pk_fma_f32 v[28:29], v[108:109], v[148:149], v[28:29] op_sel:[0,0,0] op_sel_hi:[1,0,1] neg_lo:[1,0,0] neg_hi:[1,0,0]
    v_pk_fma_f32 v[30:31], v[110:111], v[148:149], v[30:31] op_sel:[0,0,0] op_sel_hi:[1,0,1] neg_lo:[1,0,0] neg_hi:[1,0,0]
    v_pk_fma_f32 v[32:33], v[112:113], v[148:149], v[32:33] op_sel:[0,0,0] op_sel_hi:[1,0,1] neg_lo:[1,0,0] neg_hi:[1,0,0]
    v_pk_fma_f32 v[34:35], v[114:115], v[148:149], v[34:35] op_sel:[0,0,0] op_sel_hi:[1,0,1] neg_lo:[1,0,0] neg_hi:[1,0,0]
    v_pk_mul_f32 v[20:21], v[84:85], v[20:21]
    v_pk_mul_f32 v[22:23], v[86:87], v[22:23]
    v_pk_mul_f32 v[24:25], v[88:89], v[24:25]
    v_pk_mul_f32 v[26:27], v[90:91], v[26:27]
    v_pk_mul_f32 v[28:29], v[92:93], v[28:29]
    v_pk_mul_f32 v[30:31], v[94:95], v[30:31]
    v_pk_mul_f32 v[32:33], v[96:97], v[32:33]
    v_pk_mul_f32 v[34:35], v[98:99], v[34:35]
    v_cvt_pk_bf16_f32 v116, v20, v21
    v_cvt_pk_bf16_f32 v117, v22, v23
    v_cvt_pk_bf16_f32 v118, v24, v25
    v_cvt_pk_bf16_f32 v119, v26, v27
    buffer_store_dwordx4 v[116:119], v12, s[12:15], s43 offen offset:0 sc1
    v_cvt_pk_bf16_f32 v120, v28, v29
    v_cvt_pk_bf16_f32 v121, v30, v31
    v_cvt_pk_bf16_f32 v122, v32, v33
    v_cvt_pk_bf16_f32 v123, v34, v35
    buffer_store_dwordx4 v[120:123], v12, s[12:15], s43 offen offset:640 sc1
    v_pk_fma_f32 v[36:37], v[100:101], v[148:149], v[36:37] op_sel:[0,1,0] op_sel_hi:[1,1,1] neg_lo:[1,0,0] neg_hi:[1,0,0]
    v_pk_fma_f32 v[38:39], v[102:103], v[148:149], v[38:39] op_sel:[0,1,0] op_sel_hi:[1,1,1] neg_lo:[1,0,0] neg_hi:[1,0,0]
    v_pk_fma_f32 v[40:41], v[104:105], v[148:149], v[40:41] op_sel:[0,1,0] op_sel_hi:[1,1,1] neg_lo:[1,0,0] neg_hi:[1,0,0]
    v_pk_fma_f32 v[42:43], v[106:107], v[148:149], v[42:43] op_sel:[0,1,0] op_sel_hi:[1,1,1] neg_lo:[1,0,0] neg_hi:[1,0,0]
    v_pk_fma_f32 v[44:45], v[108:109], v[148:149], v[44:45] op_sel:[0,1,0] op_sel_hi:[1,1,1] neg_lo:[1,0,0] neg_hi:[1,0,0]
    v_pk_fma_f32 v[46:47], v[110:111], v[148:149], v[46:47] op_sel:[0,1,0] op_sel_hi:[1,1,1] neg_lo:[1,0,0] neg_hi:[1,0,0]
    v_pk_fma_f32 v[48:49], v[112:113], v[148:149], v[48:49] op_sel:[0,1,0] op_sel_hi:[1,1,1] neg_lo:[1,0,0] neg_hi:[1,0,0]
    v_pk_fma_f32 v[50:51], v[114:115], v[148:149], v[50:51] op_sel:[0,1,0] op_sel_hi:[1,1,1] neg_lo:[1,0,0] neg_hi:[1,0,0]
    v_pk_mul_f32 v[36:37], v[84:85], v[36:37]
    v_pk_mul_f32 v[38:39], v[86:87], v[38:39]
    v_pk_mul_f32 v[40:41], v[88:89], v[40:41]
    v_pk_mul_f32 v[42:43], v[90:91], v[42:43]
    v_pk_mul_f32 v[44:45], v[92:93], v[44:45]
    v_pk_mul_f32 v[46:47], v[94:95], v[46:47]
    v_pk_mul_f32 v[48:49], v[96:97], v[48:49]
    v_pk_mul_f32 v[50:51], v[98:99], v[50:51]
    v_cvt_pk_bf16_f32 v124, v36, v37
    v_cvt_pk_bf16_f32 v125, v38, v39
    v_cvt_pk_bf16_f32 v126, v40, v41
    v_cvt_pk_bf16_f32 v127, v42, v43
    buffer_store_dwordx4 v[124:127], v13, s[12:15], s43 offen offset:0 sc1
    v_cvt_pk_bf16_f32 v128, v44, v45
    v_cvt_pk_bf16_f32 v129, v46, v47
    v_cvt_pk_bf16_f32 v130, v48, v49
    v_cvt_pk_bf16_f32 v131, v50, v51
    buffer_store_dwordx4 v[128:131], v13, s[12:15], s43 offen offset:640 sc1
    ds_read_b128 v[84:87], v3 offset:128
    ds_read_b128 v[100:103], v3 offset:640
    ds_read_b128 v[88:91], v3 offset:160
    ds_read_b128 v[104:107], v3 offset:672
    ds_read_b128 v[92:95], v3 offset:192
    ds_read_b128 v[108:111], v3 offset:704
    ds_read_b128 v[96:99], v3 offset:224
    ds_read_b128 v[112:115], v3 offset:736
    s_waitcnt lgkmcnt(0)
    v_pk_fma_f32 v[52:53], v[100:101], v[148:149], v[52:53] op_sel:[0,0,0] op_sel_hi:[1,0,1] neg_lo:[1,0,0] neg_hi:[1,0,0]
    v_pk_fma_f32 v[54:55], v[102:103], v[148:149], v[54:55] op_sel:[0,0,0] op_sel_hi:[1,0,1] neg_lo:[1,0,0] neg_hi:[1,0,0]
    v_pk_fma_f32 v[56:57], v[104:105], v[148:149], v[56:57] op_sel:[0,0,0] op_sel_hi:[1,0,1] neg_lo:[1,0,0] neg_hi:[1,0,0]
    v_pk_fma_f32 v[58:59], v[106:107], v[148:149], v[58:59] op_sel:[0,0,0] op_sel_hi:[1,0,1] neg_lo:[1,0,0] neg_hi:[1,0,0]
    v_pk_fma_f32 v[60:61], v[108:109], v[148:149], v[60:61] op_sel:[0,0,0] op_sel_hi:[1,0,1] neg_lo:[1,0,0] neg_hi:[1,0,0]
    v_pk_fma_f32 v[62:63], v[110:111], v[148:149], v[62:63] op_sel:[0,0,0] op_sel_hi:[1,0,1] neg_lo:[1,0,0] neg_hi:[1,0,0]
    v_pk_fma_f32 v[64:65], v[112:113], v[148:149], v[64:65] op_sel:[0,0,0] op_sel_hi:[1,0,1] neg_lo:[1,0,0] neg_hi:[1,0,0]
    v_pk_fma_f32 v[66:67], v[114:115], v[148:149], v[66:67] op_sel:[0,0,0] op_sel_hi:[1,0,1] neg_lo:[1,0,0] neg_hi:[1,0,0]
    v_pk_mul_f32 v[52:53], v[84:85], v[52:53]
    v_pk_mul_f32 v[54:55], v[86:87], v[54:55]
    v_pk_mul_f32 v[56:57], v[88:89], v[56:57]
    v_pk_mul_f32 v[58:59], v[90:91], v[58:59]
    v_pk_mul_f32 v[60:61], v[92:93], v[60:61]
    v_pk_mul_f32 v[62:63], v[94:95], v[62:63]
    v_pk_mul_f32 v[64:65], v[96:97], v[64:65]
    v_pk_mul_f32 v[66:67], v[98:99], v[66:67]
    v_cvt_pk_bf16_f32 v132, v52, v53
    v_cvt_pk_bf16_f32 v133, v54, v55
    v_cvt_pk_bf16_f32 v134, v56, v57
    v_cvt_pk_bf16_f32 v135, v58, v59
    buffer_store_dwordx4 v[132:135], v12, s[12:15], s44 offen offset:0 sc1
    v_cvt_pk_bf16_f32 v136, v60, v61
    v_cvt_pk_bf16_f32 v137, v62, v63
    v_cvt_pk_bf16_f32 v138, v64, v65
    v_cvt_pk_bf16_f32 v139, v66, v67
    buffer_store_dwordx4 v[136:139], v12, s[12:15], s44 offen offset:640 sc1
    v_pk_fma_f32 v[68:69], v[100:101], v[148:149], v[68:69] op_sel:[0,1,0] op_sel_hi:[1,1,1] neg_lo:[1,0,0] neg_hi:[1,0,0]
    v_pk_fma_f32 v[70:71], v[102:103], v[148:149], v[70:71] op_sel:[0,1,0] op_sel_hi:[1,1,1] neg_lo:[1,0,0] neg_hi:[1,0,0]
    v_pk_fma_f32 v[72:73], v[104:105], v[148:149], v[72:73] op_sel:[0,1,0] op_sel_hi:[1,1,1] neg_lo:[1,0,0] neg_hi:[1,0,0]
    v_pk_fma_f32 v[74:75], v[106:107], v[148:149], v[74:75] op_sel:[0,1,0] op_sel_hi:[1,1,1] neg_lo:[1,0,0] neg_hi:[1,0,0]
    v_pk_fma_f32 v[76:77], v[108:109], v[148:149], v[76:77] op_sel:[0,1,0] op_sel_hi:[1,1,1] neg_lo:[1,0,0] neg_hi:[1,0,0]
    v_pk_fma_f32 v[78:79], v[110:111], v[148:149], v[78:79] op_sel:[0,1,0] op_sel_hi:[1,1,1] neg_lo:[1,0,0] neg_hi:[1,0,0]
    v_pk_fma_f32 v[80:81], v[112:113], v[148:149], v[80:81] op_sel:[0,1,0] op_sel_hi:[1,1,1] neg_lo:[1,0,0] neg_hi:[1,0,0]
    v_pk_fma_f32 v[82:83], v[114:115], v[148:149], v[82:83] op_sel:[0,1,0] op_sel_hi:[1,1,1] neg_lo:[1,0,0] neg_hi:[1,0,0]
    v_pk_mul_f32 v[68:69], v[84:85], v[68:69]
    v_pk_mul_f32 v[70:71], v[86:87], v[70:71]
    v_pk_mul_f32 v[72:73], v[88:89], v[72:73]
    v_pk_mul_f32 v[74:75], v[90:91], v[74:75]
    v_pk_mul_f32 v[76:77], v[92:93], v[76:77]
    v_pk_mul_f32 v[78:79], v[94:95], v[78:79]
    v_pk_mul_f32 v[80:81], v[96:97], v[80:81]
    v_pk_mul_f32 v[82:83], v[98:99], v[82:83]
    v_cvt_pk_bf16_f32 v140, v68, v69
    v_cvt_pk_bf16_f32 v141, v70, v71
    v_cvt_pk_bf16_f32 v142, v72, v73
    v_cvt_pk_bf16_f32 v143, v74, v75
    buffer_store_dwordx4 v[140:143], v13, s[12:15], s44 offen offset:0 sc1
    v_cvt_pk_bf16_f32 v144, v76, v77
    v_cvt_pk_bf16_f32 v145, v78, v79
    v_cvt_pk_bf16_f32 v146, v80, v81
    v_cvt_pk_bf16_f32 v147, v82, v83
    buffer_store_dwordx4 v[144:147], v13, s[12:15], s44 offen offset:640 sc1
qkv_done:
    s_mov_b32 s50, 262144
    s_mul_i32 s36, s26, 4096
    s_mul_i32 s37, s25, 32
    s_add_u32 s36, s36, s37
    s_add_u32 s36, s36, 20905984
    s_add_u32 s36, s36, s50
    v_mov_b32 v3, 1
    v_mov_b32 v2, 159824
    s_mov_b64 exec, 1
    s_waitcnt vmcnt(0)
    ds_add_rtn_u32 v2, v2, v3
    s_waitcnt lgkmcnt(0)
    v_readfirstlane_b32 s37, v2
    s_mov_b64 exec, -1
    s_nop 2
    s_cmp_lg_u32 s37, 3
    s_cbranch_scc1 L_sg_14
    v_mul_u32_u24 v2, 1024, v1
    s_mov_b64 exec, 0xf
    buffer_store_dword v3, v2, s[12:15], s36 offen sc1
    s_mov_b64 exec, -1
L_sg_14:
aw_body:
    s_load_dwordx2 s[8:9], s[0:1], 80
    s_load_dwordx2 s[4:5], s[0:1], 16
    s_load_dwordx2 s[6:7], s[0:1], 32
    s_load_dwordx2 s[10:11], s[0:1], 48
    s_load_dwordx2 s[46:47], s[0:1], 0
    v_lshrrev_b32 v2, 6, v0
    v_and_b32 v1, 63, v0
    s_and_b32 s25, s2, 31
    v_readfirstlane_b32 s24, v2
    s_lshr_b32 s26, s2, 5
    s_mov_b32 s30, 0
    s_mov_b32 s32, 0x000fffff
    s_mov_b32 s33, 0x000fffff
    s_lshr_b32 s27, s24, 2
    s_and_b32 s28, s24, 3
    v_lshlrev_b32 v5, 4, v1
    v_lshlrev_b32 v6, 3, v1
    v_mov_b32 v7, 0x40000000
    v_cmp_gt_u32 vcc, 32, v1
    v_and_b32 v8, 31, v1
    v_lshrrev_b32 v9, 5, v1
    v_cndmask_b32 v6, v7, v6, vcc
    s_lshl_b32 s34, s25, 6
    s_lshl_b32 s35, s26, 3
    s_add_u32 s34, s34, s35
    s_lshl_b32 s35, s28, 1
    s_add_u32 s34, s34, s35
    s_mul_i32 s40, s34, 1280
    s_mul_i32 s41, s27, 81920
    s_mul_i32 s31, s25, 163840
    s_add_u32 s31, s31, 2621440
    s_mul_i32 s36, s3, 23068672
    s_add_u32 s40, s40, s36
    s_add_u32 s31, s31, s36
    s_waitcnt lgkmcnt(0)
    s_mov_b32 s12, s8
    s_mov_b32 s13, s9
    s_mov_b32 s14, 30932992
    s_mov_b32 s15, 0x00020000
attn_restart:
    s_lshl_b32 s42, s28, 10
    s_add_u32 s42, s42, s41
    s_add_u32 s43, s31, s42
    v_mul_u32_u24 v4, 320, v9
    v_lshl_add_u32 v4, v8, 4, v4
    v_add_u32 v4, 1280, v4
    v_add_u32 v4, s41, v4
    v_and_b32 v7, 27, v1
    v_cmp_eq_u32 vcc, 24, v7
    v_mov_b32 v10, 0x3f803f80
    v_mov_b32 v12, 0
    v_mov_b32 v13, 0
    v_cndmask_b32 v10, 0, v10, vcc
    v_mov_b32 v28, v10
    v_mov_b32 v29, v10
    v_mov_b32 v30, v10
    v_mov_b32 v31, v10
    v_mov_b32 v32, v10
    v_mov_b32 v33, v10
    v_mov_b32 v34, v10
    v_mov_b32 v35, v10
    v_mov_b32 v36, v10
    v_mov_b32 v37, v10
    v_mov_b32 v38, v10
    v_mov_b32 v39, v10
    v_mov_b32 v40, v10
    v_mov_b32 v41, v10
    v_mov_b32 v42, v10
    v_mov_b32 v43, v10
    v_mov_b32 v64, 0
    v_mov_b32 v65, 0
    v_mov_b32 v66, 0
    v_mov_b32 v67, 0
    v_mov_b32 v68, 0
    v_mov_b32 v69, 0
    v_mov_b32 v70, 0
    v_mov_b32 v71, 0
    v_mov_b32 v136, 0
    v_mov_b32 v137, 0
    v_mov_b32 v138, 0
    v_mov_b32 v139, 0
    v_mov_b32 v140, 0
    v_mov_b32 v141, 0
    v_mov_b32 v142, 0
    v_mov_b32 v143, 0
    v_mov_b32 v144, 0
    v_mov_b32 v145, 0
    v_mov_b32 v146, 0
    v_mov_b32 v147, 0
    v_mov_b32 v148, 0
    v_mov_b32 v149, 0
    v_mov_b32 v150, 0
    v_mov_b32 v151, 0
    v_mov_b32 v152, 0
    v_mov_b32 v153, 0
    v_mov_b32 v154, 0
    v_mov_b32 v155, 0
    v_mov_b32 v156, 0
    v_mov_b32 v157, 0
    v_mov_b32 v158, 0
    v_mov_b32 v159, 0
    v_mov_b32 v160, 0
    v_mov_b32 v161, 0
    v_mov_b32 v162, 0
    v_mov_b32 v163, 0
    v_mov_b32 v164, 0
    v_mov_b32 v165, 0
    v_mov_b32 v166, 0
    v_mov_b32 v167, 0
    v_mov_b32 v72, 0xff800000
    v_mov_b32 v88, 0xff800000
    s_mov_b32 s16, s4
    s_mov_b32 s17, s5
    s_mov_b32 s18, 819200
    s_mov_b32 s19, 0x00020000
    s_mov_b32 s20, s6
    s_mov_b32 s21, s7
    s_mov_b32 s22, 6291456
    s_mov_b32 s23, 0x00020000
    s_mov_b32 s52, s10
    s_mov_b32 s53, s11
    s_mov_b32 s54, 6291456
    s_mov_b32 s55, 0x00020000
    s_and_b32 s34, s2, 7
    s_lshr_b32 s35, s2, 3
    s_lshl_b32 s35, s35, 3
    s_add_u32 s35, s35, s24
    s_lshl_b32 s36, s2, 3
    s_add_u32 s36, s36, s24
    s_mul_i32 s36, s36, 3072
    v_min_u32 v168, 23, v1
    v_lshl_add_u32 v168, v168, 7, s36
    v_mul_u32_u24 v169, 43, v1
    v_lshrrev_b32 v169, 8, v169
    v_mul_u32_u24 v7, 6, v169
    v_sub_u32 v7, v1, v7
    v_min_u32 v169, 7, v169
    v_mul_u32_u24 v169, 3072, v169
    v_lshl_add_u32 v169, v7, 7, v169
    s_lshr_b32 s36, s34, 1
    s_mul_i32 s36, s36, 768
    s_mul_i32 s37, s35, 24576
    s_add_u32 s36, s36, s37
    v_add_u32 v169, s36, v169
    s_mul_i32 s36, s35, 13
    v_min_u32 v170, 12, v1
    v_add_u32 v170, s36, v170
    s_movk_i32 s37, 13108
    v_mul_u32_u24 v7, s37, v170
    v_lshrrev_b32 v7, 16, v7
    v_mul_u32_u24 v7, 640, v7
    v_lshl_add_u32 v170, v170, 7, v7
    s_and_b32 s36, s34, 1
    s_mul_i32 s36, s36, 640
    v_add_u32 v170, s36, v170
    s_lshr_b32 s38, s34, 1
    s_lshl_b32 s38, s38, 3
    s_bfe_u32 s36, s2, 0x30003
    s_add_u32 s38, s38, s36
    s_and_b32 s39, s34, 1
    s_lshl_b32 s39, s39, 2
    s_lshr_b32 s36, s2, 6
    s_add_u32 s39, s39, s36
    s_lshr_b32 s36, s24, 2
    s_and_b32 s36, s36, s3
    s_cmp_lg_u32 s36, 0
    s_cselect_b64 s[60:61], -1, 0
    s_movk_i32 s62, 160
    s_cselect_b32 s62, 5120, s62
    s_movk_i32 s37, 6554
    v_add_u32 v7, 0, v1
    v_mul_u32_u24 v172, s37, v7
    v_lshrrev_b32 v172, 16, v172
    v_mul_u32_u24 v177, 5104, v172
    v_lshlrev_b32 v11, 9, v7
    v_sub_u32 v177, v11, v177
    v_mul_u32_u24 v172, 1120, v172
    v_lshl_add_u32 v172, v7, 4, v172
    v_cndmask_b32 v177, v172, v177, s[60:61]
    v_add_u32 v7, 64, v1
    v_mul_u32_u24 v173, s37, v7
    v_lshrrev_b32 v173, 16, v173
    v_mul_u32_u24 v178, 5104, v173
    v_lshlrev_b32 v11, 9, v7
    v_sub_u32 v178, v11, v178
    v_mul_u32_u24 v173, 1120, v173
    v_lshl_add_u32 v173, v7, 4, v173
    v_cndmask_b32 v178, v173, v178, s[60:61]
    v_add_u32 v7, 128, v1
    v_mul_u32_u24 v174, s37, v7
    v_lshrrev_b32 v174, 16, v174
    v_mul_u32_u24 v179, 5104, v174
    v_lshlrev_b32 v11, 9, v7
    v_sub_u32 v179, v11, v179
    v_mul_u32_u24 v174, 1120, v174
    v_lshl_add_u32 v174, v7, 4, v174
    v_cndmask_b32 v179, v174, v179, s[60:61]
    v_add_u32 v7, 192, v1
    v_mul_u32_u24 v175, s37, v7
    v_lshrrev_b32 v175, 16, v175
    v_mul_u32_u24 v180, 5104, v175
    v_lshlrev_b32 v11, 9, v7
    v_sub_u32 v180, v11, v180
    v_mul_u32_u24 v175, 1120, v175
    v_lshl_add_u32 v175, v7, 4, v175
    v_cndmask_b32 v180, v175, v180, s[60:61]
    v_add_u32 v7, 256, v1
    v_mul_u32_u24 v176, s37, v7
    v_lshrrev_b32 v176, 16, v176
    v_mul_u32_u24 v181, 5104, v176
    v_lshlrev_b32 v11, 9, v7
    v_sub_u32 v181, v11, v181
    v_mul_u32_u24 v176, 1120, v176
    v_lshl_add_u32 v176, v7, 4, v176
    v_cndmask_b32 v181, v176, v181, s[60:61]
    v_bfe_u32 v7, v1, 2, 2
    v_lshl_add_u32 v7, v9, 2, v7
    v_mul_u32_u24 v182, 3072, v7
    v_bfe_u32 v7, v1, 4, 1
    v_lshl_add_u32 v182, v7, 6, v182
    v_and_b32 v7, 3, v1
    v_lshl_add_u32 v182, v7, 4, v182
    s_lshr_b32 s36, s2, 3
    s_mul_i32 s37, s36, 43
    s_lshr_b32 s37, s37, 8
    s_mul_i32 s37, s37, 6
    s_sub_u32 s36, s36, s37
    s_lshr_b32 s63, s34, 1
    s_mul_i32 s63, s63, 6
    s_add_u32 s63, s63, s36
    s_lshl_b32 s63, s63, 7
    s_add_u32 s36, s24, 5
    s_mul_i32 s36, s36, 393216
    s_add_u32 s63, s63, s36
    s_add_u32 s36, s8, 15073280
    s_addc_u32 s37, s9, 0
    s_cmp_eq_u32 s3, 0
    s_cselect_b32 s36, s46, s36
    s_cselect_b32 s37, s47, s37
    s_cmp_lt_u32 s24, 4
    s_cselect_b32 s56, s4, s36
    s_cselect_b32 s57, s5, s37
    s_mov_b32 s58, 2621440
    s_cselect_b32 s58, 819200, s58
    s_mov_b32 s59, 0x00020000
    s_getpc_b64 s[48:49]
attn_pc:
    s_add_u32 s48, s48, tail_start - attn_pc
    s_addc_u32 s49, s49, 0
    s_lshl_b32 s36, s35, 8
    v_and_b32 v171, 1, v1
    v_lshl_add_u32 v171, v171, 7, s36
    v_min_u32 v171, code_end - tail_start - 4, v171
    s_cmp_lg_u32 s30, 0
    s_cbranch_scc1 aw_early
    s_cmp_lg_u32 s24, 4
    s_cbranch_scc1 aw_qgo
    s_cmp_lg_u32 s3, 0
    s_cbranch_scc1 aw_q1
    s_load_dwordx2 s[36:37], s[0:1], 72
    v_and_b32 v20, 15, v1
    v_lshlrev_b32 v20, 2, v20
    s_mov_b32 s35, 0
    s_waitcnt lgkmcnt(0)
aw_q0:
    global_load_dword v21, v20, s[36:37] offset:128 sc1
    s_add_u32 s35, s35, 1
    s_waitcnt vmcnt(0)
    v_cmp_eq_u32 vcc, 0, v21
    s_cmp_gt_u32 s35, 524288
    s_cbranch_scc1 aw_q1
    s_cmp_lg_u64 vcc, 0
    s_cbranch_scc1 aw_q0
aw_q1:
    s_mul_i32 s34, s25, 20
    s_add_u32 s35, s34, 19
    s_lshr_b32 s34, s34, 7
    s_lshr_b32 s35, s35, 7
    s_sub_u32 s35, s35, s34
    s_lshr_b32 s36, s2, 3
    s_and_b32 s36, s36, 3
    s_mul_i32 s36, s36, 1024
    s_mul_i32 s34, s34, 4096
    s_add_u32 s34, s34, s36
    s_add_u32 s34, s34, 21168128
    s_mul_i32 s36, s3, 262144
    s_sub_u32 s34, s34, s36
    s_mul_i32 s35, s35, 4096
    v_bfe_u32 v20, v1, 4, 1
    v_mul_lo_u32 v20, v20, s35
    v_lshrrev_b32 v21, 5, v1
    v_add_u32 v21, 1, v21
    v_mul_u32_u24 v21, 20480, v21
    v_and_b32 v22, 15, v1
    v_mul_u32_u24 v22, 32, v22
    v_add3_u32 v21, v21, v20, v22
    v_and_b32 v22, 1, v1
    s_lshl_b32 s36, s26, 1
    v_add_u32 v22, s36, v22
    v_mul_u32_u24 v22, 32, v22
    v_add_u32 v20, v20, v22
    v_mov_b32 v24, 159824
    s_mov_b32 s35, 0
aw_q2:
    ds_read_b32 v25, v24
    s_add_u32 s35, s35, 1
    s_waitcnt lgkmcnt(0)
    v_readfirstlane_b32 s36, v25
    s_cmp_gt_u32 s35, 524288
    s_cbranch_scc1 aw_q3
    s_cmp_ge_u32 s36, 4
    s_cbranch_scc1 aw_q3
    s_sleep 1
    s_branch aw_q2
aw_q3:
    s_and_b32 s36, s2, 0xe1
    s_cmp_lg_u32 s36, 0xe1
    s_cbranch_scc1 aw_q_px
    s_mov_b32 s35, 0
    s_mov_b64 exec, 1
aw_q_pw:
    s_sleep 8
    buffer_load_dword v22, v21, s[12:15], s34 offen sc1
    s_add_u32 s35, s35, 1
    s_waitcnt vmcnt(0)
    v_cmp_eq_u32 vcc, 0, v22
    s_cmp_gt_u32 s35, 524288
    s_cbranch_scc1 aw_q_py
    s_cmp_lg_u64 vcc, 0
    s_cbranch_scc1 aw_q_pw
aw_q_py:
    s_mov_b64 exec, -1
    s_branch aw_q_nod
aw_q_px:
    s_sleep 20
aw_q_nod:
    s_mov_b32 s35, 0
aw_qwait:
    buffer_load_dword v22, v21, s[12:15], s34 offen sc1
    buffer_load_dword v23, v20, s[12:15], s34 offen sc1
    s_add_u32 s35, s35, 1
    s_waitcnt vmcnt(0)
    v_and_b32 v22, v22, v23
    v_cmp_eq_u32 vcc, 0, v22
    s_cmp_gt_u32 s35, 524288
    s_cbranch_scc1 aw_qx
    s_and_b64 exec, exec, vcc
    s_cbranch_scc1 aw_qwait
aw_qx:
    s_mov_b64 exec, -1
aw_qgo:
    s_barrier
aw_early:
    buffer_load_dwordx4 v[24:27], v5, s[12:15], s31 offen sc1
    buffer_load_dwordx2 v[18:19], v6, s[12:15], s31 offen offset:1024 sc1
    buffer_load_dwordx4 v[44:47], v5, s[12:15], s40 offen offset:0 sc1
    buffer_load_dwordx2 v[52:53], v6, s[12:15], s40 offen offset:1024 sc1
    buffer_load_dwordx4 v[48:51], v5, s[12:15], s40 offen offset:1280 sc1
    buffer_load_dwordx2 v[54:55], v6, s[12:15], s40 offen offset:2304 sc1
    s_mov_b32 m0, s42
    s_add_u32 s42, s42, 4096
    buffer_load_dwordx4 v5, s[12:15], s43 offen sc1 lds
    s_add_u32 s43, s43, 4096
    s_mov_b32 m0, s42
    s_add_u32 s42, s42, 4096
    buffer_load_dwordx4 v5, s[12:15], s43 offen sc1 lds
    s_add_u32 s43, s43, 4096
    s_mov_b32 m0, s42
    s_add_u32 s42, s42, 4096
    buffer_load_dwordx4 v5, s[12:15], s43 offen sc1 lds
    s_add_u32 s43, s43, 4096
    s_mov_b32 s29, 1
    s_waitcnt vmcnt(3)
    s_cmp_eq_u32 s30, 0
    s_cbranch_scc1 attn_maxgo
attn_fill:
    s_mov_b32 m0, s42
    s_add_u32 s42, s42, 4096
    buffer_load_dwordx4 v5, s[12:15], s43 offen sc1 lds
    s_add_u32 s43, s43, 4096
    s_add_u32 s29, s29, 1
    s_cmp_lt_u32 s29, 18
    s_cbranch_scc1 attn_fill
    v_mov_b32 v2, v5
    v_lshlrev_b32 v3, 3, v8
    v_add_u32 v3, 1024, v3
    s_waitcnt vmcnt(0)
    s_barrier
    s_mov_b32 s29, 64
attn_maxloop:
    ds_read_b64 v[18:19], v3
    ds_read_b128 v[24:27], v2
    v_add_u32 v3, 2560, v3
    v_add_u32 v2, 2560, v2
    s_waitcnt lgkmcnt(0)
attn_maxgo:
    v_mfma_f32_32x32x8_bf16 v[104:119], v[18:19], v[52:53], 0
    v_mfma_f32_32x32x8_bf16 v[120:135], v[18:19], v[54:55], 0
    s_nop 8
    v_mfma_f32_32x32x16_bf16 v[104:119], v[24:27], v[44:47], v[104:119]
    v_mfma_f32_32x32x16_bf16 v[120:135], v[24:27], v[48:51], v[120:135]
    s_nop 10
    v_max3_f32 v72, v104, v105, v72
    v_max3_f32 v72, v106, v107, v72
    v_max3_f32 v72, v108, v109, v72
    v_max3_f32 v72, v110, v111, v72
    v_max3_f32 v72, v112, v113, v72
    v_max3_f32 v72, v114, v115, v72
    v_max3_f32 v72, v116, v117, v72
    v_max3_f32 v72, v118, v119, v72
    v_max3_f32 v88, v120, v121, v88
    v_max3_f32 v88, v122, v123, v88
    v_max3_f32 v88, v124, v125, v88
    v_max3_f32 v88, v126, v127, v88
    v_max3_f32 v88, v128, v129, v88
    v_max3_f32 v88, v130, v131, v88
    v_max3_f32 v88, v132, v133, v88
    v_max3_f32 v88, v134, v135, v88
    s_sub_u32 s29, s29, 1
    s_cmp_lg_u32 s29, 0
    s_cbranch_scc1 attn_maxloop
    v_add_u32 v2, s41, v5
    v_lshlrev_b32 v3, 3, v8
    v_add_u32 v3, 1024, v3
    v_add_u32 v3, s41, v3
    v_mov_b32 v73, v72
    v_mov_b32 v89, v88
    s_nop 1
    v_permlane32_swap_b32 v72, v73
    v_permlane32_swap_b32 v88, v89
    s_nop 1
    v_max_f32 v72, v72, v73
    v_sub_f32 v72, 0, v72
    v_max_f32 v88, v88, v89
    v_sub_f32 v88, 0, v88
    s_waitcnt vmcnt(0)
    s_barrier
    ds_read_b64 v[16:17], v3
    ds_read_b128 v[20:23], v2
    v_mov_b32 v73, v72
    v_mov_b32 v74, v72
    v_mov_b32 v75, v72
    v_mov_b32 v76, v72
    v_mov_b32 v77, v72
    v_mov_b32 v78, v72
    v_mov_b32 v79, v72
    v_mov_b32 v80, v72
    v_mov_b32 v81, v72
    v_mov_b32 v82, v72
    v_mov_b32 v83, v72
    v_mov_b32 v84, v72
    v_mov_b32 v85, v72
    v_mov_b32 v86, v72
    v_mov_b32 v87, v72
    s_nop 0
    s_waitcnt lgkmcnt(0)
    v_mfma_f32_32x32x8_bf16 v[104:119], v[16:17], v[52:53], v[72:87]
    v_mov_b32 v89, v88
    v_mov_b32 v90, v88
    v_mov_b32 v91, v88
    v_mov_b32 v92, v88
    v_mov_b32 v93, v88
    v_mov_b32 v94, v88
    v_mov_b32 v95, v88
    v_mov_b32 v96, v88
    v_mov_b32 v97, v88
    v_mov_b32 v98, v88
    v_mov_b32 v99, v88
    v_mov_b32 v100, v88
    v_mov_b32 v101, v88
    v_mov_b32 v102, v88
    v_mov_b32 v103, v88
    v_mfma_f32_32x32x16_bf16 v[104:119], v[20:23], v[44:47], v[104:119]
    s_nop 6
    s_mov_b32 s29, 0
    s_or_b32 s36, s30, s27
    s_cmp_lg_u32 s36, 0
    s_cbranch_scc1 attn_loop
    s_mov_b32 m0, s42
    s_add_u32 s42, s42, 4096
    buffer_load_dwordx4 v5, s[12:15], s43 offen sc1 lds
    s_add_u32 s43, s43, 4096
    s_add_u32 m0, s42, 81920-4096
    s_add_u32 s44, s43, 81920-4096
    buffer_load_dwordx4 v5, s[12:15], s44 offen sc1 lds
    s_setprio 3
    v_mfma_f32_32x32x8_bf16 v[120:135], v[16:17], v[54:55], v[88:103]
    ds_read_b64 v[18:19], v3 offset:2560
    ds_read_b128 v[24:27], v2 offset:2560
    s_mov_b32 m0, s42
    s_add_u32 s42, s42, 4096
    buffer_load_dwordx4 v5, s[12:15], s43 offen sc1 lds
    s_add_u32 s43, s43, 4096
    v_cvt_pk_bf16_f32 v71, v12, v13
    v_exp_f32 v10, v104
    v_exp_f32 v11, v105
    v_exp_f32 v12, v106
    v_cvt_pk_bf16_f32 v56, v10, v11
    v_exp_f32 v13, v107
    v_mfma_f32_32x32x16_bf16 v[152:167], v[36:39], v[64:67], v[152:167]
    s_mov_b64 exec, s[32:33]
    ds_read_b128 v[28:31], v4 offset:0
    ds_read_b128 v[32:35], v4 offset:640
    s_mov_b64 exec, -1
    s_add_u32 m0, s42, 81920-4096
    s_add_u32 s44, s43, 81920-4096
    buffer_load_dwordx4 v5, s[12:15], s44 offen sc1 lds
    v_exp_f32 v10, v108
    v_cvt_pk_bf16_f32 v57, v12, v13
    v_exp_f32 v11, v109
    v_exp_f32 v12, v110
    v_cvt_pk_bf16_f32 v58, v10, v11
    v_exp_f32 v13, v111
    v_mfma_f32_32x32x16_bf16 v[120:135], v[20:23], v[48:51], v[120:135]
    s_mov_b32 m0, s42
    s_add_u32 s42, s42, 4096
    buffer_load_dwordx4 v5, s[12:15], s43 offen sc1 lds
    s_add_u32 s43, s43, 4096
    v_exp_f32 v10, v112
    v_cvt_pk_bf16_f32 v59, v12, v13
    v_exp_f32 v11, v113
    v_exp_f32 v12, v114
    v_cvt_pk_bf16_f32 v60, v10, v11
    v_exp_f32 v13, v115
    v_mfma_f32_32x32x16_bf16 v[152:167], v[40:43], v[68:71], v[152:167]
    s_add_u32 m0, s42, 81920-4096
    s_add_u32 s44, s43, 81920-4096
    buffer_load_dwordx4 v5, s[12:15], s44 offen sc1 lds
    v_exp_f32 v10, v116
    v_cvt_pk_bf16_f32 v61, v12, v13
    v_exp_f32 v11, v117
    v_exp_f32 v12, v118
    v_cvt_pk_bf16_f32 v62, v10, v11
    v_exp_f32 v13, v119
    s_waitcnt lgkmcnt(0)
    v_mfma_f32_32x32x8_bf16 v[104:119], v[18:19], v[52:53], v[72:87]
    s_mov_b32 m0, s42
    s_add_u32 s42, s42, 4096
    buffer_load_dwordx4 v5, s[12:15], s43 offen sc1 lds
    s_add_u32 s43, s43, 4096
    v_cvt_pk_bf16_f32 v63, v12, v13
    v_exp_f32 v10, v120
    v_exp_f32 v11, v121
    v_exp_f32 v12, v122
    v_cvt_pk_bf16_f32 v64, v10, v11
    v_exp_f32 v13, v123
    v_mfma_f32_32x32x16_bf16 v[136:151], v[28:31], v[56:59], v[136:151]
    s_add_u32 m0, s42, 81920-4096
    s_add_u32 s44, s43, 81920-4096
    buffer_load_dwordx4 v5, s[12:15], s44 offen sc1 lds
    v_exp_f32 v10, v124
    v_cvt_pk_bf16_f32 v65, v12, v13
    v_exp_f32 v11, v125
    v_exp_f32 v12, v126
    v_cvt_pk_bf16_f32 v66, v10, v11
    v_exp_f32 v13, v127
    v_mfma_f32_32x32x16_bf16 v[104:119], v[24:27], v[44:47], v[104:119]
    s_mov_b32 m0, s42
    s_add_u32 s42, s42, 4096
    buffer_load_dwordx4 v5, s[12:15], s43 offen sc1 lds
    s_add_u32 s43, s43, 4096
    v_exp_f32 v10, v128
    v_cvt_pk_bf16_f32 v67, v12, v13
    v_exp_f32 v11, v129
    v_exp_f32 v12, v130
    v_cvt_pk_bf16_f32 v68, v10, v11
    v_exp_f32 v13, v131
    v_mfma_f32_32x32x16_bf16 v[136:151], v[32:35], v[60:63], v[136:151]
    s_add_u32 m0, s42, 81920-4096
    s_add_u32 s44, s43, 81920-4096
    buffer_load_dwordx4 v5, s[12:15], s44 offen sc1 lds
    v_exp_f32 v10, v132
    v_cvt_pk_bf16_f32 v69, v12, v13
    v_exp_f32 v11, v133
    v_exp_f32 v12, v134
    v_cvt_pk_bf16_f32 v70, v10, v11
    v_exp_f32 v13, v135
    v_mfma_f32_32x32x8_bf16 v[120:135], v[18:19], v[54:55], v[88:103]
    ds_read_b64 v[16:17], v3 offset:5120
    ds_read_b128 v[20:23], v2 offset:5120
    s_mov_b32 m0, s42
    s_add_u32 s42, s42, 4096
    buffer_load_dwordx4 v5, s[12:15], s43 offen sc1 lds
    s_add_u32 s43, s43, 4096
    v_cvt_pk_bf16_f32 v71, v12, v13
    v_exp_f32 v10, v104
    v_exp_f32 v11, v105
    v_exp_f32 v12, v106
    v_cvt_pk_bf16_f32 v56, v10, v11
    v_exp_f32 v13, v107
    v_mfma_f32_32x32x16_bf16 v[152:167], v[28:31], v[64:67], v[152:167]
    s_mov_b64 exec, s[32:33]
    ds_read_b128 v[36:39], v4 offset:2560
    ds_read_b128 v[40:43], v4 offset:3200
    s_mov_b64 exec, -1
    s_add_u32 m0, s42, 81920-4096
    s_add_u32 s44, s43, 81920-4096
    buffer_load_dwordx4 v5, s[12:15], s44 offen sc1 lds
    v_exp_f32 v10, v108
    v_cvt_pk_bf16_f32 v57, v12, v13
    v_exp_f32 v11, v109
    v_exp_f32 v12, v110
    v_cvt_pk_bf16_f32 v58, v10, v11
    v_exp_f32 v13, v111
    v_mfma_f32_32x32x16_bf16 v[120:135], v[24:27], v[48:51], v[120:135]
    s_mov_b32 m0, s42
    s_add_u32 s42, s42, 4096
    buffer_load_dwordx4 v5, s[12:15], s43 offen sc1 lds
    s_add_u32 s43, s43, 4096
    v_exp_f32 v10, v112
    v_cvt_pk_bf16_f32 v59, v12, v13
    v_exp_f32 v11, v113
    v_exp_f32 v12, v114
    v_cvt_pk_bf16_f32 v60, v10, v11
    v_exp_f32 v13, v115
    v_mfma_f32_32x32x16_bf16 v[152:167], v[32:35], v[68:71], v[152:167]
    s_add_u32 m0, s42, 81920-4096
    s_add_u32 s44, s43, 81920-4096
    buffer_load_dwordx4 v5, s[12:15], s44 offen sc1 lds
    v_exp_f32 v10, v116
    v_cvt_pk_bf16_f32 v61, v12, v13
    v_exp_f32 v11, v117
    v_exp_f32 v12, v118
    v_cvt_pk_bf16_f32 v62, v10, v11
    v_exp_f32 v13, v119
    s_waitcnt lgkmcnt(0)
    v_mfma_f32_32x32x8_bf16 v[104:119], v[16:17], v[52:53], v[72:87]
    s_mov_b32 m0, s42
    s_add_u32 s42, s42, 4096
    buffer_load_dwordx4 v5, s[12:15], s43 offen sc1 lds
    s_add_u32 s43, s43, 4096
    v_cvt_pk_bf16_f32 v63, v12, v13
    v_exp_f32 v10, v120
    v_exp_f32 v11, v121
    v_exp_f32 v12, v122
    v_cvt_pk_bf16_f32 v64, v10, v11
    v_exp_f32 v13, v123
    v_mfma_f32_32x32x16_bf16 v[136:151], v[36:39], v[56:59], v[136:151]
    s_add_u32 m0, s42, 81920-4096
    s_add_u32 s44, s43, 81920-4096
    buffer_load_dwordx4 v5, s[12:15], s44 offen sc1 lds
    v_exp_f32 v10, v124
    v_cvt_pk_bf16_f32 v65, v12, v13
    v_exp_f32 v11, v125
    v_exp_f32 v12, v126
    v_cvt_pk_bf16_f32 v66, v10, v11
    v_exp_f32 v13, v127
    v_mfma_f32_32x32x16_bf16 v[104:119], v[20:23], v[44:47], v[104:119]
    s_mov_b32 m0, s42
    s_add_u32 s42, s42, 4096
    buffer_load_dwordx4 v5, s[12:15], s43 offen sc1 lds
    s_add_u32 s43, s43, 4096
    v_exp_f32 v10, v128
    v_cvt_pk_bf16_f32 v67, v12, v13
    v_exp_f32 v11, v129
    v_exp_f32 v12, v130
    v_cvt_pk_bf16_f32 v68, v10, v11
    v_exp_f32 v13, v131
    v_mfma_f32_32x32x16_bf16 v[136:151], v[40:43], v[60:63], v[136:151]
    s_add_u32 m0, s42, 81920-4096
    s_add_u32 s44, s43, 81920-4096
    buffer_load_dwordx4 v5, s[12:15], s44 offen sc1 lds
    v_exp_f32 v10, v132
    v_cvt_pk_bf16_f32 v69, v12, v13
    v_exp_f32 v11, v133
    v_exp_f32 v12, v134
    v_cvt_pk_bf16_f32 v70, v10, v11
    v_exp_f32 v13, v135
    v_mfma_f32_32x32x8_bf16 v[120:135], v[16:17], v[54:55], v[88:103]
    ds_read_b64 v[18:19], v3 offset:7680
    ds_read_b128 v[24:27], v2 offset:7680
    s_mov_b32 m0, s42
    s_add_u32 s42, s42, 4096
    buffer_load_dwordx4 v5, s[12:15], s43 offen sc1 lds
    s_add_u32 s43, s43, 4096
    v_cvt_pk_bf16_f32 v71, v12, v13
    v_exp_f32 v10, v104
    v_exp_f32 v11, v105
    v_exp_f32 v12, v106
    v_cvt_pk_bf16_f32 v56, v10, v11
    v_exp_f32 v13, v107
    v_mfma_f32_32x32x16_bf16 v[152:167], v[36:39], v[64:67], v[152:167]
    s_mov_b64 exec, s[32:33]
    ds_read_b128 v[28:31], v4 offset:5120
    ds_read_b128 v[32:35], v4 offset:5760
    s_mov_b64 exec, -1
    s_add_u32 m0, s42, 81920-4096
    s_add_u32 s44, s43, 81920-4096
    buffer_load_dwordx4 v5, s[12:15], s44 offen sc1 lds
    v_exp_f32 v10, v108
    v_cvt_pk_bf16_f32 v57, v12, v13
    v_exp_f32 v11, v109
    v_exp_f32 v12, v110
    v_cvt_pk_bf16_f32 v58, v10, v11
    v_exp_f32 v13, v111
    v_mfma_f32_32x32x16_bf16 v[120:135], v[20:23], v[48:51], v[120:135]
    s_mov_b32 m0, s42
    s_add_u32 s42, s42, 4096
    buffer_load_dwordx4 v5, s[12:15], s43 offen sc1 lds
    s_add_u32 s43, s43, 4096
    v_exp_f32 v10, v112
    v_cvt_pk_bf16_f32 v59, v12, v13
    v_exp_f32 v11, v113
    v_exp_f32 v12, v114
    v_cvt_pk_bf16_f32 v60, v10, v11
    v_exp_f32 v13, v115
    v_mfma_f32_32x32x16_bf16 v[152:167], v[40:43], v[68:71], v[152:167]
    s_add_u32 m0, s42, 81920-4096
    s_add_u32 s44, s43, 81920-4096
    buffer_load_dwordx4 v5, s[12:15], s44 offen sc1 lds
    v_exp_f32 v10, v116
    v_cvt_pk_bf16_f32 v61, v12, v13
    v_exp_f32 v11, v117
    v_exp_f32 v12, v118
    v_cvt_pk_bf16_f32 v62, v10, v11
    v_exp_f32 v13, v119
    s_waitcnt lgkmcnt(0)
    v_mfma_f32_32x32x8_bf16 v[104:119], v[18:19], v[52:53], v[72:87]
    s_mov_b32 m0, s42
    s_add_u32 s42, s42, 4096
    buffer_load_dwordx4 v5, s[12:15], s43 offen sc1 lds
    s_add_u32 s43, s43, 4096
    v_cvt_pk_bf16_f32 v63, v12, v13
    v_exp_f32 v10, v120
    v_exp_f32 v11, v121
    v_exp_f32 v12, v122
    v_cvt_pk_bf16_f32 v64, v10, v11
    v_exp_f32 v13, v123
    v_mfma_f32_32x32x16_bf16 v[136:151], v[28:31], v[56:59], v[136:151]
    s_add_u32 m0, s42, 81920-4096
    s_add_u32 s44, s43, 81920-4096
    buffer_load_dwordx4 v5, s[12:15], s44 offen sc1 lds
    v_exp_f32 v10, v124
    v_cvt_pk_bf16_f32 v65, v12, v13
    v_exp_f32 v11, v125
    v_exp_f32 v12, v126
    v_cvt_pk_bf16_f32 v66, v10, v11
    v_exp_f32 v13, v127
    v_mfma_f32_32x32x16_bf16 v[104:119], v[24:27], v[44:47], v[104:119]
    s_mov_b32 m0, s42
    s_add_u32 s42, s42, 4096
    buffer_load_dwordx4 v5, s[12:15], s43 offen sc1 lds
    s_add_u32 s43, s43, 4096
    v_exp_f32 v10, v128
    v_cvt_pk_bf16_f32 v67, v12, v13
    v_exp_f32 v11, v129
    v_exp_f32 v12, v130
    v_cvt_pk_bf16_f32 v68, v10, v11
    v_exp_f32 v13, v131
    v_mfma_f32_32x32x16_bf16 v[136:151], v[32:35], v[60:63], v[136:151]
    s_add_u32 m0, s42, 81920-4096
    s_add_u32 s44, s43, 81920-4096
    buffer_load_dwordx4 v5, s[12:15], s44 offen sc1 lds
    v_exp_f32 v10, v132
    v_cvt_pk_bf16_f32 v69, v12, v13
    v_exp_f32 v11, v133
    v_exp_f32 v12, v134
    v_cvt_pk_bf16_f32 v70, v10, v11
    v_exp_f32 v13, v135
    v_mfma_f32_32x32x8_bf16 v[120:135], v[18:19], v[54:55], v[88:103]
    ds_read_b64 v[16:17], v3 offset:10240
    ds_read_b128 v[20:23], v2 offset:10240
    s_mov_b32 m0, s42
    s_add_u32 s42, s42, 4096
    buffer_load_dwordx4 v5, s[12:15], s43 offen sc1 lds
    s_add_u32 s43, s43, 4096
    v_cvt_pk_bf16_f32 v71, v12, v13
    v_exp_f32 v10, v104
    v_exp_f32 v11, v105
    v_exp_f32 v12, v106
    v_cvt_pk_bf16_f32 v56, v10, v11
    v_exp_f32 v13, v107
    v_mfma_f32_32x32x16_bf16 v[152:167], v[28:31], v[64:67], v[152:167]
    s_mov_b64 exec, s[32:33]
    ds_read_b128 v[36:39], v4 offset:7680
    ds_read_b128 v[40:43], v4 offset:8320
    s_mov_b64 exec, -1
    s_add_u32 m0, s42, 81920-4096
    s_add_u32 s44, s43, 81920-4096
    buffer_load_dwordx4 v5, s[12:15], s44 offen sc1 lds
    v_exp_f32 v10, v108
    v_cvt_pk_bf16_f32 v57, v12, v13
    v_exp_f32 v11, v109
    v_exp_f32 v12, v110
    v_cvt_pk_bf16_f32 v58, v10, v11
    v_exp_f32 v13, v111
    v_mfma_f32_32x32x16_bf16 v[120:135], v[24:27], v[48:51], v[120:135]
    s_mov_b32 m0, s42
    s_add_u32 s42, s42, 4096
    buffer_load_dwordx4 v5, s[12:15], s43 offen sc1 lds
    s_add_u32 s43, s43, 4096
    v_exp_f32 v10, v112
    v_cvt_pk_bf16_f32 v59, v12, v13
    v_exp_f32 v11, v113
    v_exp_f32 v12, v114
    v_cvt_pk_bf16_f32 v60, v10, v11
    v_exp_f32 v13, v115
    v_mfma_f32_32x32x16_bf16 v[152:167], v[32:35], v[68:71], v[152:167]
    s_add_u32 m0, s42, 81920-4096
    s_add_u32 s44, s43, 81920-4096
    buffer_load_dwordx4 v5, s[12:15], s44 offen sc1 lds
    v_exp_f32 v10, v116
    v_cvt_pk_bf16_f32 v61, v12, v13
    v_exp_f32 v11, v117
    v_exp_f32 v12, v118
    v_cvt_pk_bf16_f32 v62, v10, v11
    v_exp_f32 v13, v119
    s_waitcnt lgkmcnt(0)
    v_mfma_f32_32x32x8_bf16 v[104:119], v[16:17], v[52:53], v[72:87]
    s_mov_b32 m0, s42
    s_add_u32 s42, s42, 4096
    buffer_load_dwordx4 v5, s[12:15], s43 offen sc1 lds
    s_add_u32 s43, s43, 4096
    v_cvt_pk_bf16_f32 v63, v12, v13
    v_exp_f32 v10, v120
    v_exp_f32 v11, v121
    v_exp_f32 v12, v122
    v_cvt_pk_bf16_f32 v64, v10, v11
    v_exp_f32 v13, v123
    v_mfma_f32_32x32x16_bf16 v[136:151], v[36:39], v[56:59], v[136:151]
    s_add_u32 m0, s42, 81920-4096
    s_add_u32 s44, s43, 81920-4096
    buffer_load_dwordx4 v5, s[12:15], s44 offen sc1 lds
    v_exp_f32 v10, v124
    v_cvt_pk_bf16_f32 v65, v12, v13
    v_exp_f32 v11, v125
    v_exp_f32 v12, v126
    v_cvt_pk_bf16_f32 v66, v10, v11
    v_exp_f32 v13, v127
    v_mfma_f32_32x32x16_bf16 v[104:119], v[20:23], v[44:47], v[104:119]
    s_mov_b32 m0, s42
    s_add_u32 s42, s42, 4096
    buffer_load_dwordx4 v5, s[12:15], s43 offen sc1 lds
    s_add_u32 s43, s43, 4096
    v_exp_f32 v10, v128
    v_cvt_pk_bf16_f32 v67, v12, v13
    v_exp_f32 v11, v129
    v_exp_f32 v12, v130
    v_cvt_pk_bf16_f32 v68, v10, v11
    v_exp_f32 v13, v131
    v_mfma_f32_32x32x16_bf16 v[136:151], v[40:43], v[60:63], v[136:151]
    s_add_u32 m0, s42, 81920-4096
    s_add_u32 s44, s43, 81920-4096
    buffer_load_dwordx4 v5, s[12:15], s44 offen sc1 lds
    v_exp_f32 v10, v132
    v_cvt_pk_bf16_f32 v69, v12, v13
    v_exp_f32 v11, v133
    v_exp_f32 v12, v134
    v_cvt_pk_bf16_f32 v70, v10, v11
    v_exp_f32 v13, v135
    v_add_u32 v2, 10240, v2
    v_add_u32 v3, 10240, v3
    v_add_u32 v4, 10240, v4
    s_add_u32 s29, s29, 1
    s_branch attn_bar
.p2align 3
attn_loop:
    s_setprio 2
    v_mfma_f32_32x32x8_bf16 v[120:135], v[16:17], v[54:55], v[88:103]
    ds_read_b64 v[18:19], v3 offset:2560
    ds_read_b128 v[24:27], v2 offset:2560
    v_cvt_pk_bf16_f32 v71, v12, v13
    v_exp_f32 v10, v104
    v_exp_f32 v11, v105
    v_exp_f32 v12, v106
    v_cvt_pk_bf16_f32 v56, v10, v11
    v_exp_f32 v13, v107
    v_mfma_f32_32x32x16_bf16 v[152:167], v[36:39], v[64:67], v[152:167]
    s_mov_b64 exec, s[32:33]
    ds_read_b128 v[28:31], v4 offset:0
    ds_read_b128 v[32:35], v4 offset:640
    s_mov_b64 exec, -1
    v_exp_f32 v10, v108
    v_cvt_pk_bf16_f32 v57, v12, v13
    v_exp_f32 v11, v109
    v_exp_f32 v12, v110
    v_cvt_pk_bf16_f32 v58, v10, v11
    v_exp_f32 v13, v111
    v_mfma_f32_32x32x16_bf16 v[120:135], v[20:23], v[48:51], v[120:135]
    v_exp_f32 v10, v112
    v_cvt_pk_bf16_f32 v59, v12, v13
    v_exp_f32 v11, v113
    v_exp_f32 v12, v114
    v_cvt_pk_bf16_f32 v60, v10, v11
    v_exp_f32 v13, v115
    v_mfma_f32_32x32x16_bf16 v[152:167], v[40:43], v[68:71], v[152:167]
    v_exp_f32 v10, v116
    v_cvt_pk_bf16_f32 v61, v12, v13
    v_exp_f32 v11, v117
    v_exp_f32 v12, v118
    v_cvt_pk_bf16_f32 v62, v10, v11
    v_exp_f32 v13, v119
    s_waitcnt lgkmcnt(0)
    v_mfma_f32_32x32x8_bf16 v[104:119], v[18:19], v[52:53], v[72:87]
    v_cvt_pk_bf16_f32 v63, v12, v13
    v_exp_f32 v10, v120
    v_exp_f32 v11, v121
    v_exp_f32 v12, v122
    v_cvt_pk_bf16_f32 v64, v10, v11
    v_exp_f32 v13, v123
    v_mfma_f32_32x32x16_bf16 v[136:151], v[28:31], v[56:59], v[136:151]
    v_exp_f32 v10, v124
    v_cvt_pk_bf16_f32 v65, v12, v13
    v_exp_f32 v11, v125
    v_exp_f32 v12, v126
    v_cvt_pk_bf16_f32 v66, v10, v11
    v_exp_f32 v13, v127
    v_mfma_f32_32x32x16_bf16 v[104:119], v[24:27], v[44:47], v[104:119]
    v_exp_f32 v10, v128
    v_cvt_pk_bf16_f32 v67, v12, v13
    v_exp_f32 v11, v129
    v_exp_f32 v12, v130
    v_cvt_pk_bf16_f32 v68, v10, v11
    v_exp_f32 v13, v131
    v_mfma_f32_32x32x16_bf16 v[136:151], v[32:35], v[60:63], v[136:151]
    v_exp_f32 v10, v132
    v_cvt_pk_bf16_f32 v69, v12, v13
    v_exp_f32 v11, v133
    v_exp_f32 v12, v134
    v_cvt_pk_bf16_f32 v70, v10, v11
    v_exp_f32 v13, v135
    v_mfma_f32_32x32x8_bf16 v[120:135], v[18:19], v[54:55], v[88:103]
    ds_read_b64 v[16:17], v3 offset:5120
    ds_read_b128 v[20:23], v2 offset:5120
    v_cvt_pk_bf16_f32 v71, v12, v13
    v_exp_f32 v10, v104
    v_exp_f32 v11, v105
    v_exp_f32 v12, v106
    v_cvt_pk_bf16_f32 v56, v10, v11
    v_exp_f32 v13, v107
    v_mfma_f32_32x32x16_bf16 v[152:167], v[28:31], v[64:67], v[152:167]
    s_mov_b64 exec, s[32:33]
    ds_read_b128 v[36:39], v4 offset:2560
    ds_read_b128 v[40:43], v4 offset:3200
    s_mov_b64 exec, -1
    v_exp_f32 v10, v108
    v_cvt_pk_bf16_f32 v57, v12, v13
    v_exp_f32 v11, v109
    v_exp_f32 v12, v110
    v_cvt_pk_bf16_f32 v58, v10, v11
    v_exp_f32 v13, v111
    v_mfma_f32_32x32x16_bf16 v[120:135], v[24:27], v[48:51], v[120:135]
    v_exp_f32 v10, v112
    v_cvt_pk_bf16_f32 v59, v12, v13
    v_exp_f32 v11, v113
    v_exp_f32 v12, v114
    v_cvt_pk_bf16_f32 v60, v10, v11
    v_exp_f32 v13, v115
    v_mfma_f32_32x32x16_bf16 v[152:167], v[32:35], v[68:71], v[152:167]
    v_exp_f32 v10, v116
    v_cvt_pk_bf16_f32 v61, v12, v13
    v_exp_f32 v11, v117
    v_exp_f32 v12, v118
    v_cvt_pk_bf16_f32 v62, v10, v11
    v_exp_f32 v13, v119
    s_waitcnt lgkmcnt(0)
    v_mfma_f32_32x32x8_bf16 v[104:119], v[16:17], v[52:53], v[72:87]
    v_cvt_pk_bf16_f32 v63, v12, v13
    v_exp_f32 v10, v120
    v_exp_f32 v11, v121
    v_exp_f32 v12, v122
    v_cvt_pk_bf16_f32 v64, v10, v11
    v_exp_f32 v13, v123
    v_mfma_f32_32x32x16_bf16 v[136:151], v[36:39], v[56:59], v[136:151]
    v_exp_f32 v10, v124
    v_cvt_pk_bf16_f32 v65, v12, v13
    v_exp_f32 v11, v125
    v_exp_f32 v12, v126
    v_cvt_pk_bf16_f32 v66, v10, v11
    v_exp_f32 v13, v127
    v_mfma_f32_32x32x16_bf16 v[104:119], v[20:23], v[44:47], v[104:119]
    v_exp_f32 v10, v128
    v_cvt_pk_bf16_f32 v67, v12, v13
    v_exp_f32 v11, v129
    v_exp_f32 v12, v130
    v_cvt_pk_bf16_f32 v68, v10, v11
    v_exp_f32 v13, v131
    v_mfma_f32_32x32x16_bf16 v[136:151], v[40:43], v[60:63], v[136:151]
    v_exp_f32 v10, v132
    v_cvt_pk_bf16_f32 v69, v12, v13
    v_exp_f32 v11, v133
    v_exp_f32 v12, v134
    v_cvt_pk_bf16_f32 v70, v10, v11
    v_exp_f32 v13, v135
    v_mfma_f32_32x32x8_bf16 v[120:135], v[16:17], v[54:55], v[88:103]
    ds_read_b64 v[18:19], v3 offset:7680
    ds_read_b128 v[24:27], v2 offset:7680
    v_cvt_pk_bf16_f32 v71, v12, v13
    v_exp_f32 v10, v104
    v_exp_f32 v11, v105
    v_exp_f32 v12, v106
    v_cvt_pk_bf16_f32 v56, v10, v11
    v_exp_f32 v13, v107
    v_mfma_f32_32x32x16_bf16 v[152:167], v[36:39], v[64:67], v[152:167]
    s_mov_b64 exec, s[32:33]
    ds_read_b128 v[28:31], v4 offset:5120
    ds_read_b128 v[32:35], v4 offset:5760
    s_mov_b64 exec, -1
    v_exp_f32 v10, v108
    v_cvt_pk_bf16_f32 v57, v12, v13
    v_exp_f32 v11, v109
    v_exp_f32 v12, v110
    v_cvt_pk_bf16_f32 v58, v10, v11
    v_exp_f32 v13, v111
    v_mfma_f32_32x32x16_bf16 v[120:135], v[20:23], v[48:51], v[120:135]
    v_exp_f32 v10, v112
    v_cvt_pk_bf16_f32 v59, v12, v13
    v_exp_f32 v11, v113
    v_exp_f32 v12, v114
    v_cvt_pk_bf16_f32 v60, v10, v11
    v_exp_f32 v13, v115
    v_mfma_f32_32x32x16_bf16 v[152:167], v[40:43], v[68:71], v[152:167]
    v_exp_f32 v10, v116
    v_cvt_pk_bf16_f32 v61, v12, v13
    v_exp_f32 v11, v117
    v_exp_f32 v12, v118
    v_cvt_pk_bf16_f32 v62, v10, v11
    v_exp_f32 v13, v119
    s_waitcnt lgkmcnt(0)
    v_mfma_f32_32x32x8_bf16 v[104:119], v[18:19], v[52:53], v[72:87]
    v_cvt_pk_bf16_f32 v63, v12, v13
    v_exp_f32 v10, v120
    v_exp_f32 v11, v121
    v_exp_f32 v12, v122
    v_cvt_pk_bf16_f32 v64, v10, v11
    v_exp_f32 v13, v123
    v_mfma_f32_32x32x16_bf16 v[136:151], v[28:31], v[56:59], v[136:151]
    v_exp_f32 v10, v124
    v_cvt_pk_bf16_f32 v65, v12, v13
    v_exp_f32 v11, v125
    v_exp_f32 v12, v126
    v_cvt_pk_bf16_f32 v66, v10, v11
    v_exp_f32 v13, v127
    v_mfma_f32_32x32x16_bf16 v[104:119], v[24:27], v[44:47], v[104:119]
    v_exp_f32 v10, v128
    v_cvt_pk_bf16_f32 v67, v12, v13
    v_exp_f32 v11, v129
    v_exp_f32 v12, v130
    v_cvt_pk_bf16_f32 v68, v10, v11
    v_exp_f32 v13, v131
    v_mfma_f32_32x32x16_bf16 v[136:151], v[32:35], v[60:63], v[136:151]
    v_exp_f32 v10, v132
    v_cvt_pk_bf16_f32 v69, v12, v13
    v_exp_f32 v11, v133
    v_exp_f32 v12, v134
    v_cvt_pk_bf16_f32 v70, v10, v11
    v_exp_f32 v13, v135
    v_mfma_f32_32x32x8_bf16 v[120:135], v[18:19], v[54:55], v[88:103]
    ds_read_b64 v[16:17], v3 offset:10240
    ds_read_b128 v[20:23], v2 offset:10240
    v_cvt_pk_bf16_f32 v71, v12, v13
    v_exp_f32 v10, v104
    v_exp_f32 v11, v105
    v_exp_f32 v12, v106
    v_cvt_pk_bf16_f32 v56, v10, v11
    v_exp_f32 v13, v107
    v_mfma_f32_32x32x16_bf16 v[152:167], v[28:31], v[64:67], v[152:167]
    s_mov_b64 exec, s[32:33]
    ds_read_b128 v[36:39], v4 offset:7680
    ds_read_b128 v[40:43], v4 offset:8320
    s_mov_b64 exec, -1
    v_exp_f32 v10, v108
    v_cvt_pk_bf16_f32 v57, v12, v13
    v_exp_f32 v11, v109
    v_exp_f32 v12, v110
    v_cvt_pk_bf16_f32 v58, v10, v11
    v_exp_f32 v13, v111
    v_mfma_f32_32x32x16_bf16 v[120:135], v[24:27], v[48:51], v[120:135]
    v_exp_f32 v10, v112
    v_cvt_pk_bf16_f32 v59, v12, v13
    v_exp_f32 v11, v113
    v_exp_f32 v12, v114
    v_cvt_pk_bf16_f32 v60, v10, v11
    v_exp_f32 v13, v115
    v_mfma_f32_32x32x16_bf16 v[152:167], v[32:35], v[68:71], v[152:167]
    v_exp_f32 v10, v116
    v_cvt_pk_bf16_f32 v61, v12, v13
    v_exp_f32 v11, v117
    v_exp_f32 v12, v118
    v_cvt_pk_bf16_f32 v62, v10, v11
    v_exp_f32 v13, v119
    s_setprio 0
    s_waitcnt lgkmcnt(0)
    v_mfma_f32_32x32x8_bf16 v[104:119], v[16:17], v[52:53], v[72:87]
    v_cvt_pk_bf16_f32 v63, v12, v13
    v_exp_f32 v10, v120
    v_exp_f32 v11, v121
    v_exp_f32 v12, v122
    v_cvt_pk_bf16_f32 v64, v10, v11
    v_exp_f32 v13, v123
    v_mfma_f32_32x32x16_bf16 v[136:151], v[36:39], v[56:59], v[136:151]
    v_exp_f32 v10, v124
    v_cvt_pk_bf16_f32 v65, v12, v13
    v_exp_f32 v11, v125
    v_exp_f32 v12, v126
    v_cvt_pk_bf16_f32 v66, v10, v11
    v_exp_f32 v13, v127
    v_mfma_f32_32x32x16_bf16 v[104:119], v[20:23], v[44:47], v[104:119]
    v_exp_f32 v10, v128
    v_cvt_pk_bf16_f32 v67, v12, v13
    v_exp_f32 v11, v129
    v_exp_f32 v12, v130
    v_cvt_pk_bf16_f32 v68, v10, v11
    v_exp_f32 v13, v131
    v_mfma_f32_32x32x16_bf16 v[136:151], v[40:43], v[60:63], v[136:151]
    v_exp_f32 v10, v132
    v_cvt_pk_bf16_f32 v69, v12, v13
    v_exp_f32 v11, v133
    v_exp_f32 v12, v134
    v_cvt_pk_bf16_f32 v70, v10, v11
    v_exp_f32 v13, v135
    v_add_u32 v2, 10240, v2
    v_add_u32 v3, 10240, v3
    v_add_u32 v4, 10240, v4
    s_add_u32 s29, s29, 1
    s_cmp_lg_u32 s29, 1
    s_cbranch_scc1 attn_nobar
attn_bar:
    s_waitcnt vmcnt(0)
    s_barrier
attn_nobar:
    s_cmp_lg_u32 s29, 2
    s_cbranch_scc1 L_pf_15
    buffer_load_dword v14, v168, s[52:55], 0 offen
L_pf_15:
    s_cmp_lg_u32 s29, 3
    s_cbranch_scc1 L_pf_16
    buffer_load_dword v14, v170, s[16:19], 0 offen
    global_load_dword v14, v171, s[48:49]
L_pf_16:
    s_cmp_lg_u32 s29, 4
    s_cbranch_scc1 L_pf_17
    buffer_load_dword v14, v169, s[20:23], 0 offen
L_pf_17:
attn_nopf:
    s_cmp_lg_u32 s29, 6
    s_cbranch_scc1 attn_nopre
    s_barrier
    s_setprio 2
    v_mfma_f32_32x32x8_bf16 v[120:135], v[16:17], v[54:55], v[88:103]
    ds_read_b64 v[18:19], v3 offset:2560
    ds_read_b128 v[24:27], v2 offset:2560
    s_cmp_lt_u32 s24, 4
    s_cbranch_scc1 L_pk_33
    s_add_u32 s37, s63, 0
    buffer_load_dwordx4 v[184:187], v182, s[20:23], s37 offen
L_pk_33:
    v_cvt_pk_bf16_f32 v71, v12, v13
    v_exp_f32 v10, v104
    v_exp_f32 v11, v105
    v_exp_f32 v12, v106
    v_cvt_pk_bf16_f32 v56, v10, v11
    v_exp_f32 v13, v107
    v_mfma_f32_32x32x16_bf16 v[152:167], v[36:39], v[64:67], v[152:167]
    s_mov_b64 exec, s[32:33]
    ds_read_b128 v[28:31], v4 offset:0
    ds_read_b128 v[32:35], v4 offset:640
    s_mov_b64 exec, -1
    s_cmp_lt_u32 s24, 4
    s_cbranch_scc1 L_pk_34
    s_add_u32 s37, s63, 24576
    buffer_load_dwordx4 v[188:191], v182, s[20:23], s37 offen
L_pk_34:
    v_exp_f32 v10, v108
    v_cvt_pk_bf16_f32 v57, v12, v13
    v_exp_f32 v11, v109
    v_exp_f32 v12, v110
    v_cvt_pk_bf16_f32 v58, v10, v11
    v_exp_f32 v13, v111
    v_mfma_f32_32x32x16_bf16 v[120:135], v[20:23], v[48:51], v[120:135]
    s_add_u32 s36, s24, 0
    s_mul_i32 s45, s39, 160
    s_mul_i32 s44, s36, 40960
    s_add_u32 s45, s45, s44
    s_mul_i32 s44, s36, 5120
    s_cmp_ge_u32 s36, 10
    s_cselect_b32 s36, 30720, 0
    s_add_u32 s44, s44, s36
    s_add_u32 m0, s44, 0
    s_nop 0
    buffer_load_dwordx4 v172, s[16:19], s45 offen lds
    v_exp_f32 v10, v112
    v_cvt_pk_bf16_f32 v59, v12, v13
    v_exp_f32 v11, v113
    v_exp_f32 v12, v114
    v_cvt_pk_bf16_f32 v60, v10, v11
    v_exp_f32 v13, v115
    v_mfma_f32_32x32x16_bf16 v[152:167], v[40:43], v[68:71], v[152:167]
    s_add_u32 m0, s44, 1024
    s_nop 0
    buffer_load_dwordx4 v173, s[16:19], s45 offen lds
    v_exp_f32 v10, v116
    v_cvt_pk_bf16_f32 v61, v12, v13
    v_exp_f32 v11, v117
    v_exp_f32 v12, v118
    v_cvt_pk_bf16_f32 v62, v10, v11
    v_exp_f32 v13, v119
    s_waitcnt lgkmcnt(0)
    v_mfma_f32_32x32x8_bf16 v[104:119], v[18:19], v[52:53], v[72:87]
    s_cmp_lt_u32 s24, 4
    s_cbranch_scc1 L_pk_35
    s_add_u32 s37, s63, 49152
    buffer_load_dwordx4 v[192:195], v182, s[20:23], s37 offen
L_pk_35:
    v_cvt_pk_bf16_f32 v63, v12, v13
    v_exp_f32 v10, v120
    v_exp_f32 v11, v121
    v_exp_f32 v12, v122
    v_cvt_pk_bf16_f32 v64, v10, v11
    v_exp_f32 v13, v123
    v_mfma_f32_32x32x16_bf16 v[136:151], v[28:31], v[56:59], v[136:151]
    s_cmp_lt_u32 s24, 4
    s_cbranch_scc1 L_pk_36
    s_add_u32 s37, s63, 73728
    buffer_load_dwordx4 v[196:199], v182, s[20:23], s37 offen
L_pk_36:
    v_exp_f32 v10, v124
    v_cvt_pk_bf16_f32 v65, v12, v13
    v_exp_f32 v11, v125
    v_exp_f32 v12, v126
    v_cvt_pk_bf16_f32 v66, v10, v11
    v_exp_f32 v13, v127
    v_mfma_f32_32x32x16_bf16 v[104:119], v[24:27], v[44:47], v[104:119]
    s_add_u32 m0, s44, 2048
    s_nop 0
    buffer_load_dwordx4 v174, s[16:19], s45 offen lds
    v_exp_f32 v10, v128
    v_cvt_pk_bf16_f32 v67, v12, v13
    v_exp_f32 v11, v129
    v_exp_f32 v12, v130
    v_cvt_pk_bf16_f32 v68, v10, v11
    v_exp_f32 v13, v131
    v_mfma_f32_32x32x16_bf16 v[136:151], v[32:35], v[60:63], v[136:151]
    s_add_u32 m0, s44, 3072
    s_nop 0
    buffer_load_dwordx4 v175, s[16:19], s45 offen lds
    v_exp_f32 v10, v132
    v_cvt_pk_bf16_f32 v69, v12, v13
    v_exp_f32 v11, v133
    v_exp_f32 v12, v134
    v_cvt_pk_bf16_f32 v70, v10, v11
    v_exp_f32 v13, v135
    v_mfma_f32_32x32x8_bf16 v[120:135], v[18:19], v[54:55], v[88:103]
    ds_read_b64 v[16:17], v3 offset:5120
    ds_read_b128 v[20:23], v2 offset:5120
    s_cmp_lt_u32 s24, 4
    s_cbranch_scc1 L_pk_37
    s_add_u32 s37, s63, 98304
    buffer_load_dwordx4 v[200:203], v182, s[20:23], s37 offen
L_pk_37:
    v_cvt_pk_bf16_f32 v71, v12, v13
    v_exp_f32 v10, v104
    v_exp_f32 v11, v105
    v_exp_f32 v12, v106
    v_cvt_pk_bf16_f32 v56, v10, v11
    v_exp_f32 v13, v107
    v_mfma_f32_32x32x16_bf16 v[152:167], v[28:31], v[64:67], v[152:167]
    s_mov_b64 exec, s[32:33]
    ds_read_b128 v[36:39], v4 offset:2560
    ds_read_b128 v[40:43], v4 offset:3200
    s_mov_b64 exec, -1
    s_cmp_lt_u32 s24, 4
    s_cbranch_scc1 L_pk_38
    s_add_u32 s37, s63, 122880
    buffer_load_dwordx4 v[204:207], v182, s[20:23], s37 offen
L_pk_38:
    v_exp_f32 v10, v108
    v_cvt_pk_bf16_f32 v57, v12, v13
    v_exp_f32 v11, v109
    v_exp_f32 v12, v110
    v_cvt_pk_bf16_f32 v58, v10, v11
    v_exp_f32 v13, v111
    v_mfma_f32_32x32x16_bf16 v[120:135], v[24:27], v[48:51], v[120:135]
    s_add_u32 m0, s44, 4096
    s_nop 0
    buffer_load_dwordx4 v176, s[16:19], s45 offen lds
    v_exp_f32 v10, v112
    v_cvt_pk_bf16_f32 v59, v12, v13
    v_exp_f32 v11, v113
    v_exp_f32 v12, v114
    v_cvt_pk_bf16_f32 v60, v10, v11
    v_exp_f32 v13, v115
    v_mfma_f32_32x32x16_bf16 v[152:167], v[32:35], v[68:71], v[152:167]
    s_add_u32 s36, s24, 8
    s_mul_i32 s45, s39, 160
    s_mul_i32 s44, s36, 40960
    s_add_u32 s45, s45, s44
    s_mul_i32 s44, s36, 5120
    s_cmp_ge_u32 s36, 10
    s_cselect_b32 s36, 30720, 0
    s_add_u32 s44, s44, s36
    s_add_u32 m0, s44, 0
    s_nop 0
    buffer_load_dwordx4 v172, s[16:19], s45 offen lds
    v_exp_f32 v10, v116
    v_cvt_pk_bf16_f32 v61, v12, v13
    v_exp_f32 v11, v117
    v_exp_f32 v12, v118
    v_cvt_pk_bf16_f32 v62, v10, v11
    v_exp_f32 v13, v119
    s_waitcnt lgkmcnt(0)
    v_mfma_f32_32x32x8_bf16 v[104:119], v[16:17], v[52:53], v[72:87]
    s_cmp_lt_u32 s24, 4
    s_cbranch_scc1 L_pk_39
    s_add_u32 s37, s63, 147456
    buffer_load_dwordx4 v[208:211], v182, s[20:23], s37 offen
L_pk_39:
    v_cvt_pk_bf16_f32 v63, v12, v13
    v_exp_f32 v10, v120
    v_exp_f32 v11, v121
    v_exp_f32 v12, v122
    v_cvt_pk_bf16_f32 v64, v10, v11
    v_exp_f32 v13, v123
    v_mfma_f32_32x32x16_bf16 v[136:151], v[36:39], v[56:59], v[136:151]
    s_cmp_lt_u32 s24, 4
    s_cbranch_scc1 L_pk_40
    s_add_u32 s37, s63, 172032
    buffer_load_dwordx4 v[212:215], v182, s[20:23], s37 offen
L_pk_40:
    v_exp_f32 v10, v124
    v_cvt_pk_bf16_f32 v65, v12, v13
    v_exp_f32 v11, v125
    v_exp_f32 v12, v126
    v_cvt_pk_bf16_f32 v66, v10, v11
    v_exp_f32 v13, v127
    v_mfma_f32_32x32x16_bf16 v[104:119], v[20:23], v[44:47], v[104:119]
    s_add_u32 m0, s44, 1024
    s_nop 0
    buffer_load_dwordx4 v173, s[16:19], s45 offen lds
    v_exp_f32 v10, v128
    v_cvt_pk_bf16_f32 v67, v12, v13
    v_exp_f32 v11, v129
    v_exp_f32 v12, v130
    v_cvt_pk_bf16_f32 v68, v10, v11
    v_exp_f32 v13, v131
    v_mfma_f32_32x32x16_bf16 v[136:151], v[40:43], v[60:63], v[136:151]
    s_add_u32 m0, s44, 2048
    s_nop 0
    buffer_load_dwordx4 v174, s[16:19], s45 offen lds
    v_exp_f32 v10, v132
    v_cvt_pk_bf16_f32 v69, v12, v13
    v_exp_f32 v11, v133
    v_exp_f32 v12, v134
    v_cvt_pk_bf16_f32 v70, v10, v11
    v_exp_f32 v13, v135
    v_mfma_f32_32x32x8_bf16 v[120:135], v[16:17], v[54:55], v[88:103]
    ds_read_b64 v[18:19], v3 offset:7680
    ds_read_b128 v[24:27], v2 offset:7680
    s_cmp_lt_u32 s24, 4
    s_cbranch_scc1 L_pk_41
    s_add_u32 s37, s63, 196608
    buffer_load_dwordx4 v[216:219], v182, s[20:23], s37 offen
L_pk_41:
    v_cvt_pk_bf16_f32 v71, v12, v13
    v_exp_f32 v10, v104
    v_exp_f32 v11, v105
    v_exp_f32 v12, v106
    v_cvt_pk_bf16_f32 v56, v10, v11
    v_exp_f32 v13, v107
    v_mfma_f32_32x32x16_bf16 v[152:167], v[36:39], v[64:67], v[152:167]
    s_mov_b64 exec, s[32:33]
    ds_read_b128 v[28:31], v4 offset:5120
    ds_read_b128 v[32:35], v4 offset:5760
    s_mov_b64 exec, -1
    s_cmp_lt_u32 s24, 4
    s_cbranch_scc1 L_pk_42
    s_add_u32 s37, s63, 221184
    buffer_load_dwordx4 v[220:223], v182, s[20:23], s37 offen
L_pk_42:
    v_exp_f32 v10, v108
    v_cvt_pk_bf16_f32 v57, v12, v13
    v_exp_f32 v11, v109
    v_exp_f32 v12, v110
    v_cvt_pk_bf16_f32 v58, v10, v11
    v_exp_f32 v13, v111
    v_mfma_f32_32x32x16_bf16 v[120:135], v[20:23], v[48:51], v[120:135]
    s_add_u32 m0, s44, 3072
    s_nop 0
    buffer_load_dwordx4 v175, s[16:19], s45 offen lds
    v_exp_f32 v10, v112
    v_cvt_pk_bf16_f32 v59, v12, v13
    v_exp_f32 v11, v113
    v_exp_f32 v12, v114
    v_cvt_pk_bf16_f32 v60, v10, v11
    v_exp_f32 v13, v115
    v_mfma_f32_32x32x16_bf16 v[152:167], v[40:43], v[68:71], v[152:167]
    s_add_u32 m0, s44, 4096
    s_nop 0
    buffer_load_dwordx4 v176, s[16:19], s45 offen lds
    v_exp_f32 v10, v116
    v_cvt_pk_bf16_f32 v61, v12, v13
    v_exp_f32 v11, v117
    v_exp_f32 v12, v118
    v_cvt_pk_bf16_f32 v62, v10, v11
    v_exp_f32 v13, v119
    s_waitcnt lgkmcnt(0)
    v_mfma_f32_32x32x8_bf16 v[104:119], v[18:19], v[52:53], v[72:87]
    s_cmp_lt_u32 s24, 4
    s_cbranch_scc1 L_pk_43
    s_add_u32 s37, s63, 245760
    buffer_load_dwordx4 v[224:227], v182, s[20:23], s37 offen
L_pk_43:
    v_cvt_pk_bf16_f32 v63, v12, v13
    v_exp_f32 v10, v120
    v_exp_f32 v11, v121
    v_exp_f32 v12, v122
    v_cvt_pk_bf16_f32 v64, v10, v11
    v_exp_f32 v13, v123
    v_mfma_f32_32x32x16_bf16 v[136:151], v[28:31], v[56:59], v[136:151]
    s_cmp_lt_u32 s24, 4
    s_cbranch_scc1 L_pk_44
    s_add_u32 s37, s63, 270336
    buffer_load_dwordx4 v[228:231], v182, s[20:23], s37 offen
L_pk_44:
    v_exp_f32 v10, v124
    v_cvt_pk_bf16_f32 v65, v12, v13
    v_exp_f32 v11, v125
    v_exp_f32 v12, v126
    v_cvt_pk_bf16_f32 v66, v10, v11
    v_exp_f32 v13, v127
    v_mfma_f32_32x32x16_bf16 v[104:119], v[24:27], v[44:47], v[104:119]
    s_add_u32 s36, s24, 16
    s_mul_i32 s45, s39, s62
    s_mul_i32 s44, s38, 81920
    s_sub_u32 s44, s44, 819200
    s_cmp_lt_u32 s24, 4
    s_cselect_b32 s44, 0, s44
    s_add_u32 s45, s45, s44
    s_mul_i32 s44, s36, 40960
    s_add_u32 s45, s45, s44
    s_mul_i32 s44, s36, 5120
    s_mov_b32 s36, 4294916096
    s_cmp_lt_u32 s24, 4
    s_cselect_b32 s36, 30720, s36
    s_add_u32 s44, s44, s36
    s_cmp_ge_u32 s24, 6
    s_cbranch_scc1 L_ps_28
    s_add_u32 m0, s44, 0
    s_nop 0
    buffer_load_dwordx4 v177, s[56:59], s45 offen sc1 lds
L_ps_28:
    v_exp_f32 v10, v128
    v_cvt_pk_bf16_f32 v67, v12, v13
    v_exp_f32 v11, v129
    v_exp_f32 v12, v130
    v_cvt_pk_bf16_f32 v68, v10, v11
    v_exp_f32 v13, v131
    v_mfma_f32_32x32x16_bf16 v[136:151], v[32:35], v[60:63], v[136:151]
    s_cmp_ge_u32 s24, 6
    s_cbranch_scc1 L_ps_29
    s_add_u32 m0, s44, 1024
    s_nop 0
    buffer_load_dwordx4 v178, s[56:59], s45 offen sc1 lds
L_ps_29:
    v_exp_f32 v10, v132
    v_cvt_pk_bf16_f32 v69, v12, v13
    v_exp_f32 v11, v133
    v_exp_f32 v12, v134
    v_cvt_pk_bf16_f32 v70, v10, v11
    v_exp_f32 v13, v135
    v_mfma_f32_32x32x8_bf16 v[120:135], v[18:19], v[54:55], v[88:103]
    ds_read_b64 v[16:17], v3 offset:10240
    ds_read_b128 v[20:23], v2 offset:10240
    s_cmp_lt_u32 s24, 4
    s_cbranch_scc1 L_pk_45
    s_add_u32 s37, s63, 294912
    buffer_load_dwordx4 v[232:235], v182, s[20:23], s37 offen
L_pk_45:
    v_cvt_pk_bf16_f32 v71, v12, v13
    v_exp_f32 v10, v104
    v_exp_f32 v11, v105
    v_exp_f32 v12, v106
    v_cvt_pk_bf16_f32 v56, v10, v11
    v_exp_f32 v13, v107
    v_mfma_f32_32x32x16_bf16 v[152:167], v[28:31], v[64:67], v[152:167]
    s_mov_b64 exec, s[32:33]
    ds_read_b128 v[36:39], v4 offset:7680
    ds_read_b128 v[40:43], v4 offset:8320
    s_mov_b64 exec, -1
    s_cmp_lt_u32 s24, 4
    s_cbranch_scc1 L_pk_46
    s_add_u32 s37, s63, 319488
    buffer_load_dwordx4 v[236:239], v182, s[20:23], s37 offen
L_pk_46:
    v_exp_f32 v10, v108
    v_cvt_pk_bf16_f32 v57, v12, v13
    v_exp_f32 v11, v109
    v_exp_f32 v12, v110
    v_cvt_pk_bf16_f32 v58, v10, v11
    v_exp_f32 v13, v111
    v_mfma_f32_32x32x16_bf16 v[120:135], v[24:27], v[48:51], v[120:135]
    s_cmp_ge_u32 s24, 6
    s_cbranch_scc1 L_ps_30
    s_add_u32 m0, s44, 2048
    s_nop 0
    buffer_load_dwordx4 v179, s[56:59], s45 offen sc1 lds
L_ps_30:
    v_exp_f32 v10, v112
    v_cvt_pk_bf16_f32 v59, v12, v13
    v_exp_f32 v11, v113
    v_exp_f32 v12, v114
    v_cvt_pk_bf16_f32 v60, v10, v11
    v_exp_f32 v13, v115
    v_mfma_f32_32x32x16_bf16 v[152:167], v[32:35], v[68:71], v[152:167]
    s_cmp_ge_u32 s24, 6
    s_cbranch_scc1 L_ps_31
    s_add_u32 m0, s44, 3072
    s_nop 0
    buffer_load_dwordx4 v180, s[56:59], s45 offen sc1 lds
L_ps_31:
    v_exp_f32 v10, v116
    v_cvt_pk_bf16_f32 v61, v12, v13
    v_exp_f32 v11, v117
    v_exp_f32 v12, v118
    v_cvt_pk_bf16_f32 v62, v10, v11
    v_exp_f32 v13, v119
    s_setprio 0
    s_waitcnt lgkmcnt(0)
    v_mfma_f32_32x32x8_bf16 v[104:119], v[16:17], v[52:53], v[72:87]
    s_cmp_lt_u32 s24, 4
    s_cbranch_scc1 L_pk_47
    s_add_u32 s37, s63, 344064
    buffer_load_dwordx4 v[240:243], v182, s[20:23], s37 offen
L_pk_47:
    v_cvt_pk_bf16_f32 v63, v12, v13
    v_exp_f32 v10, v120
    v_exp_f32 v11, v121
    v_exp_f32 v12, v122
    v_cvt_pk_bf16_f32 v64, v10, v11
    v_exp_f32 v13, v123
    v_mfma_f32_32x32x16_bf16 v[136:151], v[36:39], v[56:59], v[136:151]
    s_cmp_lt_u32 s24, 4
    s_cbranch_scc1 L_pk_48
    s_add_u32 s37, s63, 368640
    buffer_load_dwordx4 v[244:247], v182, s[20:23], s37 offen
L_pk_48:
    v_exp_f32 v10, v124
    v_cvt_pk_bf16_f32 v65, v12, v13
    v_exp_f32 v11, v125
    v_exp_f32 v12, v126
    v_cvt_pk_bf16_f32 v66, v10, v11
    v_exp_f32 v13, v127
    v_mfma_f32_32x32x16_bf16 v[104:119], v[20:23], v[44:47], v[104:119]
    s_cmp_ge_u32 s24, 6
    s_cbranch_scc1 L_ps_32
    s_add_u32 m0, s44, 4096
    s_nop 0
    buffer_load_dwordx4 v181, s[56:59], s45 offen sc1 lds
L_ps_32:
    v_exp_f32 v10, v128
    v_cvt_pk_bf16_f32 v67, v12, v13
    v_exp_f32 v11, v129
    v_exp_f32 v12, v130
    v_cvt_pk_bf16_f32 v68, v10, v11
    v_exp_f32 v13, v131
    v_mfma_f32_32x32x16_bf16 v[136:151], v[40:43], v[60:63], v[136:151]
    v_exp_f32 v10, v132
    v_cvt_pk_bf16_f32 v69, v12, v13
    v_exp_f32 v11, v133
    v_exp_f32 v12, v134
    v_cvt_pk_bf16_f32 v70, v10, v11
    v_exp_f32 v13, v135
    v_add_u32 v2, 10240, v2
    v_add_u32 v3, 10240, v3
    v_add_u32 v4, 10240, v4
    s_add_u32 s29, s29, 1
attn_nopre:
    s_cmp_lt_u32 s29, 8
    s_cbranch_scc1 attn_loop
    s_setprio 2
    v_cvt_pk_bf16_f32 v71, v12, v13
    v_mfma_f32_32x32x16_bf16 v[152:167], v[36:39], v[64:67], v[152:167]
    s_mul_i32 s34, s24, 3328
    v_mfma_f32_32x32x16_bf16 v[152:167], v[40:43], v[68:71], v[152:167]
    s_xor_b32 s35, s24, 4
    s_mul_i32 s35, s35, 3328
    s_add_u32 s34, s34, 133120
    s_add_u32 s35, s35, 133120
    v_add_u32 v7, s34, v5
    v_add_u32 v10, s35, v5
    v_lshl_add_u32 v169, v1, 2, s34
    v_lshl_add_u32 v170, v1, 2, s35
    v_mov_b32 v11, 0
    v_mov_b32 v12, 159744
    s_lshl_b32 s34, s26, 3
    s_lshl_b32 s35, s28, 1
    s_add_u32 s34, s34, s35
    s_add_u32 s34, s34, s27
    s_lshl_b32 s34, s34, 11
    s_lshr_b32 s35, s25, 3
    s_lshl_b32 s35, s35, 17
    s_add_u32 s35, s35, s34
    s_and_b32 s36, s25, 7
    s_lshl_b32 s36, s36, 7
    s_add_u32 s35, s35, s36
    s_add_u32 s35, s35, 9961472
    s_lshr_b32 s36, s25, 1
    s_lshl_b32 s36, s36, 17
    s_add_u32 s34, s34, s36
    s_and_b32 s36, s25, 1
    s_lshl_b32 s36, s36, 9
    s_add_u32 s34, s34, s36
    s_add_u32 s34, s34, 7864320
    v_and_b32 v168, 15, v1
    v_bfe_u32 v171, v1, 4, 1
    v_lshlrev_b32 v171, 10, v171
    v_lshl_add_u32 v3, v168, 3, v171
    v_lshl_add_u32 v3, v9, 30, v3
    v_lshl_add_u32 v2, v168, 4, v171
    v_lshl_add_u32 v2, v9, 8, v2
    s_barrier
    ds_write_b32 v12, v11
    s_cmp_eq_u32 s27, 0
    s_cbranch_scc1 attn_ep0
    ds_write_b128 v7, v[136:139] offset:0
    ds_write_b128 v7, v[140:143] offset:1024
    ds_write_b128 v7, v[144:147] offset:2048
    ds_write_b32 v169, v148 offset:3072
    s_waitcnt lgkmcnt(0)
    s_barrier
    ds_read_b32 v116, v170 offset:3072
    ds_read_b128 v[104:107], v10 offset:0
    ds_read_b128 v[108:111], v10 offset:1024
    ds_read_b128 v[112:115], v10 offset:2048
    s_waitcnt lgkmcnt(3)
    v_add_f32 v116, v116, v164
    v_rcp_f32 v117, v116
    s_waitcnt lgkmcnt(0)
    v_add_f32 v104, v104, v152
    v_add_f32 v105, v105, v153
    v_add_f32 v106, v106, v154
    v_add_f32 v107, v107, v155
    v_add_f32 v108, v108, v156
    v_add_f32 v109, v109, v157
    v_add_f32 v110, v110, v158
    v_add_f32 v111, v111, v159
    v_add_f32 v112, v112, v160
    v_add_f32 v113, v113, v161
    v_add_f32 v114, v114, v162
    v_add_f32 v115, v115, v163
    s_branch attn_fin
attn_ep0:
    ds_write_b128 v7, v[152:155] offset:0
    ds_write_b128 v7, v[156:159] offset:1024
    ds_write_b128 v7, v[160:163] offset:2048
    ds_write_b32 v169, v164 offset:3072
    s_waitcnt lgkmcnt(0)
    s_barrier
    ds_read_b32 v116, v170 offset:3072
    ds_read_b128 v[104:107], v10 offset:0
    ds_read_b128 v[108:111], v10 offset:1024
    ds_read_b128 v[112:115], v10 offset:2048
    s_waitcnt lgkmcnt(3)
    v_add_f32 v116, v116, v148
    v_rcp_f32 v117, v116
    s_waitcnt lgkmcnt(0)
    v_add_f32 v104, v104, v136
    v_add_f32 v105, v105, v137
    v_add_f32 v106, v106, v138
    v_add_f32 v107, v107, v139
    v_add_f32 v108, v108, v140
    v_add_f32 v109, v109, v141
    v_add_f32 v110, v110, v142
    v_add_f32 v111, v111, v143
    v_add_f32 v112, v112, v144
    v_add_f32 v113, v113, v145
    v_add_f32 v114, v114, v146
    v_add_f32 v115, v115, v147
attn_fin:
    v_mul_f32 v120, v104, v117
    v_mul_f32 v121, v105, v117
    v_mul_f32 v122, v106, v117
    v_mul_f32 v123, v107, v117
    v_mul_f32 v124, v108, v117
    v_mul_f32 v125, v109, v117
    v_mul_f32 v126, v110, v117
    v_mul_f32 v127, v111, v117
    v_mul_f32 v128, v112, v117
    v_mul_f32 v129, v113, v117
    v_mul_f32 v130, v114, v117
    v_mul_f32 v131, v115, v117
    v_cvt_pk_bf16_f32 v56, v120, v121
    v_cvt_pk_bf16_f32 v57, v122, v123
    v_cvt_pk_bf16_f32 v58, v124, v125
    v_cvt_pk_bf16_f32 v59, v126, v127
    v_cvt_pk_bf16_f32 v60, v128, v129
    v_cvt_pk_bf16_f32 v61, v130, v131
    buffer_store_dwordx4 v[56:59], v2, s[12:15], s34 offen sc1
    buffer_store_dwordx2 v[60:61], v3, s[12:15], s35 offen sc1
    s_mul_i32 s50, s3, 262144
    s_mul_i32 s34, s26, 4096
    s_mul_i32 s37, s25, 32
    s_add_u32 s34, s34, s37
    s_add_u32 s34, s34, 20709376
    s_add_u32 s34, s34, s50
    v_mov_b32 v11, 1
    s_cmp_lg_u32 s30, 0
    s_cbranch_scc1 attn_vote
    v_add_f32 v118, abs(v104), abs(v105)
    v_add_f32 v118, v118, abs(v106)
    v_add_f32 v118, v118, abs(v107)
    v_add_f32 v118, v118, abs(v108)
    v_add_f32 v118, v118, abs(v109)
    v_add_f32 v118, v118, abs(v110)
    v_add_f32 v118, v118, abs(v111)
    v_add_f32 v118, v118, abs(v112)
    v_add_f32 v118, v118, abs(v113)
    v_add_f32 v118, v118, abs(v114)
    v_add_f32 v118, v118, abs(v115)
    v_mov_b32 v10, 0x53800000
    v_mov_b32 v13, 0x7b800000
    v_cmp_nlt_f32 vcc, v116, v10
    v_cmp_nlt_f32 s[36:37], v118, v13
    s_nop 4
    s_or_b64 s[36:37], vcc, s[36:37]
    s_cbranch_scc0 attn_vote
    v_mov_b32 v11, 0x101
attn_vote:
    s_mov_b64 exec, 1
    s_waitcnt vmcnt(0)
    ds_add_rtn_u32 v10, v12, v11
    s_waitcnt lgkmcnt(0)
    v_add_u32 v10, v10, v11
    s_mov_b64 exec, -1
    v_readfirstlane_b32 s36, v10
    v_mul_u32_u24 v10, 1024, v1
    s_nop 2
    s_cmp_lg_u32 s36, 8
    s_cbranch_scc1 attn_nosig
    s_mov_b64 exec, 0xf
    buffer_store_dword v11, v10, s[12:15], s34 offen sc1
    s_mov_b64 exec, -1
attn_nosig:
    s_barrier
    ds_read_b32 v13, v12
    s_waitcnt lgkmcnt(0)
    v_readfirstlane_b32 s36, v13
    s_nop 3
    s_cmp_eq_u32 s36, 8
    s_cbranch_scc1 attn_done
    s_mov_b32 s30, 1
    s_waitcnt vmcnt(0)
    s_barrier
    s_branch attn_restart
attn_done:
tail_start:
    s_load_dwordx2 s[4:5], s[0:1], 40
    s_load_dwordx2 s[6:7], s[0:1], 56
    s_load_dwordx2 s[10:11], s[0:1], 64
    s_load_dwordx2 s[56:57], s[0:1], 8
    s_mul_i32 s50, s3, 262144
    s_lshl_b32 s51, s3, 17
    s_add_u32 s51, s51, 20316160
    s_and_b32 s34, s2, 7
    s_lshr_b32 s35, s2, 3
    s_lshr_b32 s60, s34, 1
    s_lshl_b32 s60, s60, 2
    s_and_b32 s36, s35, 3
    s_add_u32 s60, s60, s36
    s_and_b32 s61, s34, 1
    s_lshl_b32 s61, s61, 3
    s_lshr_b32 s36, s35, 2
    s_add_u32 s61, s61, s36
    s_mul_i32 s36, s35, 43
    s_lshr_b32 s36, s36, 8
    s_mul_i32 s37, s36, 6
    s_sub_u32 s37, s35, s37
    s_and_b32 s40, s34, 1
    s_mul_i32 s40, s40, 5
    s_add_u32 s40, s40, s36
    s_lshr_b32 s41, s34, 1
    s_mul_i32 s41, s41, 6
    s_add_u32 s41, s41, s37
    s_cmp_lt_u32 s35, 30
    s_cselect_b32 s42, 1, 0
    v_and_b32 v4, 15, v1
    v_lshrrev_b32 v5, 4, v1
    s_mov_b32 s45, 0xffff0000
    s_cmp_lt_u32 s24, 4
    s_cbranch_scc1 tl_cons
    s_cmp_eq_u32 s24, 4
    s_cbranch_scc1 tl_sync
    s_cmp_eq_u32 s24, 5
    s_cbranch_scc1 tl_sig
    s_setprio 0
    s_and_b32 s27, s24, 1
    v_lshrrev_b32 v2, 5, v1
    v_bfe_u32 v3, v1, 2, 2
    v_lshl_add_u32 v3, v2, 2, v3
    v_mul_u32_u24 v6, 3072, v3
    v_lshlrev_b32 v7, 12, v3
    v_bfe_u32 v3, v1, 4, 1
    v_lshl_add_u32 v6, v3, 6, v6
    v_lshl_add_u32 v7, v3, 6, v7
    v_and_b32 v3, 3, v1
    v_lshl_add_u32 v6, v3, 4, v6
    v_lshlrev_b32 v2, 1, v2
    v_xor_b32 v3, v3, v2
    v_lshl_add_u32 v7, v3, 4, v7
    s_mul_i32 s28, s27, 196608
    s_lshl_b32 s36, s41, 7
    s_add_u32 s28, s28, s36
    s_lshl_b32 s29, s27, 18
    s_lshl_b32 s36, s38, 7
    s_add_u32 s29, s29, s36
    s_lshl_b32 s43, s27, 13
    v_lshrrev_b32 v2, 5, v1
    v_bfe_u32 v3, v1, 2, 2
    v_lshl_add_u32 v3, v2, 2, v3
    v_mul_u32_u24 v8, 3840, v3
    v_bfe_u32 v3, v1, 4, 1
    v_lshl_add_u32 v8, v3, 6, v8
    v_and_b32 v3, 3, v1
    v_lshl_add_u32 v8, v3, 4, v8
    s_mul_i32 s31, s27, 122880
    s_lshl_b32 s36, s61, 8
    s_add_u32 s31, s31, s36
    s_waitcnt lgkmcnt(0)
    s_mov_b32 s16, s56
    s_mov_b32 s17, s57
    s_mov_b32 s18, 2457600
    s_mov_b32 s19, 0x00020000
    v_lshlrev_b32 v9, 4, v1
    v_add_u32 v9, s43, v9
    v_add_u32 v10, 65536, v9
    s_cmp_eq_u32 s42, 0
    s_cbranch_scc1 tl_l_notile
    s_add_u32 s36, s28, 5111808
    buffer_load_dwordx4 v[16:19], v6, s[20:23], s36 offen
    s_add_u32 s36, s28, 5136384
    buffer_load_dwordx4 v[20:23], v6, s[20:23], s36 offen
    s_add_u32 s36, s28, 5160960
    buffer_load_dwordx4 v[24:27], v6, s[20:23], s36 offen
    s_add_u32 s36, s28, 5185536
    buffer_load_dwordx4 v[28:31], v6, s[20:23], s36 offen
    s_add_u32 s36, s28, 5210112
    buffer_load_dwordx4 v[32:35], v6, s[20:23], s36 offen
    s_add_u32 s36, s28, 5234688
    buffer_load_dwordx4 v[36:39], v6, s[20:23], s36 offen
    s_add_u32 s36, s28, 5259264
    buffer_load_dwordx4 v[40:43], v6, s[20:23], s36 offen
    s_add_u32 s36, s28, 5283840
    buffer_load_dwordx4 v[44:47], v6, s[20:23], s36 offen
    s_add_u32 s36, s28, 5505024
    buffer_load_dwordx4 v[48:51], v6, s[20:23], s36 offen
    s_add_u32 s36, s28, 5529600
    buffer_load_dwordx4 v[52:55], v6, s[20:23], s36 offen
    s_add_u32 s36, s28, 5554176
    buffer_load_dwordx4 v[56:59], v6, s[20:23], s36 offen
    s_add_u32 s36, s28, 5578752
    buffer_load_dwordx4 v[60:63], v6, s[20:23], s36 offen
    s_add_u32 s36, s28, 5603328
    buffer_load_dwordx4 v[64:67], v6, s[20:23], s36 offen
    s_add_u32 s36, s28, 5627904
    buffer_load_dwordx4 v[68:71], v6, s[20:23], s36 offen
    s_add_u32 s36, s28, 5652480
    buffer_load_dwordx4 v[72:75], v6, s[20:23], s36 offen
    s_add_u32 s36, s28, 5677056
    buffer_load_dwordx4 v[76:79], v6, s[20:23], s36 offen
    s_add_u32 s36, s28, 5898240
    buffer_load_dwordx4 v[80:83], v6, s[20:23], s36 offen
    s_add_u32 s36, s28, 5922816
    buffer_load_dwordx4 v[84:87], v6, s[20:23], s36 offen
    s_add_u32 s36, s28, 5947392
    buffer_load_dwordx4 v[88:91], v6, s[20:23], s36 offen
    s_add_u32 s36, s28, 5971968
    buffer_load_dwordx4 v[92:95], v6, s[20:23], s36 offen
    s_add_u32 s36, s28, 5996544
    buffer_load_dwordx4 v[96:99], v6, s[20:23], s36 offen
    s_add_u32 s36, s28, 6021120
    buffer_load_dwordx4 v[100:103], v6, s[20:23], s36 offen
    s_add_u32 s36, s28, 6045696
    buffer_load_dwordx4 v[104:107], v6, s[20:23], s36 offen
    s_add_u32 s36, s28, 6070272
    buffer_load_dwordx4 v[108:111], v6, s[20:23], s36 offen
    s_barrier
    s_barrier
    s_add_u32 s32, s43, 0
    s_mov_b32 s33, 6
L_wf_49:
    s_add_u32 m0, s32, 0
    s_add_u32 s36, s28, 0
    buffer_load_dwordx4 v6, s[20:23], s36 offen lds
    s_add_u32 m0, s32, 1024
    s_add_u32 s36, s28, 24576
    buffer_load_dwordx4 v6, s[20:23], s36 offen lds
    s_add_u32 m0, s32, 2048
    s_add_u32 s36, s28, 49152
    buffer_load_dwordx4 v6, s[20:23], s36 offen lds
    s_add_u32 m0, s32, 3072
    s_add_u32 s36, s28, 73728
    buffer_load_dwordx4 v6, s[20:23], s36 offen lds
    s_add_u32 m0, s32, 4096
    s_add_u32 s36, s28, 98304
    buffer_load_dwordx4 v6, s[20:23], s36 offen lds
    s_add_u32 m0, s32, 5120
    s_add_u32 s36, s28, 122880
    buffer_load_dwordx4 v6, s[20:23], s36 offen lds
    s_add_u32 m0, s32, 6144
    s_add_u32 s36, s28, 147456
    buffer_load_dwordx4 v6, s[20:23], s36 offen lds
    s_add_u32 m0, s32, 7168
    s_add_u32 s36, s28, 172032
    buffer_load_dwordx4 v6, s[20:23], s36 offen lds
    s_add_u32 s28, s28, 393216
    s_add_u32 s32, s32, 16384
    s_sub_u32 s33, s33, 1
    s_waitcnt vmcnt(12)
    s_cmp_lg_u32 s33, 0
    s_cbranch_scc1 L_wf_49
    s_barrier
    s_add_u32 s32, s43, 98304
    s_mov_b32 s33, 3
L_wf_50:
    s_add_u32 m0, s32, 0
    s_add_u32 s36, s28, 0
    buffer_load_dwordx4 v6, s[20:23], s36 offen lds
    s_add_u32 m0, s32, 1024
    s_add_u32 s36, s28, 24576
    buffer_load_dwordx4 v6, s[20:23], s36 offen lds
    s_add_u32 m0, s32, 2048
    s_add_u32 s36, s28, 49152
    buffer_load_dwordx4 v6, s[20:23], s36 offen lds
    s_add_u32 m0, s32, 3072
    s_add_u32 s36, s28, 73728
    buffer_load_dwordx4 v6, s[20:23], s36 offen lds
    s_add_u32 m0, s32, 4096
    s_add_u32 s36, s28, 98304
    buffer_load_dwordx4 v6, s[20:23], s36 offen lds
    s_add_u32 m0, s32, 5120
    s_add_u32 s36, s28, 122880
    buffer_load_dwordx4 v6, s[20:23], s36 offen lds
    s_add_u32 m0, s32, 6144
    s_add_u32 s36, s28, 147456
    buffer_load_dwordx4 v6, s[20:23], s36 offen lds
    s_add_u32 m0, s32, 7168
    s_add_u32 s36, s28, 172032
    buffer_load_dwordx4 v6, s[20:23], s36 offen lds
    s_add_u32 s28, s28, 393216
    s_add_u32 s32, s32, 16384
    s_sub_u32 s33, s33, 1
    s_waitcnt vmcnt(12)
    s_cmp_lg_u32 s33, 0
    s_cbranch_scc1 L_wf_50
    s_waitcnt vmcnt(32)
    s_barrier
    s_waitcnt vmcnt(0)
    s_barrier
    s_lshl_b32 s36, s24, 14
    s_sub_u32 s36, s36, 65536
    v_lshl_add_u32 v11, v1, 4, s36
    ds_write_b128 v11, v[184:187] offset:0
    ds_write_b128 v11, v[188:191] offset:1024
    ds_write_b128 v11, v[192:195] offset:2048
    ds_write_b128 v11, v[196:199] offset:3072
    ds_write_b128 v11, v[200:203] offset:4096
    ds_write_b128 v11, v[204:207] offset:5120
    ds_write_b128 v11, v[208:211] offset:6144
    ds_write_b128 v11, v[212:215] offset:7168
    ds_write_b128 v11, v[216:219] offset:8192
    ds_write_b128 v11, v[220:223] offset:9216
    ds_write_b128 v11, v[224:227] offset:10240
    ds_write_b128 v11, v[228:231] offset:11264
    ds_write_b128 v11, v[232:235] offset:12288
    ds_write_b128 v11, v[236:239] offset:13312
    ds_write_b128 v11, v[240:243] offset:14336
    ds_write_b128 v11, v[244:247] offset:15360
    s_barrier
    ds_write_b128 v10, v[16:19] offset:0
    ds_write_b128 v10, v[20:23] offset:1024
    ds_write_b128 v10, v[24:27] offset:2048
    ds_write_b128 v10, v[28:31] offset:3072
    ds_write_b128 v10, v[32:35] offset:4096
    ds_write_b128 v10, v[36:39] offset:5120
    ds_write_b128 v10, v[40:43] offset:6144
    ds_write_b128 v10, v[44:47] offset:7168
    ds_write_b128 v10, v[48:51] offset:16384
    ds_write_b128 v10, v[52:55] offset:17408
    ds_write_b128 v10, v[56:59] offset:18432
    ds_write_b128 v10, v[60:63] offset:19456
    ds_write_b128 v10, v[64:67] offset:20480
    ds_write_b128 v10, v[68:71] offset:21504
    ds_write_b128 v10, v[72:75] offset:22528
    ds_write_b128 v10, v[76:79] offset:23552
    ds_write_b128 v10, v[80:83] offset:32768
    ds_write_b128 v10, v[84:87] offset:33792
    ds_write_b128 v10, v[88:91] offset:34816
    ds_write_b128 v10, v[92:95] offset:35840
    ds_write_b128 v10, v[96:99] offset:36864
    ds_write_b128 v10, v[100:103] offset:37888
    ds_write_b128 v10, v[104:107] offset:38912
    ds_write_b128 v10, v[108:111] offset:39936
    s_waitcnt lgkmcnt(0)
    s_barrier
    s_barrier
    s_add_u32 s32, s43, 0
    s_mov_b32 s33, 4
L_wf_51:
    s_add_u32 m0, s32, 0
    s_add_u32 s36, s29, 0
    buffer_load_dwordx4 v7, s[52:55], s36 offen lds
    s_add_u32 m0, s32, 1024
    s_add_u32 s36, s29, 32768
    buffer_load_dwordx4 v7, s[52:55], s36 offen lds
    s_add_u32 m0, s32, 2048
    s_add_u32 s36, s29, 65536
    buffer_load_dwordx4 v7, s[52:55], s36 offen lds
    s_add_u32 m0, s32, 3072
    s_add_u32 s36, s29, 98304
    buffer_load_dwordx4 v7, s[52:55], s36 offen lds
    s_add_u32 m0, s32, 4096
    s_add_u32 s36, s29, 131072
    buffer_load_dwordx4 v7, s[52:55], s36 offen lds
    s_add_u32 m0, s32, 5120
    s_add_u32 s36, s29, 163840
    buffer_load_dwordx4 v7, s[52:55], s36 offen lds
    s_add_u32 m0, s32, 6144
    s_add_u32 s36, s29, 196608
    buffer_load_dwordx4 v7, s[52:55], s36 offen lds
    s_add_u32 m0, s32, 7168
    s_add_u32 s36, s29, 229376
    buffer_load_dwordx4 v7, s[52:55], s36 offen lds
    s_add_u32 s29, s29, 524288
    s_add_u32 s32, s32, 16384
    s_sub_u32 s33, s33, 1
    s_waitcnt vmcnt(12)
    s_cmp_lg_u32 s33, 0
    s_cbranch_scc1 L_wf_51
    s_barrier
    s_branch tl_l_p3
tl_l_notile:
    s_barrier
    s_barrier
    s_barrier
    s_add_u32 s32, s43, 0
    s_mov_b32 s33, 4
L_wf_52:
    s_add_u32 m0, s32, 0
    s_add_u32 s36, s29, 0
    buffer_load_dwordx4 v7, s[52:55], s36 offen lds
    s_add_u32 m0, s32, 1024
    s_add_u32 s36, s29, 32768
    buffer_load_dwordx4 v7, s[52:55], s36 offen lds
    s_add_u32 m0, s32, 2048
    s_add_u32 s36, s29, 65536
    buffer_load_dwordx4 v7, s[52:55], s36 offen lds
    s_add_u32 m0, s32, 3072
    s_add_u32 s36, s29, 98304
    buffer_load_dwordx4 v7, s[52:55], s36 offen lds
    s_add_u32 m0, s32, 4096
    s_add_u32 s36, s29, 131072
    buffer_load_dwordx4 v7, s[52:55], s36 offen lds
    s_add_u32 m0, s32, 5120
    s_add_u32 s36, s29, 163840
    buffer_load_dwordx4 v7, s[52:55], s36 offen lds
    s_add_u32 m0, s32, 6144
    s_add_u32 s36, s29, 196608
    buffer_load_dwordx4 v7, s[52:55], s36 offen lds
    s_add_u32 m0, s32, 7168
    s_add_u32 s36, s29, 229376
    buffer_load_dwordx4 v7, s[52:55], s36 offen lds
    s_add_u32 s29, s29, 524288
    s_add_u32 s32, s32, 16384
    s_sub_u32 s33, s33, 1
    s_waitcnt vmcnt(12)
    s_cmp_lg_u32 s33, 0
    s_cbranch_scc1 L_wf_52
tl_l_p3:
    s_add_u32 s32, s43, 65536
    s_mov_b32 s33, 4
L_wf_53:
    s_add_u32 m0, s32, 0
    s_add_u32 s36, s29, 0
    buffer_load_dwordx4 v7, s[52:55], s36 offen lds
    s_add_u32 m0, s32, 1024
    s_add_u32 s36, s29, 32768
    buffer_load_dwordx4 v7, s[52:55], s36 offen lds
    s_add_u32 m0, s32, 2048
    s_add_u32 s36, s29, 65536
    buffer_load_dwordx4 v7, s[52:55], s36 offen lds
    s_add_u32 m0, s32, 3072
    s_add_u32 s36, s29, 98304
    buffer_load_dwordx4 v7, s[52:55], s36 offen lds
    s_add_u32 m0, s32, 4096
    s_add_u32 s36, s29, 131072
    buffer_load_dwordx4 v7, s[52:55], s36 offen lds
    s_add_u32 m0, s32, 5120
    s_add_u32 s36, s29, 163840
    buffer_load_dwordx4 v7, s[52:55], s36 offen lds
    s_add_u32 m0, s32, 6144
    s_add_u32 s36, s29, 196608
    buffer_load_dwordx4 v7, s[52:55], s36 offen lds
    s_add_u32 m0, s32, 7168
    s_add_u32 s36, s29, 229376
    buffer_load_dwordx4 v7, s[52:55], s36 offen lds
    s_add_u32 s29, s29, 524288
    s_add_u32 s32, s32, 16384
    s_sub_u32 s33, s33, 1
    s_waitcnt vmcnt(12)
    s_cmp_lg_u32 s33, 0
    s_cbranch_scc1 L_wf_53
    s_waitcnt vmcnt(16)
    s_barrier
    s_add_u32 s32, s43, 131072
    s_mov_b32 s33, 1
L_wf_54:
    s_add_u32 m0, s32, 0
    s_add_u32 s36, s29, 0
    buffer_load_dwordx4 v7, s[52:55], s36 offen lds
    s_add_u32 m0, s32, 1024
    s_add_u32 s36, s29, 32768
    buffer_load_dwordx4 v7, s[52:55], s36 offen lds
    s_add_u32 m0, s32, 2048
    s_add_u32 s36, s29, 65536
    buffer_load_dwordx4 v7, s[52:55], s36 offen lds
    s_add_u32 m0, s32, 3072
    s_add_u32 s36, s29, 98304
    buffer_load_dwordx4 v7, s[52:55], s36 offen lds
    s_add_u32 m0, s32, 4096
    s_add_u32 s36, s29, 131072
    buffer_load_dwordx4 v7, s[52:55], s36 offen lds
    s_add_u32 m0, s32, 5120
    s_add_u32 s36, s29, 163840
    buffer_load_dwordx4 v7, s[52:55], s36 offen lds
    s_add_u32 m0, s32, 6144
    s_add_u32 s36, s29, 196608
    buffer_load_dwordx4 v7, s[52:55], s36 offen lds
    s_add_u32 m0, s32, 7168
    s_add_u32 s36, s29, 229376
    buffer_load_dwordx4 v7, s[52:55], s36 offen lds
    s_add_u32 s29, s29, 524288
    s_add_u32 s32, s32, 16384
    s_sub_u32 s33, s33, 1
    s_waitcnt vmcnt(12)
    s_cmp_lg_u32 s33, 0
    s_cbranch_scc1 L_wf_54
    s_barrier
    s_add_u32 s32, s43, 0
    s_mov_b32 s33, 3
L_wf_55:
    s_add_u32 m0, s32, 0
    s_add_u32 s36, s29, 0
    buffer_load_dwordx4 v7, s[52:55], s36 offen lds
    s_add_u32 m0, s32, 1024
    s_add_u32 s36, s29, 32768
    buffer_load_dwordx4 v7, s[52:55], s36 offen lds
    s_add_u32 m0, s32, 2048
    s_add_u32 s36, s29, 65536
    buffer_load_dwordx4 v7, s[52:55], s36 offen lds
    s_add_u32 m0, s32, 3072
    s_add_u32 s36, s29, 98304
    buffer_load_dwordx4 v7, s[52:55], s36 offen lds
    s_add_u32 m0, s32, 4096
    s_add_u32 s36, s29, 131072
    buffer_load_dwordx4 v7, s[52:55], s36 offen lds
    s_add_u32 m0, s32, 5120
    s_add_u32 s36, s29, 163840
    buffer_load_dwordx4 v7, s[52:55], s36 offen lds
    s_add_u32 m0, s32, 6144
    s_add_u32 s36, s29, 196608
    buffer_load_dwordx4 v7, s[52:55], s36 offen lds
    s_add_u32 m0, s32, 7168
    s_add_u32 s36, s29, 229376
    buffer_load_dwordx4 v7, s[52:55], s36 offen lds
    s_add_u32 s29, s29, 524288
    s_add_u32 s32, s32, 16384
    s_sub_u32 s33, s33, 1
    s_waitcnt vmcnt(12)
    s_cmp_lg_u32 s33, 0
    s_cbranch_scc1 L_wf_55
    s_waitcnt vmcnt(24)
    s_barrier
    s_cmp_eq_u32 s61, 15
    s_cselect_b32 s36, 1, s3
    s_cmp_eq_u32 s36, 0
    s_cbranch_scc1 tl_l_p4
    s_waitcnt vmcnt(0)
    s_barrier
    s_cmp_lg_u32 s3, 0
    s_cbranch_scc1 attn_exit
    s_barrier
    s_barrier
    s_branch tl_again
tl_l_p4:
    v_add_u32 v11, 131072, v9
    s_add_u32 s36, s31, 737280
    buffer_load_dwordx4 v[16:19], v8, s[16:19], s36 offen
    s_add_u32 s36, s31, 737408
    buffer_load_dwordx4 v[20:23], v8, s[16:19], s36 offen
    s_add_u32 s36, s31, 768000
    buffer_load_dwordx4 v[24:27], v8, s[16:19], s36 offen
    s_add_u32 s36, s31, 768128
    buffer_load_dwordx4 v[28:31], v8, s[16:19], s36 offen
    s_add_u32 s36, s31, 798720
    buffer_load_dwordx4 v[32:35], v8, s[16:19], s36 offen
    s_add_u32 s36, s31, 798848
    buffer_load_dwordx4 v[36:39], v8, s[16:19], s36 offen
    s_add_u32 s36, s31, 829440
    buffer_load_dwordx4 v[40:43], v8, s[16:19], s36 offen
    s_add_u32 s36, s31, 829568
    buffer_load_dwordx4 v[44:47], v8, s[16:19], s36 offen
    s_add_u32 s36, s31, 983040
    buffer_load_dwordx4 v[48:51], v8, s[16:19], s36 offen
    s_add_u32 s36, s31, 983168
    buffer_load_dwordx4 v[52:55], v8, s[16:19], s36 offen
    s_add_u32 s36, s31, 1013760
    buffer_load_dwordx4 v[56:59], v8, s[16:19], s36 offen
    s_add_u32 s36, s31, 1013888
    buffer_load_dwordx4 v[60:63], v8, s[16:19], s36 offen
    s_add_u32 s36, s31, 1044480
    buffer_load_dwordx4 v[64:67], v8, s[16:19], s36 offen
    s_add_u32 s36, s31, 1044608
    buffer_load_dwordx4 v[68:71], v8, s[16:19], s36 offen
    s_add_u32 s36, s31, 1075200
    buffer_load_dwordx4 v[72:75], v8, s[16:19], s36 offen
    s_add_u32 s36, s31, 1075328
    buffer_load_dwordx4 v[76:79], v8, s[16:19], s36 offen
    s_add_u32 s36, s31, 1228800
    buffer_load_dwordx4 v[80:83], v8, s[16:19], s36 offen
    s_add_u32 s36, s31, 1228928
    buffer_load_dwordx4 v[84:87], v8, s[16:19], s36 offen
    s_add_u32 s36, s31, 1259520
    buffer_load_dwordx4 v[88:91], v8, s[16:19], s36 offen
    s_add_u32 s36, s31, 1259648
    buffer_load_dwordx4 v[92:95], v8, s[16:19], s36 offen
    s_add_u32 s36, s31, 1290240
    buffer_load_dwordx4 v[96:99], v8, s[16:19], s36 offen
    s_add_u32 s36, s31, 1290368
    buffer_load_dwordx4 v[100:103], v8, s[16:19], s36 offen
    s_add_u32 s36, s31, 1320960
    buffer_load_dwordx4 v[104:107], v8, s[16:19], s36 offen
    s_add_u32 s36, s31, 1321088
    buffer_load_dwordx4 v[108:111], v8, s[16:19], s36 offen
    s_waitcnt vmcnt(24)
    s_barrier
    s_add_u32 s36, s31, 1474560
    buffer_load_dwordx4 v[112:115], v8, s[16:19], s36 offen
    s_add_u32 s36, s31, 1474688
    buffer_load_dwordx4 v[116:119], v8, s[16:19], s36 offen
    s_add_u32 s36, s31, 1505280
    buffer_load_dwordx4 v[120:123], v8, s[16:19], s36 offen
    s_add_u32 s36, s31, 1505408
    buffer_load_dwordx4 v[124:127], v8, s[16:19], s36 offen
    s_add_u32 s36, s31, 1536000
    buffer_load_dwordx4 v[128:131], v8, s[16:19], s36 offen
    s_add_u32 s36, s31, 1536128
    buffer_load_dwordx4 v[132:135], v8, s[16:19], s36 offen
    s_add_u32 s36, s31, 1566720
    buffer_load_dwordx4 v[136:139], v8, s[16:19], s36 offen
    s_add_u32 s36, s31, 1566848
    buffer_load_dwordx4 v[140:143], v8, s[16:19], s36 offen
    s_add_u32 s36, s31, 1720320
    buffer_load_dwordx4 v[144:147], v8, s[16:19], s36 offen
    s_add_u32 s36, s31, 1720448
    buffer_load_dwordx4 v[148:151], v8, s[16:19], s36 offen
    s_add_u32 s36, s31, 1751040
    buffer_load_dwordx4 v[152:155], v8, s[16:19], s36 offen
    s_add_u32 s36, s31, 1751168
    buffer_load_dwordx4 v[156:159], v8, s[16:19], s36 offen
    s_add_u32 s36, s31, 1781760
    buffer_load_dwordx4 v[160:163], v8, s[16:19], s36 offen
    s_add_u32 s36, s31, 1781888
    buffer_load_dwordx4 v[164:167], v8, s[16:19], s36 offen
    s_add_u32 s36, s31, 1812480
    buffer_load_dwordx4 v[168:171], v8, s[16:19], s36 offen
    s_add_u32 s36, s31, 1812608
    buffer_load_dwordx4 v[172:175], v8, s[16:19], s36 offen
    s_add_u32 s36, s31, 1966080
    buffer_load_dwordx4 v[176:179], v8, s[16:19], s36 offen
    s_add_u32 s36, s31, 1966208
    buffer_load_dwordx4 v[180:183], v8, s[16:19], s36 offen
    s_add_u32 s36, s31, 1996800
    buffer_load_dwordx4 v[184:187], v8, s[16:19], s36 offen
    s_add_u32 s36, s31, 1996928
    buffer_load_dwordx4 v[188:191], v8, s[16:19], s36 offen
    s_add_u32 s36, s31, 2027520
    buffer_load_dwordx4 v[192:195], v8, s[16:19], s36 offen
    s_add_u32 s36, s31, 2027648
    buffer_load_dwordx4 v[196:199], v8, s[16:19], s36 offen
    s_add_u32 s36, s31, 2058240
    buffer_load_dwordx4 v[200:203], v8, s[16:19], s36 offen
    s_add_u32 s36, s31, 2058368
    buffer_load_dwordx4 v[204:207], v8, s[16:19], s36 offen
    s_barrier
    s_add_u32 s32, s43, 0
    s_mov_b32 s33, 2
L_wf_56:
    s_add_u32 m0, s32, 0
    s_add_u32 s36, s31, 0
    buffer_load_dwordx4 v8, s[16:19], s36 offen lds
    s_add_u32 m0, s32, 1024
    s_add_u32 s36, s31, 128
    buffer_load_dwordx4 v8, s[16:19], s36 offen lds
    s_add_u32 m0, s32, 2048
    s_add_u32 s36, s31, 30720
    buffer_load_dwordx4 v8, s[16:19], s36 offen lds
    s_add_u32 m0, s32, 3072
    s_add_u32 s36, s31, 30848
    buffer_load_dwordx4 v8, s[16:19], s36 offen lds
    s_add_u32 m0, s32, 4096
    s_add_u32 s36, s31, 61440
    buffer_load_dwordx4 v8, s[16:19], s36 offen lds
    s_add_u32 m0, s32, 5120
    s_add_u32 s36, s31, 61568
    buffer_load_dwordx4 v8, s[16:19], s36 offen lds
    s_add_u32 m0, s32, 6144
    s_add_u32 s36, s31, 92160
    buffer_load_dwordx4 v8, s[16:19], s36 offen lds
    s_add_u32 m0, s32, 7168
    s_add_u32 s36, s31, 92288
    buffer_load_dwordx4 v8, s[16:19], s36 offen lds
    s_add_u32 s31, s31, 245760
    s_add_u32 s32, s32, 16384
    s_sub_u32 s33, s33, 1
    s_waitcnt vmcnt(12)
    s_cmp_lg_u32 s33, 0
    s_cbranch_scc1 L_wf_56
    s_barrier
    s_add_u32 s32, s43, 32768
    s_mov_b32 s33, 1
L_wf_57:
    s_add_u32 m0, s32, 0
    s_add_u32 s36, s31, 0
    buffer_load_dwordx4 v8, s[16:19], s36 offen lds
    s_add_u32 m0, s32, 1024
    s_add_u32 s36, s31, 128
    buffer_load_dwordx4 v8, s[16:19], s36 offen lds
    s_add_u32 m0, s32, 2048
    s_add_u32 s36, s31, 30720
    buffer_load_dwordx4 v8, s[16:19], s36 offen lds
    s_add_u32 m0, s32, 3072
    s_add_u32 s36, s31, 30848
    buffer_load_dwordx4 v8, s[16:19], s36 offen lds
    s_add_u32 m0, s32, 4096
    s_add_u32 s36, s31, 61440
    buffer_load_dwordx4 v8, s[16:19], s36 offen lds
    s_add_u32 m0, s32, 5120
    s_add_u32 s36, s31, 61568
    buffer_load_dwordx4 v8, s[16:19], s36 offen lds
    s_add_u32 m0, s32, 6144
    s_add_u32 s36, s31, 92160
    buffer_load_dwordx4 v8, s[16:19], s36 offen lds
    s_add_u32 m0, s32, 7168
    s_add_u32 s36, s31, 92288
    buffer_load_dwordx4 v8, s[16:19], s36 offen lds
    s_add_u32 s31, s31, 245760
    s_add_u32 s32, s32, 16384
    s_sub_u32 s33, s33, 1
    s_waitcnt vmcnt(12)
    s_cmp_lg_u32 s33, 0
    s_cbranch_scc1 L_wf_57
    ds_write_b128 v9, v[16:19] offset:49152
    ds_write_b128 v9, v[20:23] offset:50176
    ds_write_b128 v9, v[24:27] offset:51200
    ds_write_b128 v9, v[28:31] offset:52224
    ds_write_b128 v9, v[32:35] offset:53248
    ds_write_b128 v9, v[36:39] offset:54272
    ds_write_b128 v9, v[40:43] offset:55296
    ds_write_b128 v9, v[44:47] offset:56320
    ds_write_b128 v10, v[48:51] offset:0
    ds_write_b128 v10, v[52:55] offset:1024
    ds_write_b128 v10, v[56:59] offset:2048
    ds_write_b128 v10, v[60:63] offset:3072
    ds_write_b128 v10, v[64:67] offset:4096
    ds_write_b128 v10, v[68:71] offset:5120
    ds_write_b128 v10, v[72:75] offset:6144
    ds_write_b128 v10, v[76:79] offset:7168
    ds_write_b128 v10, v[80:83] offset:16384
    ds_write_b128 v10, v[84:87] offset:17408
    ds_write_b128 v10, v[88:91] offset:18432
    ds_write_b128 v10, v[92:95] offset:19456
    ds_write_b128 v10, v[96:99] offset:20480
    ds_write_b128 v10, v[100:103] offset:21504
    ds_write_b128 v10, v[104:107] offset:22528
    ds_write_b128 v10, v[108:111] offset:23552
    ds_write_b128 v10, v[112:115] offset:32768
    ds_write_b128 v10, v[116:119] offset:33792
    ds_write_b128 v10, v[120:123] offset:34816
    ds_write_b128 v10, v[124:127] offset:35840
    ds_write_b128 v10, v[128:131] offset:36864
    ds_write_b128 v10, v[132:135] offset:37888
    ds_write_b128 v10, v[136:139] offset:38912
    ds_write_b128 v10, v[140:143] offset:39936
    ds_write_b128 v10, v[144:147] offset:49152
    ds_write_b128 v10, v[148:151] offset:50176
    ds_write_b128 v10, v[152:155] offset:51200
    ds_write_b128 v10, v[156:159] offset:52224
    ds_write_b128 v10, v[160:163] offset:53248
    ds_write_b128 v10, v[164:167] offset:54272
    ds_write_b128 v10, v[168:171] offset:55296
    ds_write_b128 v10, v[172:175] offset:56320
    s_add_u32 s31, s31, 1474560
    s_waitcnt vmcnt(0) lgkmcnt(0)
    s_barrier
    ds_write_b128 v11, v[176:179] offset:0
    ds_write_b128 v11, v[180:183] offset:1024
    ds_write_b128 v11, v[184:187] offset:2048
    ds_write_b128 v11, v[188:191] offset:3072
    ds_write_b128 v11, v[192:195] offset:4096
    ds_write_b128 v11, v[196:199] offset:5120
    ds_write_b128 v11, v[200:203] offset:6144
    ds_write_b128 v11, v[204:207] offset:7168
    s_barrier
    s_add_u32 s32, s43, 0
    s_mov_b32 s33, 1
L_wf_58:
    s_add_u32 m0, s32, 0
    s_add_u32 s36, s31, 0
    buffer_load_dwordx4 v8, s[16:19], s36 offen lds
    s_add_u32 m0, s32, 1024
    s_add_u32 s36, s31, 128
    buffer_load_dwordx4 v8, s[16:19], s36 offen lds
    s_add_u32 m0, s32, 2048
    s_add_u32 s36, s31, 30720
    buffer_load_dwordx4 v8, s[16:19], s36 offen lds
    s_add_u32 m0, s32, 3072
    s_add_u32 s36, s31, 30848
    buffer_load_dwordx4 v8, s[16:19], s36 offen lds
    s_add_u32 m0, s32, 4096
    s_add_u32 s36, s31, 61440
    buffer_load_dwordx4 v8, s[16:19], s36 offen lds
    s_add_u32 m0, s32, 5120
    s_add_u32 s36, s31, 61568
    buffer_load_dwordx4 v8, s[16:19], s36 offen lds
    s_add_u32 m0, s32, 6144
    s_add_u32 s36, s31, 92160
    buffer_load_dwordx4 v8, s[16:19], s36 offen lds
    s_add_u32 m0, s32, 7168
    s_add_u32 s36, s31, 92288
    buffer_load_dwordx4 v8, s[16:19], s36 offen lds
    s_add_u32 s31, s31, 245760
    s_add_u32 s32, s32, 16384
    s_sub_u32 s33, s33, 1
    s_waitcnt vmcnt(12)
    s_cmp_lg_u32 s33, 0
    s_cbranch_scc1 L_wf_58
    s_waitcnt vmcnt(0) lgkmcnt(0)
    s_barrier
    s_branch tl_again
tl_sig:
    v_lshlrev_b32 v2, 2, v1
    v_add_u32 v2, 159808, v2
    v_mov_b32 v3, 0
    s_mov_b64 exec, 0xff
    ds_write_b32 v2, v3
    s_mov_b64 exec, -1
    s_lshr_b32 s36, s34, 1
    s_lshl_b32 s36, s36, 10
    s_mul_i32 s37, s35, 196608
    s_add_u32 s36, s36, s37
    s_add_u32 s36, s36, 384
    v_min_u32 v6, 47, v1
    v_lshl_add_u32 v6, v6, 12, s36
    s_waitcnt lgkmcnt(0)
    s_barrier
    s_barrier
    s_barrier
    s_cmp_eq_u32 s42, 0
    s_cbranch_scc1 tl_idle_p3a
    s_barrier
    s_barrier
    buffer_load_dword v8, v6, s[52:55], 0 offen
    s_lshl_b32 s36, s24, 14
    s_sub_u32 s36, s36, 65536
    v_lshl_add_u32 v11, v1, 4, s36
    ds_write_b128 v11, v[184:187] offset:0
    ds_write_b128 v11, v[188:191] offset:1024
    ds_write_b128 v11, v[192:195] offset:2048
    ds_write_b128 v11, v[196:199] offset:3072
    ds_write_b128 v11, v[200:203] offset:4096
    ds_write_b128 v11, v[204:207] offset:5120
    ds_write_b128 v11, v[208:211] offset:6144
    ds_write_b128 v11, v[212:215] offset:7168
    ds_write_b128 v11, v[216:219] offset:8192
    ds_write_b128 v11, v[220:223] offset:9216
    ds_write_b128 v11, v[224:227] offset:10240
    ds_write_b128 v11, v[228:231] offset:11264
    ds_write_b128 v11, v[232:235] offset:12288
    ds_write_b128 v11, v[236:239] offset:13312
    ds_write_b128 v11, v[240:243] offset:14336
    ds_write_b128 v11, v[244:247] offset:15360
    s_waitcnt lgkmcnt(0)
    s_barrier
    s_barrier
    s_barrier
    s_barrier
    s_branch tl_idle_p3
tl_idle_p3a:
    buffer_load_dword v8, v6, s[52:55], 0 offen
tl_idle_p3:
    s_barrier
    s_waitcnt lgkmcnt(0)
    s_mov_b32 s16, s6
    s_mov_b32 s17, s7
    s_mov_b32 s18, 4096
    s_mov_b32 s19, 0x00020000
    s_lshl_b32 s36, s38, 7
    s_movk_i32 s37, 6554
    s_cmp_eq_u32 s3, 0
    s_cselect_b64 vcc, -1, 0
    v_add_u32 v2, 0, v0
    v_mul_u32_u24 v3, s37, v2
    v_lshrrev_b32 v3, 16, v3
    v_mul_u32_u24 v234, 10, v3
    v_sub_u32 v234, v2, v234
    v_lshrrev_b32 v2, 6, v2
    v_cndmask_b32 v3, v3, v1, vcc
    v_cndmask_b32 v2, v234, v2, vcc
    v_mul_u32_u24 v236, 336, v3
    v_lshl_add_u32 v236, v2, 5, v236
    v_add_u32 v236, 49152, v236
    v_mul_u32_u24 v238, 176, v3
    v_lshl_add_u32 v238, v2, 4, v238
    v_add_u32 v238, 147456, v238
    v_mul_u32_u24 v234, 1280, v3
    v_lshl_add_u32 v234, v2, 4, v234
    v_lshrrev_b32 v240, 5, v3
    v_mul_u32_u24 v240, 40448, v240
    v_lshl_add_u32 v240, v3, 4, v240
    v_lshl_add_u32 v240, v2, 9, v240
    v_cndmask_b32 v234, v234, v240, vcc
    v_lshlrev_b32 v3, 1, v3
    buffer_load_ushort v240, v3, s[16:19], s36 offen
    v_add_u32 v2, 384, v0
    v_mul_u32_u24 v3, s37, v2
    v_lshrrev_b32 v3, 16, v3
    v_mul_u32_u24 v235, 10, v3
    v_sub_u32 v235, v2, v235
    v_lshrrev_b32 v2, 6, v2
    v_cndmask_b32 v3, v3, v1, vcc
    v_cndmask_b32 v2, v235, v2, vcc
    v_mul_u32_u24 v237, 336, v3
    v_lshl_add_u32 v237, v2, 5, v237
    v_add_u32 v237, 49152, v237
    v_mul_u32_u24 v239, 176, v3
    v_lshl_add_u32 v239, v2, 4, v239
    v_add_u32 v239, 147456, v239
    v_mul_u32_u24 v235, 1280, v3
    v_lshl_add_u32 v235, v2, 4, v235
    v_lshrrev_b32 v241, 5, v3
    v_mul_u32_u24 v241, 40448, v241
    v_lshl_add_u32 v241, v3, 4, v241
    v_lshl_add_u32 v241, v2, 9, v241
    v_cndmask_b32 v235, v235, v241, vcc
    v_lshlrev_b32 v3, 1, v3
    buffer_load_ushort v241, v3, s[16:19], s36 offen
    s_barrier
    s_barrier
    s_barrier
    s_branch tl_ep2
tl_sync:
    s_setprio 3
    s_lshr_b32 s28, s38, 2
    s_lshr_b32 s36, s2, 3
    s_and_b32 s36, s36, 3
    s_mul_i32 s36, s36, 1024
    s_add_u32 s30, s36, 20709376
    s_add_u32 s30, s30, s50
    s_mul_i32 s36, s28, 4096
    s_mul_i32 s37, s28, 4096
    v_mov_b32 v2, s36
    v_mov_b32 v3, s37
    v_cmp_gt_u32 vcc, 32, v1
    v_and_b32 v15, 31, v1
    v_min_u32 v15, 31, v15
    v_mul_u32_u24 v15, 32, v15
    v_cndmask_b32 v2, v3, v2, vcc
    v_add_u32 v2, v15, v2
    s_sleep 20
tl_pa_nod:
    s_mov_b32 s35, 0
    s_mov_b64 exec, 0xffffffff
tl_pa_wait:
    buffer_load_dword v3, v2, s[12:15], s30 offen sc1
    s_add_u32 s35, s35, 1
    s_waitcnt vmcnt(0)
    v_cmp_eq_u32 vcc, 0, v3
    s_cmp_gt_u32 s35, 524288
    s_cbranch_scc1 tl_pa_go
    s_and_b64 exec, exec, vcc
    s_cbranch_scc1 tl_pa_wait
tl_pa_go:
    s_mov_b64 exec, -1
    s_barrier
    s_lshl_b32 s31, s38, 12
    s_add_u32 s31, s31, s51
    v_lshlrev_b32 v6, 3, v1
    v_add_u32 v7, 160000, v6
    s_mov_b32 s35, 0
    s_barrier
    v_mov_b32 v15, 159820
    s_mov_b32 s35, 0
tl_g_own:
    ds_read_b32 v3, v15
    s_add_u32 s35, s35, 1
    s_waitcnt lgkmcnt(0)
    v_readfirstlane_b32 s36, v3
    s_cmp_gt_u32 s35, 524288
    s_cbranch_scc1 tl_g_ownx
    s_cmp_ge_u32 s36, 4
    s_cbranch_scc1 tl_g_ownx
    s_sleep 1
    s_branch tl_g_own
tl_g_ownx:
    s_sleep 12
tl_gpoll:
    buffer_load_dwordx2 v[8:9], v6, s[12:15], s31 offen offset:0 sc1
    buffer_load_dwordx2 v[10:11], v6, s[12:15], s31 offen offset:512 sc1
    buffer_load_dwordx2 v[12:13], v6, s[12:15], s31 offen offset:1024 sc1
    buffer_load_dwordx2 v[14:15], v6, s[12:15], s31 offen offset:1536 sc1
    buffer_load_dwordx2 v[16:17], v6, s[12:15], s31 offen offset:2048 sc1
    buffer_load_dwordx2 v[18:19], v6, s[12:15], s31 offen offset:2560 sc1
    buffer_load_dwordx2 v[20:21], v6, s[12:15], s31 offen offset:3072 sc1
    buffer_load_dwordx2 v[22:23], v6, s[12:15], s31 offen offset:3584 sc1
    s_add_u32 s35, s35, 1
    s_waitcnt vmcnt(0)
    v_max3_u32 v2, v9, v11, v13
    v_max3_u32 v3, v15, v17, v19
    v_max3_u32 v2, v21, v23, v2
    v_max_u32 v2, v2, v3
    v_cmp_eq_u32 vcc, -1, v2
    s_cmp_gt_u32 s35, 524288
    s_cbranch_scc1 tl_got
    s_cmp_lg_u64 vcc, 0
    s_cbranch_scc1 tl_gpoll
tl_got:
    v_add_f32 v8, v8, v16
    v_add_f32 v9, v9, v17
    v_add_f32 v10, v10, v18
    v_add_f32 v11, v11, v19
    v_add_f32 v12, v12, v20
    v_add_f32 v13, v13, v21
    v_add_f32 v14, v14, v22
    v_add_f32 v15, v15, v23
    v_add_f32 v8, v8, v12
    v_add_f32 v9, v9, v13
    v_add_f32 v10, v10, v14
    v_add_f32 v11, v11, v15
    v_add_f32 v8, v8, v10
    v_add_f32 v9, v9, v11
    v_mul_f32 v8, 0x3acccccd, v8
    v_mul_f32 v9, 0x3acccccd, v9
    v_fma_f32 v9, -v8, v8, v9
    v_max_f32 v9, 0, v9
    v_add_f32 v10, 0x3727c5ac, v9
    v_rsq_f32 v10, v10
    s_nop 0
    v_mul_f32 v9, v9, v10
    v_mul_f32 v9, v9, v10
    v_add_f32 v9, 0x3727c5ac, v9
    v_rsq_f32 v9, v9
    s_nop 0
    v_mul_f32 v9, v9, v10
    v_mul_f32 v8, -v8, v9
    ds_write_b64 v7, v[8:9]
    s_waitcnt lgkmcnt(0)
    s_barrier
    s_cmp_eq_u32 s42, 0
    s_cbranch_scc1 tl_s_p3
    s_mul_i32 s28, s40, 205
    s_add_u32 s29, s28, 201
    s_lshr_b32 s28, s28, 8
    s_lshr_b32 s29, s29, 8
    s_lshr_b32 s36, s2, 3
    s_and_b32 s36, s36, 3
    s_mul_i32 s36, s36, 1024
    s_add_u32 s30, s36, 20742144
    s_add_u32 s30, s30, s50
    s_mul_i32 s36, s28, 4096
    s_mul_i32 s37, s29, 4096
    v_mov_b32 v2, s36
    v_mov_b32 v3, s37
    v_cmp_gt_u32 vcc, 32, v1
    v_and_b32 v15, 31, v1
    v_min_u32 v15, 31, v15
    v_mul_u32_u24 v15, 32, v15
    v_cndmask_b32 v2, v3, v2, vcc
    v_add_u32 v2, v15, v2
    v_mov_b32 v15, 159808
    s_mov_b32 s35, 0
tl_ph_own:
    ds_read_b32 v3, v15
    s_add_u32 s35, s35, 1
    s_waitcnt lgkmcnt(0)
    v_readfirstlane_b32 s36, v3
    s_cmp_gt_u32 s35, 524288
    s_cbranch_scc1 tl_ph_ownx
    s_cmp_ge_u32 s36, 4
    s_cbranch_scc1 tl_ph_ownx
    s_sleep 1
    s_branch tl_ph_own
tl_ph_ownx:
    s_sleep 20
tl_ph_nod:
    s_mov_b32 s35, 0
tl_ph_wait:
    buffer_load_dword v3, v2, s[12:15], s30 offen sc1
    s_add_u32 s35, s35, 1
    s_waitcnt vmcnt(0)
    v_cmp_eq_u32 vcc, 0, v3
    s_cmp_gt_u32 s35, 524288
    s_cbranch_scc1 tl_ph_go
    s_and_b64 exec, exec, vcc
    s_cbranch_scc1 tl_ph_wait
tl_ph_go:
    s_mov_b64 exec, -1
    s_barrier
    s_barrier
    s_lshl_b32 s36, s24, 14
    s_sub_u32 s36, s36, 65536
    v_lshl_add_u32 v11, v1, 4, s36
    ds_write_b128 v11, v[184:187] offset:0
    ds_write_b128 v11, v[188:191] offset:1024
    ds_write_b128 v11, v[192:195] offset:2048
    ds_write_b128 v11, v[196:199] offset:3072
    ds_write_b128 v11, v[200:203] offset:4096
    ds_write_b128 v11, v[204:207] offset:5120
    ds_write_b128 v11, v[208:211] offset:6144
    ds_write_b128 v11, v[212:215] offset:7168
    ds_write_b128 v11, v[216:219] offset:8192
    ds_write_b128 v11, v[220:223] offset:9216
    ds_write_b128 v11, v[224:227] offset:10240
    ds_write_b128 v11, v[228:231] offset:11264
    ds_write_b128 v11, v[232:235] offset:12288
    ds_write_b128 v11, v[236:239] offset:13312
    ds_write_b128 v11, v[240:243] offset:14336
    ds_write_b128 v11, v[244:247] offset:15360
    s_waitcnt lgkmcnt(0)
    s_barrier
    s_barrier
    s_barrier
    s_barrier
    s_branch tl_s_p3b
tl_s_p3:
    v_mov_b32 v2, 159812
    v_mov_b32 v3, 4
    ds_write_b32 v2, v3
tl_s_p3b:
    s_mul_i32 s28, s39, 5
    s_add_u32 s29, s28, 4
    s_lshr_b32 s28, s28, 2
    s_lshr_b32 s29, s29, 2
    s_lshr_b32 s36, s2, 3
    s_and_b32 s36, s36, 3
    s_mul_i32 s36, s36, 1024
    s_add_u32 s30, s36, 20774912
    s_add_u32 s30, s30, s50
    s_mul_i32 s36, s28, 4096
    s_mul_i32 s37, s29, 4096
    v_mov_b32 v2, s36
    v_mov_b32 v3, s37
    v_cmp_gt_u32 vcc, 32, v1
    v_and_b32 v15, 31, v1
    v_min_u32 v15, 23, v15
    v_mul_u32_u24 v15, 32, v15
    v_cndmask_b32 v2, v3, v2, vcc
    v_add_u32 v2, v15, v2
    v_mov_b32 v15, 159812
    s_mov_b32 s35, 0
tl_pu_own:
    ds_read_b32 v3, v15
    s_add_u32 s35, s35, 1
    s_waitcnt lgkmcnt(0)
    v_readfirstlane_b32 s36, v3
    s_cmp_gt_u32 s35, 524288
    s_cbranch_scc1 tl_pu_ownx
    s_cmp_ge_u32 s36, 4
    s_cbranch_scc1 tl_pu_ownx
    s_sleep 1
    s_branch tl_pu_own
tl_pu_ownx:
    s_cmp_lg_u32 s42, 0
    s_cbranch_scc1 tl_pu_px
    s_mov_b32 s35, 0
    s_mov_b64 exec, 1
tl_pu_pw:
    s_sleep 8
    buffer_load_dword v3, v2, s[12:15], s30 offen sc1
    s_add_u32 s35, s35, 1
    s_waitcnt vmcnt(0)
    v_cmp_eq_u32 vcc, 0, v3
    s_cmp_gt_u32 s35, 524288
    s_cbranch_scc1 tl_pu_py
    s_cmp_lg_u64 vcc, 0
    s_cbranch_scc1 tl_pu_pw
tl_pu_py:
    s_mov_b64 exec, -1
    s_branch tl_pu_nod
tl_pu_px:
    s_sleep 20
tl_pu_nod:
    s_mov_b32 s35, 0
tl_pu_wait:
    buffer_load_dword v3, v2, s[12:15], s30 offen sc1
    s_add_u32 s35, s35, 1
    s_waitcnt vmcnt(0)
    v_cmp_eq_u32 vcc, 0, v3
    s_cmp_gt_u32 s35, 524288
    s_cbranch_scc1 tl_pu_go
    s_and_b64 exec, exec, vcc
    s_cbranch_scc1 tl_pu_wait
tl_pu_go:
    s_mov_b64 exec, -1
    s_barrier
    s_waitcnt lgkmcnt(0)
    s_mov_b32 s16, s6
    s_mov_b32 s17, s7
    s_mov_b32 s18, 4096
    s_mov_b32 s19, 0x00020000
    s_lshl_b32 s36, s38, 7
    s_movk_i32 s37, 6554
    s_cmp_eq_u32 s3, 0
    s_cselect_b64 vcc, -1, 0
    v_add_u32 v2, 0, v0
    v_mul_u32_u24 v3, s37, v2
    v_lshrrev_b32 v3, 16, v3
    v_mul_u32_u24 v234, 10, v3
    v_sub_u32 v234, v2, v234
    v_lshrrev_b32 v2, 6, v2
    v_cndmask_b32 v3, v3, v1, vcc
    v_cndmask_b32 v2, v234, v2, vcc
    v_mul_u32_u24 v236, 336, v3
    v_lshl_add_u32 v236, v2, 5, v236
    v_add_u32 v236, 49152, v236
    v_mul_u32_u24 v238, 176, v3
    v_lshl_add_u32 v238, v2, 4, v238
    v_add_u32 v238, 147456, v238
    v_mul_u32_u24 v234, 1280, v3
    v_lshl_add_u32 v234, v2, 4, v234
    v_lshrrev_b32 v240, 5, v3
    v_mul_u32_u24 v240, 40448, v240
    v_lshl_add_u32 v240, v3, 4, v240
    v_lshl_add_u32 v240, v2, 9, v240
    v_cndmask_b32 v234, v234, v240, vcc
    v_lshlrev_b32 v3, 1, v3
    buffer_load_ushort v240, v3, s[16:19], s36 offen
    v_add_u32 v2, 384, v0
    v_mul_u32_u24 v3, s37, v2
    v_lshrrev_b32 v3, 16, v3
    v_mul_u32_u24 v235, 10, v3
    v_sub_u32 v235, v2, v235
    v_lshrrev_b32 v2, 6, v2
    v_cndmask_b32 v3, v3, v1, vcc
    v_cndmask_b32 v2, v235, v2, vcc
    v_mul_u32_u24 v237, 336, v3
    v_lshl_add_u32 v237, v2, 5, v237
    v_add_u32 v237, 49152, v237
    v_mul_u32_u24 v239, 176, v3
    v_lshl_add_u32 v239, v2, 4, v239
    v_add_u32 v239, 147456, v239
    v_mul_u32_u24 v235, 1280, v3
    v_lshl_add_u32 v235, v2, 4, v235
    v_lshrrev_b32 v241, 5, v3
    v_mul_u32_u24 v241, 40448, v241
    v_lshl_add_u32 v241, v3, 4, v241
    v_lshl_add_u32 v241, v2, 9, v241
    v_cndmask_b32 v235, v235, v241, vcc
    v_lshlrev_b32 v3, 1, v3
    buffer_load_ushort v241, v3, s[16:19], s36 offen
    s_barrier
    s_barrier
    s_barrier
    s_branch tl_ep2
tl_cons:
    s_setprio 2
    s_mul_i32 s36, s24, 2560
    s_add_u32 s36, s36, 51200
    v_mul_u32_u24 v10, 160, v4
    v_lshl_add_u32 v10, v5, 3, v10
    v_add_u32 v10, s36, v10
    s_waitcnt lgkmcnt(0)
    s_and_b32 s46, s24, 1
    s_lshr_b32 s47, s24, 1
    s_mov_b32 s16, s4
    s_mov_b32 s17, s5
    s_mov_b32 s18, 3072
    s_mov_b32 s19, 0x00020000
    s_lshl_b32 s37, s41, 7
    s_lshl_b32 s36, s47, 6
    s_add_u32 s37, s37, s36
    v_lshrrev_b32 v2, 5, v1
    v_lshlrev_b32 v3, 3, v2
    buffer_load_dwordx2 v[224:225], v3, s[16:19], s37 offen offset:0
    buffer_load_dwordx2 v[226:227], v3, s[16:19], s37 offen offset:16
    buffer_load_dwordx2 v[228:229], v3, s[16:19], s37 offen offset:32
    buffer_load_dwordx2 v[230:231], v3, s[16:19], s37 offen offset:48
    s_lshl_b32 s36, s40, 2
    s_lshl_b32 s37, s46, 1
    s_add_u32 s36, s36, s37
    s_mul_i32 s36, s36, 48
    s_lshl_b32 s37, s41, 1
    s_add_u32 s36, s36, s37
    s_add_u32 s36, s36, s47
    s_lshl_b32 s36, s36, 10
    s_add_u32 s49, s36, 13107200
    v_bfe_u32 v3, v1, 4, 1
    v_mul_u32_u24 v3, 49152, v3
    v_lshl_add_u32 v3, v2, 8, v3
    v_lshl_add_u32 v233, v4, 4, v3
    s_mov_b32 s16, s6
    s_mov_b32 s17, s7
    s_mov_b32 s18, 4096
    s_mov_b32 s19, 0x00020000
    s_lshl_b32 s36, s38, 7
    s_movk_i32 s37, 6554
    s_cmp_eq_u32 s3, 0
    s_cselect_b64 vcc, -1, 0
    v_add_u32 v2, 0, v0
    v_mul_u32_u24 v3, s37, v2
    v_lshrrev_b32 v3, 16, v3
    v_mul_u32_u24 v234, 10, v3
    v_sub_u32 v234, v2, v234
    v_lshrrev_b32 v2, 6, v2
    v_cndmask_b32 v3, v3, v1, vcc
    v_cndmask_b32 v2, v234, v2, vcc
    v_mul_u32_u24 v236, 336, v3
    v_lshl_add_u32 v236, v2, 5, v236
    v_add_u32 v236, 49152, v236
    v_mul_u32_u24 v238, 176, v3
    v_lshl_add_u32 v238, v2, 4, v238
    v_add_u32 v238, 147456, v238
    v_mul_u32_u24 v234, 1280, v3
    v_lshl_add_u32 v234, v2, 4, v234
    v_lshrrev_b32 v240, 5, v3
    v_mul_u32_u24 v240, 40448, v240
    v_lshl_add_u32 v240, v3, 4, v240
    v_lshl_add_u32 v240, v2, 9, v240
    v_cndmask_b32 v234, v234, v240, vcc
    v_lshlrev_b32 v3, 1, v3
    buffer_load_ushort v240, v3, s[16:19], s36 offen
    v_add_u32 v2, 384, v0
    v_mul_u32_u24 v3, s37, v2
    v_lshrrev_b32 v3, 16, v3
    v_mul_u32_u24 v235, 10, v3
    v_sub_u32 v235, v2, v235
    v_lshrrev_b32 v2, 6, v2
    v_cndmask_b32 v3, v3, v1, vcc
    v_cndmask_b32 v2, v235, v2, vcc
    v_mul_u32_u24 v237, 336, v3
    v_lshl_add_u32 v237, v2, 5, v237
    v_add_u32 v237, 49152, v237
    v_mul_u32_u24 v239, 176, v3
    v_lshl_add_u32 v239, v2, 4, v239
    v_add_u32 v239, 147456, v239
    v_mul_u32_u24 v235, 1280, v3
    v_lshl_add_u32 v235, v2, 4, v235
    v_lshrrev_b32 v241, 5, v3
    v_mul_u32_u24 v241, 40448, v241
    v_lshl_add_u32 v241, v3, 4, v241
    v_lshl_add_u32 v241, v2, 9, v241
    v_cndmask_b32 v235, v235, v241, vcc
    v_lshlrev_b32 v3, 1, v3
    buffer_load_ushort v241, v3, s[16:19], s36 offen
    ds_read_b64 v[124:125], v10 offset:0
    ds_read_b64 v[126:127], v10 offset:32
    ds_read_b64 v[128:129], v10 offset:64
    ds_read_b64 v[130:131], v10 offset:96
    ds_read_b64 v[132:133], v10 offset:128
    v_lshlrev_b32 v6, 4, v1
    v_lshlrev_b32 v7, 8, v5
    v_lshl_add_u32 v7, v4, 3, v7
    v_lshrrev_b32 v2, 2, v4
    v_mul_u32_u24 v2, 160, v2
    v_and_b32 v3, 3, v1
    v_lshl_add_u32 v2, v3, 3, v2
    v_lshrrev_b32 v3, 1, v5
    v_mul_u32_u24 v8, 3200, v3
    v_and_b32 v3, 1, v5
    v_mul_u32_u24 v3, 640, v3
    v_add3_u32 v8, v8, v3, v2
    v_mul_u32_u24 v9, 6400, v5
    v_add_u32 v9, v9, v2
    s_lshl_b32 s28, s38, 2
    s_add_u32 s28, s28, s24
    s_lshl_b32 s29, s28, 10
    s_mul_i32 s33, s24, 2816
    s_add_u32 s33, s33, 147456
    v_and_b32 v2, 1, v5
    v_lshrrev_b32 v3, 2, v4
    v_lshl_add_u32 v3, v2, 3, v3
    v_mul_u32_u24 v12, 176, v3
    v_lshrrev_b32 v3, 1, v5
    v_lshl_add_u32 v12, v3, 5, v12
    v_and_b32 v3, 3, v1
    v_lshl_add_u32 v12, v3, 3, v12
    v_add_u32 v12, s33, v12
    s_lshl_b32 s36, s24, 7
    s_add_u32 s36, s36, 160000
    v_lshl_add_u32 v13, v2, 6, s36
    v_lshrrev_b32 v2, 5, v1
    v_lshl_add_u32 v14, v2, 30, v6
    s_mul_i32 s34, s28, 20480
    s_mul_i32 s36, s39, 2560
    s_add_u32 s34, s34, s36
    s_add_u32 s34, s34, 17694720
    s_lshl_b32 s32, s38, 12
    s_lshl_b32 s36, s24, 7
    s_add_u32 s32, s32, s36
    s_lshl_b32 s36, s39, 9
    s_add_u32 s32, s32, s36
    s_add_u32 s32, s32, s51
    s_waitcnt lgkmcnt(0)
    v_lshlrev_b32 v24, 16, v124
    v_and_b32 v25, s45, v124
    v_lshlrev_b32 v26, 16, v125
    v_and_b32 v27, s45, v125
    v_lshlrev_b32 v28, 16, v126
    v_and_b32 v29, s45, v126
    v_lshlrev_b32 v30, 16, v127
    v_and_b32 v31, s45, v127
    v_lshlrev_b32 v32, 16, v128
    v_and_b32 v33, s45, v128
    v_lshlrev_b32 v34, 16, v129
    v_and_b32 v35, s45, v129
    v_lshlrev_b32 v36, 16, v130
    v_and_b32 v37, s45, v130
    v_lshlrev_b32 v38, 16, v131
    v_and_b32 v39, s45, v131
    v_lshlrev_b32 v40, 16, v132
    v_and_b32 v41, s45, v132
    v_lshlrev_b32 v42, 16, v133
    v_and_b32 v43, s45, v133
    ds_read_b64_tr_b16 v[124:125], v8 offset:0
    ds_read_b64_tr_b16 v[126:127], v8 offset:1280
    ds_read_b64_tr_b16 v[128:129], v8 offset:32
    ds_read_b64_tr_b16 v[130:131], v8 offset:1312
    ds_read_b64_tr_b16 v[132:133], v8 offset:64
    ds_read_b64_tr_b16 v[134:135], v8 offset:1344
    ds_read_b64_tr_b16 v[136:137], v8 offset:96
    ds_read_b64_tr_b16 v[138:139], v8 offset:1376
    ds_read_b64_tr_b16 v[140:141], v8 offset:128
    ds_read_b64_tr_b16 v[142:143], v8 offset:1408
    ds_read_b64_tr_b16 v[144:145], v8 offset:6400
    ds_read_b64_tr_b16 v[146:147], v8 offset:7680
    ds_read_b64_tr_b16 v[148:149], v8 offset:6432
    ds_read_b64_tr_b16 v[150:151], v8 offset:7712
    ds_read_b64_tr_b16 v[152:153], v8 offset:6464
    ds_read_b64_tr_b16 v[154:155], v8 offset:7744
    ds_read_b64_tr_b16 v[156:157], v8 offset:6496
    ds_read_b64_tr_b16 v[158:159], v8 offset:7776
    ds_read_b64_tr_b16 v[160:161], v8 offset:6528
    ds_read_b64_tr_b16 v[162:163], v8 offset:7808
    ds_read_b64_tr_b16 v[164:165], v8 offset:12800
    ds_read_b64_tr_b16 v[166:167], v8 offset:14080
    ds_read_b64_tr_b16 v[168:169], v8 offset:12832
    ds_read_b64_tr_b16 v[170:171], v8 offset:14112
    ds_read_b64_tr_b16 v[172:173], v8 offset:12864
    ds_read_b64_tr_b16 v[174:175], v8 offset:14144
    ds_read_b64_tr_b16 v[176:177], v8 offset:12896
    ds_read_b64_tr_b16 v[178:179], v8 offset:14176
    ds_read_b64_tr_b16 v[180:181], v8 offset:12928
    ds_read_b64_tr_b16 v[182:183], v8 offset:14208
    ds_read_b64_tr_b16 v[184:185], v8 offset:19200
    ds_read_b64_tr_b16 v[186:187], v8 offset:20480
    ds_read_b64_tr_b16 v[188:189], v8 offset:19232
    ds_read_b64_tr_b16 v[190:191], v8 offset:20512
    ds_read_b64_tr_b16 v[192:193], v8 offset:19264
    ds_read_b64_tr_b16 v[194:195], v8 offset:20544
    ds_read_b64_tr_b16 v[196:197], v8 offset:19296
    ds_read_b64_tr_b16 v[198:199], v8 offset:20576
    ds_read_b64_tr_b16 v[200:201], v8 offset:19328
    ds_read_b64_tr_b16 v[202:203], v8 offset:20608
    s_barrier
    s_add_u32 s36, s29, 7864320
    buffer_load_dwordx4 v[44:47], v6, s[12:15], s36 offen sc1
    s_add_u32 s36, s29, 7995392
    buffer_load_dwordx4 v[48:51], v6, s[12:15], s36 offen sc1
    s_add_u32 s36, s29, 8126464
    buffer_load_dwordx4 v[52:55], v6, s[12:15], s36 offen sc1
    s_add_u32 s36, s29, 8257536
    buffer_load_dwordx4 v[56:59], v6, s[12:15], s36 offen sc1
    s_add_u32 s36, s29, 9961472
    buffer_load_dwordx2 v[60:61], v7, s[12:15], s36 offen offset:0 sc1
    buffer_load_dwordx2 v[62:63], v7, s[12:15], s36 offen offset:128 sc1
    s_add_u32 s36, s29, 8388608
    buffer_load_dwordx4 v[64:67], v6, s[12:15], s36 offen sc1
    s_add_u32 s36, s29, 8519680
    buffer_load_dwordx4 v[68:71], v6, s[12:15], s36 offen sc1
    s_add_u32 s36, s29, 8650752
    buffer_load_dwordx4 v[72:75], v6, s[12:15], s36 offen sc1
    s_waitcnt vmcnt(8) lgkmcnt(10)
    v_mfma_f32_16x16x32_bf16 v[24:27], v[124:127], v[44:47], v[24:27]
    ds_read_b64_tr_b16 v[204:205], v9 offset:2560
    ds_read_b64_tr_b16 v[206:207], v9 offset:5760
    v_mfma_f32_16x16x32_bf16 v[28:31], v[128:131], v[44:47], v[28:31]
    ds_read_b64_tr_b16 v[208:209], v9 offset:2592
    ds_read_b64_tr_b16 v[210:211], v9 offset:5792
    v_mfma_f32_16x16x32_bf16 v[32:35], v[132:135], v[44:47], v[32:35]
    ds_read_b64_tr_b16 v[212:213], v9 offset:2624
    ds_read_b64_tr_b16 v[214:215], v9 offset:5824
    v_mfma_f32_16x16x32_bf16 v[36:39], v[136:139], v[44:47], v[36:39]
    ds_read_b64_tr_b16 v[216:217], v9 offset:2656
    ds_read_b64_tr_b16 v[218:219], v9 offset:5856
    v_mfma_f32_16x16x32_bf16 v[40:43], v[140:143], v[44:47], v[40:43]
    ds_read_b64_tr_b16 v[220:221], v9 offset:2688
    ds_read_b64_tr_b16 v[222:223], v9 offset:5888
    s_add_u32 s36, s29, 8781824
    buffer_load_dwordx4 v[76:79], v6, s[12:15], s36 offen sc1
    s_waitcnt vmcnt(8) lgkmcnt(10)
    v_mfma_f32_16x16x32_bf16 v[24:27], v[144:147], v[48:51], v[24:27]
    ds_read_b64_tr_b16 v[124:125], v8 offset:25600
    ds_read_b64_tr_b16 v[126:127], v8 offset:26880
    v_mfma_f32_16x16x32_bf16 v[28:31], v[148:151], v[48:51], v[28:31]
    ds_read_b64_tr_b16 v[128:129], v8 offset:25632
    ds_read_b64_tr_b16 v[130:131], v8 offset:26912
    v_mfma_f32_16x16x32_bf16 v[32:35], v[152:155], v[48:51], v[32:35]
    ds_read_b64_tr_b16 v[132:133], v8 offset:25664
    ds_read_b64_tr_b16 v[134:135], v8 offset:26944
    v_mfma_f32_16x16x32_bf16 v[36:39], v[156:159], v[48:51], v[36:39]
    ds_read_b64_tr_b16 v[136:137], v8 offset:25696
    ds_read_b64_tr_b16 v[138:139], v8 offset:26976
    v_mfma_f32_16x16x32_bf16 v[40:43], v[160:163], v[48:51], v[40:43]
    ds_read_b64_tr_b16 v[140:141], v8 offset:25728
    ds_read_b64_tr_b16 v[142:143], v8 offset:27008
    s_add_u32 s36, s29, 10092544
    buffer_load_dwordx2 v[80:81], v7, s[12:15], s36 offen offset:0 sc1
    buffer_load_dwordx2 v[82:83], v7, s[12:15], s36 offen offset:128 sc1
    s_waitcnt vmcnt(9) lgkmcnt(10)
    v_mfma_f32_16x16x32_bf16 v[24:27], v[164:167], v[52:55], v[24:27]
    ds_read_b64_tr_b16 v[144:145], v8 offset:32000
    ds_read_b64_tr_b16 v[146:147], v8 offset:33280
    v_mfma_f32_16x16x32_bf16 v[28:31], v[168:171], v[52:55], v[28:31]
    ds_read_b64_tr_b16 v[148:149], v8 offset:32032
    ds_read_b64_tr_b16 v[150:151], v8 offset:33312
    v_mfma_f32_16x16x32_bf16 v[32:35], v[172:175], v[52:55], v[32:35]
    ds_read_b64_tr_b16 v[152:153], v8 offset:32064
    ds_read_b64_tr_b16 v[154:155], v8 offset:33344
    v_mfma_f32_16x16x32_bf16 v[36:39], v[176:179], v[52:55], v[36:39]
    ds_read_b64_tr_b16 v[156:157], v8 offset:32096
    ds_read_b64_tr_b16 v[158:159], v8 offset:33376
    v_mfma_f32_16x16x32_bf16 v[40:43], v[180:183], v[52:55], v[40:43]
    ds_read_b64_tr_b16 v[160:161], v8 offset:32128
    ds_read_b64_tr_b16 v[162:163], v8 offset:33408
    s_add_u32 s36, s29, 8912896
    buffer_load_dwordx4 v[84:87], v6, s[12:15], s36 offen sc1
    s_waitcnt vmcnt(9) lgkmcnt(10)
    v_mfma_f32_16x16x32_bf16 v[24:27], v[184:187], v[56:59], v[24:27]
    ds_read_b64_tr_b16 v[164:165], v8 offset:38400
    ds_read_b64_tr_b16 v[166:167], v8 offset:39680
    v_mfma_f32_16x16x32_bf16 v[28:31], v[188:191], v[56:59], v[28:31]
    ds_read_b64_tr_b16 v[168:169], v8 offset:38432
    ds_read_b64_tr_b16 v[170:171], v8 offset:39712
    v_mfma_f32_16x16x32_bf16 v[32:35], v[192:195], v[56:59], v[32:35]
    ds_read_b64_tr_b16 v[172:173], v8 offset:38464
    ds_read_b64_tr_b16 v[174:175], v8 offset:39744
    v_mfma_f32_16x16x32_bf16 v[36:39], v[196:199], v[56:59], v[36:39]
    ds_read_b64_tr_b16 v[176:177], v8 offset:38496
    ds_read_b64_tr_b16 v[178:179], v8 offset:39776
    v_mfma_f32_16x16x32_bf16 v[40:43], v[200:203], v[56:59], v[40:43]
    ds_read_b64_tr_b16 v[180:181], v8 offset:38528
    ds_read_b64_tr_b16 v[182:183], v8 offset:39808
    s_add_u32 s36, s29, 9043968
    buffer_load_dwordx4 v[88:91], v6, s[12:15], s36 offen sc1
    s_waitcnt vmcnt(8) lgkmcnt(10)
    v_mfma_f32_16x16x32_bf16 v[24:27], v[204:207], v[60:63], v[24:27]
    ds_read_b64_tr_b16 v[184:185], v8 offset:44800
    ds_read_b64_tr_b16 v[186:187], v8 offset:46080
    v_mfma_f32_16x16x32_bf16 v[28:31], v[208:211], v[60:63], v[28:31]
    ds_read_b64_tr_b16 v[188:189], v8 offset:44832
    ds_read_b64_tr_b16 v[190:191], v8 offset:46112
    v_mfma_f32_16x16x32_bf16 v[32:35], v[212:215], v[60:63], v[32:35]
    ds_read_b64_tr_b16 v[192:193], v8 offset:44864
    ds_read_b64_tr_b16 v[194:195], v8 offset:46144
    v_mfma_f32_16x16x32_bf16 v[36:39], v[216:219], v[60:63], v[36:39]
    ds_read_b64_tr_b16 v[196:197], v8 offset:44896
    ds_read_b64_tr_b16 v[198:199], v8 offset:46176
    v_mfma_f32_16x16x32_bf16 v[40:43], v[220:223], v[60:63], v[40:43]
    ds_read_b64_tr_b16 v[200:201], v8 offset:44928
    ds_read_b64_tr_b16 v[202:203], v8 offset:46208
    s_add_u32 s36, s29, 9175040
    buffer_load_dwordx4 v[92:95], v6, s[12:15], s36 offen sc1
    s_waitcnt vmcnt(8) lgkmcnt(10)
    v_mfma_f32_16x16x32_bf16 v[24:27], v[124:127], v[64:67], v[24:27]
    ds_read_b64_tr_b16 v[204:205], v9 offset:28160
    ds_read_b64_tr_b16 v[206:207], v9 offset:31360
    v_mfma_f32_16x16x32_bf16 v[28:31], v[128:131], v[64:67], v[28:31]
    ds_read_b64_tr_b16 v[208:209], v9 offset:28192
    ds_read_b64_tr_b16 v[210:211], v9 offset:31392
    v_mfma_f32_16x16x32_bf16 v[32:35], v[132:135], v[64:67], v[32:35]
    ds_read_b64_tr_b16 v[212:213], v9 offset:28224
    ds_read_b64_tr_b16 v[214:215], v9 offset:31424
    v_mfma_f32_16x16x32_bf16 v[36:39], v[136:139], v[64:67], v[36:39]
    ds_read_b64_tr_b16 v[216:217], v9 offset:28256
    ds_read_b64_tr_b16 v[218:219], v9 offset:31456
    v_mfma_f32_16x16x32_bf16 v[40:43], v[140:143], v[64:67], v[40:43]
    ds_read_b64_tr_b16 v[220:221], v9 offset:28288
    ds_read_b64_tr_b16 v[222:223], v9 offset:31488
    s_add_u32 s36, s29, 9306112
    buffer_load_dwordx4 v[96:99], v6, s[12:15], s36 offen sc1
    s_waitcnt vmcnt(8) lgkmcnt(10)
    v_mfma_f32_16x16x32_bf16 v[24:27], v[144:147], v[68:71], v[24:27]
    v_add_u32 v8, 81920, v8
    v_add_u32 v9, 81920, v9
    ds_read_b64_tr_b16 v[124:125], v8 offset:0
    v_mfma_f32_16x16x32_bf16 v[28:31], v[148:151], v[68:71], v[28:31]
    ds_read_b64_tr_b16 v[126:127], v8 offset:1280
    ds_read_b64_tr_b16 v[128:129], v8 offset:32
    v_mfma_f32_16x16x32_bf16 v[32:35], v[152:155], v[68:71], v[32:35]
    ds_read_b64_tr_b16 v[130:131], v8 offset:1312
    ds_read_b64_tr_b16 v[132:133], v8 offset:64
    ds_read_b64_tr_b16 v[134:135], v8 offset:1344
    v_mfma_f32_16x16x32_bf16 v[36:39], v[156:159], v[68:71], v[36:39]
    ds_read_b64_tr_b16 v[136:137], v8 offset:96
    ds_read_b64_tr_b16 v[138:139], v8 offset:1376
    v_mfma_f32_16x16x32_bf16 v[40:43], v[160:163], v[68:71], v[40:43]
    ds_read_b64_tr_b16 v[140:141], v8 offset:128
    ds_read_b64_tr_b16 v[142:143], v8 offset:1408
    s_add_u32 s36, s29, 10223616
    buffer_load_dwordx2 v[100:101], v7, s[12:15], s36 offen offset:0 sc1
    buffer_load_dwordx2 v[102:103], v7, s[12:15], s36 offen offset:128 sc1
    s_waitcnt vmcnt(9) lgkmcnt(10)
    v_mfma_f32_16x16x32_bf16 v[24:27], v[164:167], v[72:75], v[24:27]
    ds_read_b64_tr_b16 v[144:145], v8 offset:6400
    ds_read_b64_tr_b16 v[146:147], v8 offset:7680
    v_mfma_f32_16x16x32_bf16 v[28:31], v[168:171], v[72:75], v[28:31]
    ds_read_b64_tr_b16 v[148:149], v8 offset:6432
    ds_read_b64_tr_b16 v[150:151], v8 offset:7712
    v_mfma_f32_16x16x32_bf16 v[32:35], v[172:175], v[72:75], v[32:35]
    ds_read_b64_tr_b16 v[152:153], v8 offset:6464
    ds_read_b64_tr_b16 v[154:155], v8 offset:7744
    v_mfma_f32_16x16x32_bf16 v[36:39], v[176:179], v[72:75], v[36:39]
    ds_read_b64_tr_b16 v[156:157], v8 offset:6496
    ds_read_b64_tr_b16 v[158:159], v8 offset:7776
    v_mfma_f32_16x16x32_bf16 v[40:43], v[180:183], v[72:75], v[40:43]
    ds_read_b64_tr_b16 v[160:161], v8 offset:6528
    ds_read_b64_tr_b16 v[162:163], v8 offset:7808
    s_add_u32 s36, s29, 9437184
    buffer_load_dwordx4 v[104:107], v6, s[12:15], s36 offen sc1
    s_waitcnt vmcnt(9) lgkmcnt(10)
    v_mfma_f32_16x16x32_bf16 v[24:27], v[184:187], v[76:79], v[24:27]
    ds_read_b64_tr_b16 v[164:165], v8 offset:12800
    ds_read_b64_tr_b16 v[166:167], v8 offset:14080
    v_mfma_f32_16x16x32_bf16 v[28:31], v[188:191], v[76:79], v[28:31]
    ds_read_b64_tr_b16 v[168:169], v8 offset:12832
    ds_read_b64_tr_b16 v[170:171], v8 offset:14112
    v_mfma_f32_16x16x32_bf16 v[32:35], v[192:195], v[76:79], v[32:35]
    ds_read_b64_tr_b16 v[172:173], v8 offset:12864
    ds_read_b64_tr_b16 v[174:175], v8 offset:14144
    v_mfma_f32_16x16x32_bf16 v[36:39], v[196:199], v[76:79], v[36:39]
    ds_read_b64_tr_b16 v[176:177], v8 offset:12896
    ds_read_b64_tr_b16 v[178:179], v8 offset:14176
    v_mfma_f32_16x16x32_bf16 v[40:43], v[200:203], v[76:79], v[40:43]
    ds_read_b64_tr_b16 v[180:181], v8 offset:12928
    ds_read_b64_tr_b16 v[182:183], v8 offset:14208
    s_add_u32 s36, s29, 9568256
    buffer_load_dwordx4 v[108:111], v6, s[12:15], s36 offen sc1
    s_waitcnt vmcnt(8) lgkmcnt(10)
    v_mfma_f32_16x16x32_bf16 v[24:27], v[204:207], v[80:83], v[24:27]
    ds_read_b64_tr_b16 v[184:185], v8 offset:19200
    ds_read_b64_tr_b16 v[186:187], v8 offset:20480
    v_mfma_f32_16x16x32_bf16 v[28:31], v[208:211], v[80:83], v[28:31]
    ds_read_b64_tr_b16 v[188:189], v8 offset:19232
    ds_read_b64_tr_b16 v[190:191], v8 offset:20512
    v_mfma_f32_16x16x32_bf16 v[32:35], v[212:215], v[80:83], v[32:35]
    ds_read_b64_tr_b16 v[192:193], v8 offset:19264
    ds_read_b64_tr_b16 v[194:195], v8 offset:20544
    v_mfma_f32_16x16x32_bf16 v[36:39], v[216:219], v[80:83], v[36:39]
    ds_read_b64_tr_b16 v[196:197], v8 offset:19296
    ds_read_b64_tr_b16 v[198:199], v8 offset:20576
    v_mfma_f32_16x16x32_bf16 v[40:43], v[220:223], v[80:83], v[40:43]
    ds_read_b64_tr_b16 v[200:201], v8 offset:19328
    ds_read_b64_tr_b16 v[202:203], v8 offset:20608
    s_add_u32 s36, s29, 9699328
    buffer_load_dwordx4 v[112:115], v6, s[12:15], s36 offen sc1
    s_waitcnt vmcnt(8) lgkmcnt(10)
    v_mfma_f32_16x16x32_bf16 v[24:27], v[124:127], v[84:87], v[24:27]
    ds_read_b64_tr_b16 v[204:205], v9 offset:2560
    ds_read_b64_tr_b16 v[206:207], v9 offset:5760
    v_mfma_f32_16x16x32_bf16 v[28:31], v[128:131], v[84:87], v[28:31]
    ds_read_b64_tr_b16 v[208:209], v9 offset:2592
    ds_read_b64_tr_b16 v[210:211], v9 offset:5792
    v_mfma_f32_16x16x32_bf16 v[32:35], v[132:135], v[84:87], v[32:35]
    ds_read_b64_tr_b16 v[212:213], v9 offset:2624
    ds_read_b64_tr_b16 v[214:215], v9 offset:5824
    v_mfma_f32_16x16x32_bf16 v[36:39], v[136:139], v[84:87], v[36:39]
    ds_read_b64_tr_b16 v[216:217], v9 offset:2656
    ds_read_b64_tr_b16 v[218:219], v9 offset:5856
    v_mfma_f32_16x16x32_bf16 v[40:43], v[140:143], v[84:87], v[40:43]
    ds_read_b64_tr_b16 v[220:221], v9 offset:2688
    ds_read_b64_tr_b16 v[222:223], v9 offset:5888
    s_add_u32 s36, s29, 9830400
    buffer_load_dwordx4 v[116:119], v6, s[12:15], s36 offen sc1
    s_waitcnt vmcnt(8) lgkmcnt(10)
    v_mfma_f32_16x16x32_bf16 v[24:27], v[144:147], v[88:91], v[24:27]
    ds_read_b64_tr_b16 v[124:125], v8 offset:25600
    ds_read_b64_tr_b16 v[126:127], v8 offset:26880
    v_mfma_f32_16x16x32_bf16 v[28:31], v[148:151], v[88:91], v[28:31]
    ds_read_b64_tr_b16 v[128:129], v8 offset:25632
    ds_read_b64_tr_b16 v[130:131], v8 offset:26912
    v_mfma_f32_16x16x32_bf16 v[32:35], v[152:155], v[88:91], v[32:35]
    ds_read_b64_tr_b16 v[132:133], v8 offset:25664
    ds_read_b64_tr_b16 v[134:135], v8 offset:26944
    v_mfma_f32_16x16x32_bf16 v[36:39], v[156:159], v[88:91], v[36:39]
    ds_read_b64_tr_b16 v[136:137], v8 offset:25696
    ds_read_b64_tr_b16 v[138:139], v8 offset:26976
    v_mfma_f32_16x16x32_bf16 v[40:43], v[160:163], v[88:91], v[40:43]
    ds_read_b64_tr_b16 v[140:141], v8 offset:25728
    ds_read_b64_tr_b16 v[142:143], v8 offset:27008
    s_add_u32 s36, s29, 10354688
    buffer_load_dwordx2 v[120:121], v7, s[12:15], s36 offen offset:0 sc1
    buffer_load_dwordx2 v[122:123], v7, s[12:15], s36 offen offset:128 sc1
    s_waitcnt vmcnt(9) lgkmcnt(10)
    v_mfma_f32_16x16x32_bf16 v[24:27], v[164:167], v[92:95], v[24:27]
    ds_read_b64_tr_b16 v[144:145], v8 offset:32000
    ds_read_b64_tr_b16 v[146:147], v8 offset:33280
    v_mfma_f32_16x16x32_bf16 v[28:31], v[168:171], v[92:95], v[28:31]
    ds_read_b64_tr_b16 v[148:149], v8 offset:32032
    ds_read_b64_tr_b16 v[150:151], v8 offset:33312
    v_mfma_f32_16x16x32_bf16 v[32:35], v[172:175], v[92:95], v[32:35]
    ds_read_b64_tr_b16 v[152:153], v8 offset:32064
    ds_read_b64_tr_b16 v[154:155], v8 offset:33344
    v_mfma_f32_16x16x32_bf16 v[36:39], v[176:179], v[92:95], v[36:39]
    ds_read_b64_tr_b16 v[156:157], v8 offset:32096
    ds_read_b64_tr_b16 v[158:159], v8 offset:33376
    v_mfma_f32_16x16x32_bf16 v[40:43], v[180:183], v[92:95], v[40:43]
    ds_read_b64_tr_b16 v[160:161], v8 offset:32128
    ds_read_b64_tr_b16 v[162:163], v8 offset:33408
    s_waitcnt vmcnt(8) lgkmcnt(10)
    v_mfma_f32_16x16x32_bf16 v[24:27], v[184:187], v[96:99], v[24:27]
    ds_read_b64_tr_b16 v[164:165], v8 offset:38400
    ds_read_b64_tr_b16 v[166:167], v8 offset:39680
    v_mfma_f32_16x16x32_bf16 v[28:31], v[188:191], v[96:99], v[28:31]
    ds_read_b64_tr_b16 v[168:169], v8 offset:38432
    ds_read_b64_tr_b16 v[170:171], v8 offset:39712
    v_mfma_f32_16x16x32_bf16 v[32:35], v[192:195], v[96:99], v[32:35]
    ds_read_b64_tr_b16 v[172:173], v8 offset:38464
    ds_read_b64_tr_b16 v[174:175], v8 offset:39744
    v_mfma_f32_16x16x32_bf16 v[36:39], v[196:199], v[96:99], v[36:39]
    ds_read_b64_tr_b16 v[176:177], v8 offset:38496
    ds_read_b64_tr_b16 v[178:179], v8 offset:39776
    v_mfma_f32_16x16x32_bf16 v[40:43], v[200:203], v[96:99], v[40:43]
    ds_read_b64_tr_b16 v[180:181], v8 offset:38528
    ds_read_b64_tr_b16 v[182:183], v8 offset:39808
    s_waitcnt vmcnt(6) lgkmcnt(10)
    v_mfma_f32_16x16x32_bf16 v[24:27], v[204:207], v[100:103], v[24:27]
    ds_read_b64_tr_b16 v[184:185], v8 offset:44800
    ds_read_b64_tr_b16 v[186:187], v8 offset:46080
    v_mfma_f32_16x16x32_bf16 v[28:31], v[208:211], v[100:103], v[28:31]
    ds_read_b64_tr_b16 v[188:189], v8 offset:44832
    ds_read_b64_tr_b16 v[190:191], v8 offset:46112
    v_mfma_f32_16x16x32_bf16 v[32:35], v[212:215], v[100:103], v[32:35]
    ds_read_b64_tr_b16 v[192:193], v8 offset:44864
    ds_read_b64_tr_b16 v[194:195], v8 offset:46144
    v_mfma_f32_16x16x32_bf16 v[36:39], v[216:219], v[100:103], v[36:39]
    ds_read_b64_tr_b16 v[196:197], v8 offset:44896
    ds_read_b64_tr_b16 v[198:199], v8 offset:46176
    v_mfma_f32_16x16x32_bf16 v[40:43], v[220:223], v[100:103], v[40:43]
    ds_read_b64_tr_b16 v[200:201], v8 offset:44928
    ds_read_b64_tr_b16 v[202:203], v8 offset:46208
    s_waitcnt vmcnt(5) lgkmcnt(10)
    v_mfma_f32_16x16x32_bf16 v[24:27], v[124:127], v[104:107], v[24:27]
    ds_read_b64_tr_b16 v[204:205], v9 offset:28160
    ds_read_b64_tr_b16 v[206:207], v9 offset:31360
    v_mfma_f32_16x16x32_bf16 v[28:31], v[128:131], v[104:107], v[28:31]
    ds_read_b64_tr_b16 v[208:209], v9 offset:28192
    ds_read_b64_tr_b16 v[210:211], v9 offset:31392
    v_mfma_f32_16x16x32_bf16 v[32:35], v[132:135], v[104:107], v[32:35]
    ds_read_b64_tr_b16 v[212:213], v9 offset:28224
    ds_read_b64_tr_b16 v[214:215], v9 offset:31424
    v_mfma_f32_16x16x32_bf16 v[36:39], v[136:139], v[104:107], v[36:39]
    ds_read_b64_tr_b16 v[216:217], v9 offset:28256
    ds_read_b64_tr_b16 v[218:219], v9 offset:31456
    v_mfma_f32_16x16x32_bf16 v[40:43], v[140:143], v[104:107], v[40:43]
    ds_read_b64_tr_b16 v[220:221], v9 offset:28288
    ds_read_b64_tr_b16 v[222:223], v9 offset:31488
    s_waitcnt vmcnt(4) lgkmcnt(10)
    v_mfma_f32_16x16x32_bf16 v[24:27], v[144:147], v[108:111], v[24:27]
    v_mfma_f32_16x16x32_bf16 v[28:31], v[148:151], v[108:111], v[28:31]
    v_mfma_f32_16x16x32_bf16 v[32:35], v[152:155], v[108:111], v[32:35]
    v_mfma_f32_16x16x32_bf16 v[36:39], v[156:159], v[108:111], v[36:39]
    v_mfma_f32_16x16x32_bf16 v[40:43], v[160:163], v[108:111], v[40:43]
    s_waitcnt vmcnt(3) lgkmcnt(10)
    v_mfma_f32_16x16x32_bf16 v[24:27], v[164:167], v[112:115], v[24:27]
    v_mfma_f32_16x16x32_bf16 v[28:31], v[168:171], v[112:115], v[28:31]
    v_mfma_f32_16x16x32_bf16 v[32:35], v[172:175], v[112:115], v[32:35]
    v_mfma_f32_16x16x32_bf16 v[36:39], v[176:179], v[112:115], v[36:39]
    v_mfma_f32_16x16x32_bf16 v[40:43], v[180:183], v[112:115], v[40:43]
    s_waitcnt vmcnt(2) lgkmcnt(10)
    v_mfma_f32_16x16x32_bf16 v[24:27], v[184:187], v[116:119], v[24:27]
    v_mfma_f32_16x16x32_bf16 v[28:31], v[188:191], v[116:119], v[28:31]
    v_mfma_f32_16x16x32_bf16 v[32:35], v[192:195], v[116:119], v[32:35]
    v_mfma_f32_16x16x32_bf16 v[36:39], v[196:199], v[116:119], v[36:39]
    v_mfma_f32_16x16x32_bf16 v[40:43], v[200:203], v[116:119], v[40:43]
    s_waitcnt vmcnt(0) lgkmcnt(0)
    v_mfma_f32_16x16x32_bf16 v[24:27], v[204:207], v[120:123], v[24:27]
    v_mfma_f32_16x16x32_bf16 v[28:31], v[208:211], v[120:123], v[28:31]
    v_mfma_f32_16x16x32_bf16 v[32:35], v[212:215], v[120:123], v[32:35]
    v_mfma_f32_16x16x32_bf16 v[36:39], v[216:219], v[120:123], v[36:39]
    v_mfma_f32_16x16x32_bf16 v[40:43], v[220:223], v[120:123], v[40:43]
    s_barrier
    v_mul_u32_u24 v2, 176, v4
    v_lshl_add_u32 v2, v5, 3, v2
    v_add_u32 v2, s33, v2
    v_mov_b32 v3, 0x3f803f80
    v_mov_b32 v56, 0
    v_mov_b32 v57, 0
    v_lshlrev_b32 v11, 3, v4
    v_cvt_pk_bf16_f32 v44, v24, v25
    v_cvt_pk_bf16_f32 v45, v26, v27
    v_cvt_pk_bf16_f32 v46, v28, v29
    v_cvt_pk_bf16_f32 v47, v30, v31
    v_cvt_pk_bf16_f32 v48, v32, v33
    v_cvt_pk_bf16_f32 v49, v34, v35
    v_cvt_pk_bf16_f32 v50, v36, v37
    v_cvt_pk_bf16_f32 v51, v38, v39
    v_cvt_pk_bf16_f32 v52, v40, v41
    v_cvt_pk_bf16_f32 v53, v42, v43
    v_dot2c_f32_bf16 v56, v44, v3
    v_dot2c_f32_bf16 v57, v44, v44
    v_dot2c_f32_bf16 v56, v45, v3
    v_dot2c_f32_bf16 v57, v45, v45
    v_dot2c_f32_bf16 v56, v46, v3
    v_dot2c_f32_bf16 v57, v46, v46
    v_dot2c_f32_bf16 v56, v47, v3
    v_dot2c_f32_bf16 v57, v47, v47
    v_dot2c_f32_bf16 v56, v48, v3
    v_dot2c_f32_bf16 v57, v48, v48
    v_dot2c_f32_bf16 v56, v49, v3
    v_dot2c_f32_bf16 v57, v49, v49
    v_dot2c_f32_bf16 v56, v50, v3
    v_dot2c_f32_bf16 v57, v50, v50
    v_dot2c_f32_bf16 v56, v51, v3
    v_dot2c_f32_bf16 v57, v51, v51
    v_dot2c_f32_bf16 v56, v52, v3
    v_dot2c_f32_bf16 v57, v52, v52
    v_dot2c_f32_bf16 v56, v53, v3
    v_dot2c_f32_bf16 v57, v53, v53
    s_nop 2
    v_mov_b32 v58, v56
    v_mov_b32 v59, v57
    s_nop 1
    v_permlane32_swap_b32 v56, v58
    v_permlane32_swap_b32 v57, v59
    s_nop 1
    v_add_f32 v56, v56, v58
    v_add_f32 v57, v57, v59
    v_mov_b32 v58, v56
    v_mov_b32 v59, v57
    s_nop 1
    v_permlane16_swap_b32 v56, v58
    v_permlane16_swap_b32 v57, v59
    s_nop 1
    v_add_f32 v56, v56, v58
    v_add_f32 v57, v57, v59
    v_and_b32 v57, 0x7fffffff, v57
    s_mov_b64 exec, 0xffff
    buffer_store_dwordx2 v[56:57], v11, s[12:15], s32 offen sc1
    s_mov_b64 exec, -1
    ds_write_b64 v2, v[44:45] offset:0
    ds_write_b64 v2, v[46:47] offset:32
    ds_write_b64 v2, v[48:49] offset:64
    ds_write_b64 v2, v[50:51] offset:96
    ds_write_b64 v2, v[52:53] offset:128
    v_mov_b32 v58, 159820
    v_mov_b32 v59, 1
    s_mov_b64 exec, 1
    ds_add_u32 v58, v59
    s_mov_b64 exec, -1
    s_waitcnt lgkmcnt(0)
    ds_read_b64_tr_b16 v[60:61], v12 offset:0
    ds_read_b64_tr_b16 v[62:63], v12 offset:704
    ds_read_b64_tr_b16 v[64:65], v12 offset:64
    ds_read_b64_tr_b16 v[66:67], v12 offset:768
    ds_read_b64_tr_b16 v[68:69], v12 offset:128
    ds_read_b64_tr_b16 v[70:71], v12 offset:832
    s_waitcnt lgkmcnt(0)
    v_lshlrev_b32 v72, 16, v60
    v_and_b32 v73, s45, v60
    v_lshlrev_b32 v74, 16, v61
    v_and_b32 v75, s45, v61
    v_lshlrev_b32 v76, 16, v62
    v_and_b32 v77, s45, v62
    v_lshlrev_b32 v78, 16, v63
    v_and_b32 v79, s45, v63
    v_lshlrev_b32 v80, 16, v64
    v_and_b32 v81, s45, v64
    v_lshlrev_b32 v82, 16, v65
    v_and_b32 v83, s45, v65
    v_lshlrev_b32 v84, 16, v66
    v_and_b32 v85, s45, v66
    v_lshlrev_b32 v86, 16, v67
    v_and_b32 v87, s45, v67
    v_lshlrev_b32 v88, 16, v68
    v_and_b32 v89, s45, v68
    v_lshlrev_b32 v90, 16, v69
    v_and_b32 v91, s45, v69
    v_lshlrev_b32 v92, 16, v70
    v_and_b32 v93, s45, v70
    v_lshlrev_b32 v94, 16, v71
    v_and_b32 v95, s45, v71
    s_barrier
    ds_read_b128 v[96:99], v13 offset:0
    ds_read_b128 v[100:103], v13 offset:16
    ds_read_b128 v[104:107], v13 offset:32
    ds_read_b128 v[108:111], v13 offset:48
    s_waitcnt lgkmcnt(0)
    v_fma_f32 v72, v72, v97, v96
    v_fma_f32 v73, v73, v99, v98
    v_fma_f32 v74, v74, v101, v100
    v_fma_f32 v75, v75, v103, v102
    v_fma_f32 v76, v76, v105, v104
    v_fma_f32 v77, v77, v107, v106
    v_fma_f32 v78, v78, v109, v108
    v_fma_f32 v79, v79, v111, v110
    v_cvt_pk_bf16_f32 v112, v72, v73
    v_cvt_pk_bf16_f32 v113, v74, v75
    v_cvt_pk_bf16_f32 v114, v76, v77
    v_cvt_pk_bf16_f32 v115, v78, v79
    buffer_store_dwordx4 v[112:115], v6, s[12:15], s34 offen offset:0 sc1
    v_fma_f32 v80, v80, v97, v96
    v_fma_f32 v81, v81, v99, v98
    v_fma_f32 v82, v82, v101, v100
    v_fma_f32 v83, v83, v103, v102
    v_fma_f32 v84, v84, v105, v104
    v_fma_f32 v85, v85, v107, v106
    v_fma_f32 v86, v86, v109, v108
    v_fma_f32 v87, v87, v111, v110
    v_cvt_pk_bf16_f32 v116, v80, v81
    v_cvt_pk_bf16_f32 v117, v82, v83
    v_cvt_pk_bf16_f32 v118, v84, v85
    v_cvt_pk_bf16_f32 v119, v86, v87
    buffer_store_dwordx4 v[116:119], v6, s[12:15], s34 offen offset:1024 sc1
    v_fma_f32 v88, v88, v97, v96
    v_fma_f32 v89, v89, v99, v98
    v_fma_f32 v90, v90, v101, v100
    v_fma_f32 v91, v91, v103, v102
    v_fma_f32 v92, v92, v105, v104
    v_fma_f32 v93, v93, v107, v106
    v_fma_f32 v94, v94, v109, v108
    v_fma_f32 v95, v95, v111, v110
    v_cvt_pk_bf16_f32 v120, v88, v89
    v_cvt_pk_bf16_f32 v121, v90, v91
    v_cvt_pk_bf16_f32 v122, v92, v93
    v_cvt_pk_bf16_f32 v123, v94, v95
    buffer_store_dwordx4 v[120:123], v14, s[12:15], s34 offen offset:2048 sc1
    s_and_b32 s46, s24, 1
    s_lshr_b32 s47, s24, 1
    v_lshrrev_b32 v10, 5, v1
    v_and_b32 v2, 3, v1
    v_lshlrev_b32 v2, 3, v2
    v_bfe_u32 v3, v1, 4, 1
    v_lshl_add_u32 v2, v3, 5, v2
    v_lshlrev_b32 v11, 9, v3
    v_bfe_u32 v3, v1, 2, 2
    v_lshl_add_u32 v2, v3, 6, v2
    v_lshl_add_u32 v2, v10, 10, v2
    s_mul_i32 s36, s39, 4096
    s_mul_i32 s37, s38, 32
    s_add_u32 s36, s36, s37
    s_add_u32 s36, s36, 20742144
    s_add_u32 s36, s36, s50
    v_mov_b32 v13, 1
    v_mov_b32 v12, 159808
    s_mov_b64 exec, 1
    s_waitcnt vmcnt(0)
    ds_add_rtn_u32 v12, v12, v13
    s_waitcnt lgkmcnt(0)
    v_readfirstlane_b32 s37, v12
    s_mov_b64 exec, -1
    s_nop 2
    s_cmp_lg_u32 s37, 3
    s_cbranch_scc1 L_sg_59
    v_mul_u32_u24 v12, 1024, v1
    s_mov_b64 exec, 0xf
    buffer_store_dword v13, v12, s[12:15], s36 offen sc1
    s_mov_b64 exec, -1
L_sg_59:
    s_lshl_b32 s36, s47, 13
    s_lshl_b32 s37, s47, 8
    s_add_u32 s36, s36, s37
    v_add_u32 v6, s36, v2
    v_add_u32 v7, 65536, v6
    v_add_u32 v8, 131072, v6
    v_xor_b32 v208, 256, v6
    v_xor_b32 v209, 256, v7
    v_xor_b32 v210, 256, v8
    v_lshl_add_u32 v9, v10, 8, v11
    v_lshl_add_u32 v9, v4, 4, v9
    s_cmp_eq_u32 s42, 0
    s_cbranch_scc1 tl_c_p3
    s_lshl_b32 s28, s40, 11
    s_lshl_b32 s36, s46, 10
    s_add_u32 s28, s28, s36
    s_mul_i32 s36, s47, 81920
    s_add_u32 s28, s28, s36
    s_add_u32 s28, s28, 17694720
    v_lshlrev_b32 v16, 16, v224
    v_and_b32 v17, s45, v224
    v_lshlrev_b32 v18, 16, v225
    v_and_b32 v19, s45, v225
    v_lshlrev_b32 v20, 16, v226
    v_and_b32 v21, s45, v226
    v_lshlrev_b32 v22, 16, v227
    v_and_b32 v23, s45, v227
    v_lshlrev_b32 v24, 16, v228
    v_and_b32 v25, s45, v228
    v_lshlrev_b32 v26, 16, v229
    v_and_b32 v27, s45, v229
    v_lshlrev_b32 v28, 16, v230
    v_and_b32 v29, s45, v230
    v_lshlrev_b32 v30, 16, v231
    v_and_b32 v31, s45, v231
    v_mov_b32 v32, 0
    v_mov_b32 v33, 0
    v_mov_b32 v34, 0
    v_mov_b32 v35, 0
    v_mov_b32 v36, 0
    v_mov_b32 v37, 0
    v_mov_b32 v38, 0
    v_mov_b32 v39, 0
    v_mov_b32 v40, 0
    v_mov_b32 v41, 0
    v_mov_b32 v42, 0
    v_mov_b32 v43, 0
    v_mov_b32 v44, 0
    v_mov_b32 v45, 0
    v_mov_b32 v46, 0
    v_mov_b32 v47, 0
    s_lshl_b32 s36, s24, 12
    s_add_u32 s36, s36, 131072
    s_xor_b32 s37, s36, 8192
    v_lshl_add_u32 v211, v1, 4, s36
    v_lshl_add_u32 v212, v1, 4, s37
    v_mov_b32 v214, 0xc0135761
    v_mov_b32 v216, 0xbdd2d3e8
    v_mov_b32 v218, 1.0
    v_mov_b32 v215, 0xc0135761
    v_mov_b32 v217, 0xbdd2d3e8
    v_mov_b32 v219, 1.0
    s_mul_i32 s33, s40, 4096
    s_mul_i32 s37, s41, 32
    s_add_u32 s33, s33, s37
    s_add_u32 s33, s33, 20774912
    s_add_u32 s33, s33, s50
    s_barrier
    s_add_u32 s36, s28, 0
    buffer_load_dwordx4 v[80:83], v9, s[12:15], s36 offen sc1
    ds_read_b64_tr_b16 v[48:49], v6 offset:0
    ds_read_b64_tr_b16 v[50:51], v6 offset:512
    ds_read_b64_tr_b16 v[52:53], v208 offset:0
    ds_read_b64_tr_b16 v[54:55], v208 offset:512
    s_add_u32 s36, s28, 20480
    buffer_load_dwordx4 v[84:87], v9, s[12:15], s36 offen sc1
    ds_read_b64_tr_b16 v[56:57], v6 offset:2048
    ds_read_b64_tr_b16 v[58:59], v6 offset:2560
    ds_read_b64_tr_b16 v[60:61], v208 offset:2048
    ds_read_b64_tr_b16 v[62:63], v208 offset:2560
    s_add_u32 s36, s28, 40960
    buffer_load_dwordx4 v[88:91], v9, s[12:15], s36 offen sc1
    ds_read_b64_tr_b16 v[64:65], v6 offset:4096
    ds_read_b64_tr_b16 v[66:67], v6 offset:4608
    ds_read_b64_tr_b16 v[68:69], v208 offset:4096
    ds_read_b64_tr_b16 v[70:71], v208 offset:4608
    s_add_u32 s36, s28, 61440
    buffer_load_dwordx4 v[92:95], v9, s[12:15], s36 offen sc1
    s_add_u32 s36, s28, 163840
    buffer_load_dwordx4 v[96:99], v9, s[12:15], s36 offen sc1
    s_add_u32 s36, s28, 184320
    buffer_load_dwordx4 v[100:103], v9, s[12:15], s36 offen sc1
    s_add_u32 s36, s28, 204800
    buffer_load_dwordx4 v[104:107], v9, s[12:15], s36 offen sc1
    s_add_u32 s36, s28, 225280
    buffer_load_dwordx4 v[108:111], v9, s[12:15], s36 offen sc1
    s_add_u32 s36, s28, 327680
    buffer_load_dwordx4 v[112:115], v9, s[12:15], s36 offen sc1
    s_add_u32 s36, s28, 348160
    buffer_load_dwordx4 v[116:119], v9, s[12:15], s36 offen sc1
    s_add_u32 s36, s28, 368640
    buffer_load_dwordx4 v[120:123], v9, s[12:15], s36 offen sc1
    s_add_u32 s36, s28, 389120
    buffer_load_dwordx4 v[124:127], v9, s[12:15], s36 offen sc1
    s_waitcnt vmcnt(11) lgkmcnt(8)
    s_add_u32 s36, s28, 491520
    v_mfma_f32_32x32x16_bf16 v[32:47], v[52:55], v[80:83], v[32:47]
    buffer_load_dwordx4 v[128:131], v9, s[12:15], s36 offen sc1
    v_mfma_f32_32x32x16_bf16 v[16:31], v[48:51], v[80:83], v[16:31]
    ds_read_b64_tr_b16 v[72:73], v6 offset:6144
    ds_read_b64_tr_b16 v[74:75], v6 offset:6656
    ds_read_b64_tr_b16 v[76:77], v208 offset:6144
    ds_read_b64_tr_b16 v[78:79], v208 offset:6656
    s_waitcnt vmcnt(11) lgkmcnt(8)
    s_add_u32 s36, s28, 512000
    v_mfma_f32_32x32x16_bf16 v[32:47], v[60:63], v[84:87], v[32:47]
    buffer_load_dwordx4 v[132:135], v9, s[12:15], s36 offen sc1
    v_mfma_f32_32x32x16_bf16 v[16:31], v[56:59], v[84:87], v[16:31]
    ds_read_b64_tr_b16 v[48:49], v6 offset:16384
    ds_read_b64_tr_b16 v[50:51], v6 offset:16896
    ds_read_b64_tr_b16 v[52:53], v208 offset:16384
    ds_read_b64_tr_b16 v[54:55], v208 offset:16896
    s_waitcnt vmcnt(11) lgkmcnt(8)
    s_add_u32 s36, s28, 532480
    v_mfma_f32_32x32x16_bf16 v[32:47], v[68:71], v[88:91], v[32:47]
    buffer_load_dwordx4 v[136:139], v9, s[12:15], s36 offen sc1
    v_mfma_f32_32x32x16_bf16 v[16:31], v[64:67], v[88:91], v[16:31]
    ds_read_b64_tr_b16 v[56:57], v6 offset:18432
    ds_read_b64_tr_b16 v[58:59], v6 offset:18944
    ds_read_b64_tr_b16 v[60:61], v208 offset:18432
    ds_read_b64_tr_b16 v[62:63], v208 offset:18944
    s_waitcnt vmcnt(11) lgkmcnt(8)
    s_add_u32 s36, s28, 552960
    v_mfma_f32_32x32x16_bf16 v[32:47], v[76:79], v[92:95], v[32:47]
    buffer_load_dwordx4 v[140:143], v9, s[12:15], s36 offen sc1
    v_mfma_f32_32x32x16_bf16 v[16:31], v[72:75], v[92:95], v[16:31]
    ds_read_b64_tr_b16 v[64:65], v6 offset:20480
    ds_read_b64_tr_b16 v[66:67], v6 offset:20992
    ds_read_b64_tr_b16 v[68:69], v208 offset:20480
    ds_read_b64_tr_b16 v[70:71], v208 offset:20992
    s_waitcnt vmcnt(11) lgkmcnt(8)
    s_add_u32 s36, s28, 655360
    v_mfma_f32_32x32x16_bf16 v[32:47], v[52:55], v[96:99], v[32:47]
    buffer_load_dwordx4 v[144:147], v9, s[12:15], s36 offen sc1
    v_mfma_f32_32x32x16_bf16 v[16:31], v[48:51], v[96:99], v[16:31]
    ds_read_b64_tr_b16 v[72:73], v6 offset:22528
    ds_read_b64_tr_b16 v[74:75], v6 offset:23040
    ds_read_b64_tr_b16 v[76:77], v208 offset:22528
    ds_read_b64_tr_b16 v[78:79], v208 offset:23040
    s_waitcnt vmcnt(11) lgkmcnt(8)
    s_add_u32 s36, s28, 675840
    v_mfma_f32_32x32x16_bf16 v[32:47], v[60:63], v[100:103], v[32:47]
    buffer_load_dwordx4 v[148:151], v9, s[12:15], s36 offen sc1
    v_mfma_f32_32x32x16_bf16 v[16:31], v[56:59], v[100:103], v[16:31]
    ds_read_b64_tr_b16 v[48:49], v6 offset:32768
    ds_read_b64_tr_b16 v[50:51], v6 offset:33280
    ds_read_b64_tr_b16 v[52:53], v208 offset:32768
    ds_read_b64_tr_b16 v[54:55], v208 offset:33280
    s_waitcnt vmcnt(11) lgkmcnt(8)
    s_add_u32 s36, s28, 696320
    v_mfma_f32_32x32x16_bf16 v[32:47], v[68:71], v[104:107], v[32:47]
    buffer_load_dwordx4 v[152:155], v9, s[12:15], s36 offen sc1
    v_mfma_f32_32x32x16_bf16 v[16:31], v[64:67], v[104:107], v[16:31]
    ds_read_b64_tr_b16 v[56:57], v6 offset:34816
    ds_read_b64_tr_b16 v[58:59], v6 offset:35328
    ds_read_b64_tr_b16 v[60:61], v208 offset:34816
    ds_read_b64_tr_b16 v[62:63], v208 offset:35328
    s_waitcnt vmcnt(11) lgkmcnt(8)
    s_add_u32 s36, s28, 716800
    v_mfma_f32_32x32x16_bf16 v[32:47], v[76:79], v[108:111], v[32:47]
    buffer_load_dwordx4 v[156:159], v9, s[12:15], s36 offen sc1
    v_mfma_f32_32x32x16_bf16 v[16:31], v[72:75], v[108:111], v[16:31]
    ds_read_b64_tr_b16 v[64:65], v6 offset:36864
    ds_read_b64_tr_b16 v[66:67], v6 offset:37376
    ds_read_b64_tr_b16 v[68:69], v208 offset:36864
    ds_read_b64_tr_b16 v[70:71], v208 offset:37376
    s_waitcnt vmcnt(11) lgkmcnt(8)
    s_add_u32 s36, s28, 819200
    v_mfma_f32_32x32x16_bf16 v[32:47], v[52:55], v[112:115], v[32:47]
    buffer_load_dwordx4 v[160:163], v9, s[12:15], s36 offen sc1
    v_mfma_f32_32x32x16_bf16 v[16:31], v[48:51], v[112:115], v[16:31]
    ds_read_b64_tr_b16 v[72:73], v6 offset:38912
    ds_read_b64_tr_b16 v[74:75], v6 offset:39424
    ds_read_b64_tr_b16 v[76:77], v208 offset:38912
    ds_read_b64_tr_b16 v[78:79], v208 offset:39424
    s_waitcnt vmcnt(11) lgkmcnt(8)
    s_add_u32 s36, s28, 839680
    v_mfma_f32_32x32x16_bf16 v[32:47], v[60:63], v[116:119], v[32:47]
    buffer_load_dwordx4 v[164:167], v9, s[12:15], s36 offen sc1
    v_mfma_f32_32x32x16_bf16 v[16:31], v[56:59], v[116:119], v[16:31]
    ds_read_b64_tr_b16 v[48:49], v6 offset:49152
    ds_read_b64_tr_b16 v[50:51], v6 offset:49664
    ds_read_b64_tr_b16 v[52:53], v208 offset:49152
    ds_read_b64_tr_b16 v[54:55], v208 offset:49664
    s_waitcnt vmcnt(11) lgkmcnt(8)
    s_add_u32 s36, s28, 860160
    v_mfma_f32_32x32x16_bf16 v[32:47], v[68:71], v[120:123], v[32:47]
    buffer_load_dwordx4 v[168:171], v9, s[12:15], s36 offen sc1
    v_mfma_f32_32x32x16_bf16 v[16:31], v[64:67], v[120:123], v[16:31]
    ds_read_b64_tr_b16 v[56:57], v6 offset:51200
    ds_read_b64_tr_b16 v[58:59], v6 offset:51712
    ds_read_b64_tr_b16 v[60:61], v208 offset:51200
    ds_read_b64_tr_b16 v[62:63], v208 offset:51712
    s_waitcnt vmcnt(11) lgkmcnt(8)
    s_add_u32 s36, s28, 880640
    v_mfma_f32_32x32x16_bf16 v[32:47], v[76:79], v[124:127], v[32:47]
    buffer_load_dwordx4 v[172:175], v9, s[12:15], s36 offen sc1
    v_mfma_f32_32x32x16_bf16 v[16:31], v[72:75], v[124:127], v[16:31]
    ds_read_b64_tr_b16 v[64:65], v6 offset:53248
    ds_read_b64_tr_b16 v[66:67], v6 offset:53760
    ds_read_b64_tr_b16 v[68:69], v208 offset:53248
    ds_read_b64_tr_b16 v[70:71], v208 offset:53760
    s_waitcnt vmcnt(11) lgkmcnt(8)
    s_add_u32 s36, s28, 983040
    v_mfma_f32_32x32x16_bf16 v[32:47], v[52:55], v[128:131], v[32:47]
    buffer_load_dwordx4 v[176:179], v9, s[12:15], s36 offen sc1
    v_mfma_f32_32x32x16_bf16 v[16:31], v[48:51], v[128:131], v[16:31]
    ds_read_b64_tr_b16 v[72:73], v6 offset:55296
    ds_read_b64_tr_b16 v[74:75], v6 offset:55808
    ds_read_b64_tr_b16 v[76:77], v208 offset:55296
    ds_read_b64_tr_b16 v[78:79], v208 offset:55808
    s_waitcnt lgkmcnt(0)
    s_barrier
    s_waitcnt vmcnt(11) lgkmcnt(8)
    s_add_u32 s36, s28, 1003520
    v_mfma_f32_32x32x16_bf16 v[32:47], v[60:63], v[132:135], v[32:47]
    buffer_load_dwordx4 v[180:183], v9, s[12:15], s36 offen sc1
    v_mfma_f32_32x32x16_bf16 v[16:31], v[56:59], v[132:135], v[16:31]
    ds_read_b64_tr_b16 v[48:49], v7 offset:0
    ds_read_b64_tr_b16 v[50:51], v7 offset:512
    ds_read_b64_tr_b16 v[52:53], v209 offset:0
    ds_read_b64_tr_b16 v[54:55], v209 offset:512
    s_waitcnt vmcnt(11) lgkmcnt(8)
    s_add_u32 s36, s28, 1024000
    v_mfma_f32_32x32x16_bf16 v[32:47], v[68:71], v[136:139], v[32:47]
    buffer_load_dwordx4 v[184:187], v9, s[12:15], s36 offen sc1
    v_mfma_f32_32x32x16_bf16 v[16:31], v[64:67], v[136:139], v[16:31]
    ds_read_b64_tr_b16 v[56:57], v7 offset:2048
    ds_read_b64_tr_b16 v[58:59], v7 offset:2560
    ds_read_b64_tr_b16 v[60:61], v209 offset:2048
    ds_read_b64_tr_b16 v[62:63], v209 offset:2560
    s_waitcnt vmcnt(11) lgkmcnt(8)
    s_add_u32 s36, s28, 1044480
    v_mfma_f32_32x32x16_bf16 v[32:47], v[76:79], v[140:143], v[32:47]
    buffer_load_dwordx4 v[188:191], v9, s[12:15], s36 offen sc1
    v_mfma_f32_32x32x16_bf16 v[16:31], v[72:75], v[140:143], v[16:31]
    ds_read_b64_tr_b16 v[64:65], v7 offset:4096
    ds_read_b64_tr_b16 v[66:67], v7 offset:4608
    ds_read_b64_tr_b16 v[68:69], v209 offset:4096
    ds_read_b64_tr_b16 v[70:71], v209 offset:4608
    s_waitcnt vmcnt(11) lgkmcnt(8)
    s_add_u32 s36, s28, 1146880
    v_mfma_f32_32x32x16_bf16 v[32:47], v[52:55], v[144:147], v[32:47]
    buffer_load_dwordx4 v[192:195], v9, s[12:15], s36 offen sc1
    v_mfma_f32_32x32x16_bf16 v[16:31], v[48:51], v[144:147], v[16:31]
    ds_read_b64_tr_b16 v[72:73], v7 offset:6144
    ds_read_b64_tr_b16 v[74:75], v7 offset:6656
    ds_read_b64_tr_b16 v[76:77], v209 offset:6144
    ds_read_b64_tr_b16 v[78:79], v209 offset:6656
    s_waitcnt vmcnt(11) lgkmcnt(8)
    s_add_u32 s36, s28, 1167360
    v_mfma_f32_32x32x16_bf16 v[32:47], v[60:63], v[148:151], v[32:47]
    buffer_load_dwordx4 v[196:199], v9, s[12:15], s36 offen sc1
    v_mfma_f32_32x32x16_bf16 v[16:31], v[56:59], v[148:151], v[16:31]
    ds_read_b64_tr_b16 v[48:49], v7 offset:16384
    ds_read_b64_tr_b16 v[50:51], v7 offset:16896
    ds_read_b64_tr_b16 v[52:53], v209 offset:16384
    ds_read_b64_tr_b16 v[54:55], v209 offset:16896
    s_waitcnt vmcnt(11) lgkmcnt(8)
    s_add_u32 s36, s28, 1187840
    v_mfma_f32_32x32x16_bf16 v[32:47], v[68:71], v[152:155], v[32:47]
    buffer_load_dwordx4 v[200:203], v9, s[12:15], s36 offen sc1
    v_mfma_f32_32x32x16_bf16 v[16:31], v[64:67], v[152:155], v[16:31]
    ds_read_b64_tr_b16 v[56:57], v7 offset:18432
    ds_read_b64_tr_b16 v[58:59], v7 offset:18944
    ds_read_b64_tr_b16 v[60:61], v209 offset:18432
    ds_read_b64_tr_b16 v[62:63], v209 offset:18944
    s_waitcnt vmcnt(11) lgkmcnt(8)
    s_add_u32 s36, s28, 1208320
    v_mfma_f32_32x32x16_bf16 v[32:47], v[76:79], v[156:159], v[32:47]
    buffer_load_dwordx4 v[204:207], v9, s[12:15], s36 offen sc1
    v_mfma_f32_32x32x16_bf16 v[16:31], v[72:75], v[156:159], v[16:31]
    ds_read_b64_tr_b16 v[64:65], v7 offset:20480
    ds_read_b64_tr_b16 v[66:67], v7 offset:20992
    ds_read_b64_tr_b16 v[68:69], v209 offset:20480
    ds_read_b64_tr_b16 v[70:71], v209 offset:20992
    s_waitcnt vmcnt(11) lgkmcnt(8)
    s_add_u32 s36, s28, 1310720
    v_mfma_f32_32x32x16_bf16 v[32:47], v[52:55], v[160:163], v[32:47]
    buffer_load_dwordx4 v[80:83], v9, s[12:15], s36 offen sc1
    v_mfma_f32_32x32x16_bf16 v[16:31], v[48:51], v[160:163], v[16:31]
    ds_read_b64_tr_b16 v[72:73], v7 offset:22528
    ds_read_b64_tr_b16 v[74:75], v7 offset:23040
    ds_read_b64_tr_b16 v[76:77], v209 offset:22528
    ds_read_b64_tr_b16 v[78:79], v209 offset:23040
    s_waitcnt vmcnt(11) lgkmcnt(8)
    s_add_u32 s36, s28, 1331200
    v_mfma_f32_32x32x16_bf16 v[32:47], v[60:63], v[164:167], v[32:47]
    buffer_load_dwordx4 v[84:87], v9, s[12:15], s36 offen sc1
    v_mfma_f32_32x32x16_bf16 v[16:31], v[56:59], v[164:167], v[16:31]
    ds_read_b64_tr_b16 v[48:49], v7 offset:32768
    ds_read_b64_tr_b16 v[50:51], v7 offset:33280
    ds_read_b64_tr_b16 v[52:53], v209 offset:32768
    ds_read_b64_tr_b16 v[54:55], v209 offset:33280
    s_waitcnt vmcnt(11) lgkmcnt(8)
    s_add_u32 s36, s28, 1351680
    v_mfma_f32_32x32x16_bf16 v[32:47], v[68:71], v[168:171], v[32:47]
    buffer_load_dwordx4 v[88:91], v9, s[12:15], s36 offen sc1
    v_mfma_f32_32x32x16_bf16 v[16:31], v[64:67], v[168:171], v[16:31]
    ds_read_b64_tr_b16 v[56:57], v7 offset:34816
    ds_read_b64_tr_b16 v[58:59], v7 offset:35328
    ds_read_b64_tr_b16 v[60:61], v209 offset:34816
    ds_read_b64_tr_b16 v[62:63], v209 offset:35328
    s_waitcnt vmcnt(11) lgkmcnt(8)
    s_add_u32 s36, s28, 1372160
    v_mfma_f32_32x32x16_bf16 v[32:47], v[76:79], v[172:175], v[32:47]
    buffer_load_dwordx4 v[92:95], v9, s[12:15], s36 offen sc1
    v_mfma_f32_32x32x16_bf16 v[16:31], v[72:75], v[172:175], v[16:31]
    ds_read_b64_tr_b16 v[64:65], v7 offset:36864
    ds_read_b64_tr_b16 v[66:67], v7 offset:37376
    ds_read_b64_tr_b16 v[68:69], v209 offset:36864
    ds_read_b64_tr_b16 v[70:71], v209 offset:37376
    s_waitcnt vmcnt(11) lgkmcnt(8)
    s_add_u32 s36, s28, 1474560
    v_mfma_f32_32x32x16_bf16 v[32:47], v[52:55], v[176:179], v[32:47]
    buffer_load_dwordx4 v[96:99], v9, s[12:15], s36 offen sc1
    v_mfma_f32_32x32x16_bf16 v[16:31], v[48:51], v[176:179], v[16:31]
    ds_read_b64_tr_b16 v[72:73], v7 offset:38912
    ds_read_b64_tr_b16 v[74:75], v7 offset:39424
    ds_read_b64_tr_b16 v[76:77], v209 offset:38912
    ds_read_b64_tr_b16 v[78:79], v209 offset:39424
    s_waitcnt lgkmcnt(0)
    s_barrier
    s_waitcnt vmcnt(11) lgkmcnt(8)
    s_add_u32 s36, s28, 1495040
    v_mfma_f32_32x32x16_bf16 v[32:47], v[60:63], v[180:183], v[32:47]
    buffer_load_dwordx4 v[100:103], v9, s[12:15], s36 offen sc1
    v_mfma_f32_32x32x16_bf16 v[16:31], v[56:59], v[180:183], v[16:31]
    ds_read_b64_tr_b16 v[48:49], v7 offset:49152
    ds_read_b64_tr_b16 v[50:51], v7 offset:49664
    ds_read_b64_tr_b16 v[52:53], v209 offset:49152
    ds_read_b64_tr_b16 v[54:55], v209 offset:49664
    s_waitcnt vmcnt(11) lgkmcnt(8)
    s_add_u32 s36, s28, 1515520
    v_mfma_f32_32x32x16_bf16 v[32:47], v[68:71], v[184:187], v[32:47]
    buffer_load_dwordx4 v[104:107], v9, s[12:15], s36 offen sc1
    v_mfma_f32_32x32x16_bf16 v[16:31], v[64:67], v[184:187], v[16:31]
    ds_read_b64_tr_b16 v[56:57], v7 offset:51200
    ds_read_b64_tr_b16 v[58:59], v7 offset:51712
    ds_read_b64_tr_b16 v[60:61], v209 offset:51200
    ds_read_b64_tr_b16 v[62:63], v209 offset:51712
    s_waitcnt vmcnt(11) lgkmcnt(8)
    s_add_u32 s36, s28, 1536000
    v_mfma_f32_32x32x16_bf16 v[32:47], v[76:79], v[188:191], v[32:47]
    buffer_load_dwordx4 v[108:111], v9, s[12:15], s36 offen sc1
    v_mfma_f32_32x32x16_bf16 v[16:31], v[72:75], v[188:191], v[16:31]
    ds_read_b64_tr_b16 v[64:65], v7 offset:53248
    ds_read_b64_tr_b16 v[66:67], v7 offset:53760
    ds_read_b64_tr_b16 v[68:69], v209 offset:53248
    ds_read_b64_tr_b16 v[70:71], v209 offset:53760
    s_waitcnt vmcnt(11) lgkmcnt(8)
    s_add_u32 s36, s28, 1638400
    v_mfma_f32_32x32x16_bf16 v[32:47], v[52:55], v[192:195], v[32:47]
    buffer_load_dwordx4 v[112:115], v9, s[12:15], s36 offen sc1
    v_mfma_f32_32x32x16_bf16 v[16:31], v[48:51], v[192:195], v[16:31]
    ds_read_b64_tr_b16 v[72:73], v7 offset:55296
    ds_read_b64_tr_b16 v[74:75], v7 offset:55808
    ds_read_b64_tr_b16 v[76:77], v209 offset:55296
    ds_read_b64_tr_b16 v[78:79], v209 offset:55808
    s_waitcnt vmcnt(11) lgkmcnt(8)
    s_add_u32 s36, s28, 1658880
    v_mfma_f32_32x32x16_bf16 v[32:47], v[60:63], v[196:199], v[32:47]
    buffer_load_dwordx4 v[116:119], v9, s[12:15], s36 offen sc1
    v_mfma_f32_32x32x16_bf16 v[16:31], v[56:59], v[196:199], v[16:31]
    ds_read_b64_tr_b16 v[48:49], v8 offset:0
    ds_read_b64_tr_b16 v[50:51], v8 offset:512
    ds_read_b64_tr_b16 v[52:53], v210 offset:0
    ds_read_b64_tr_b16 v[54:55], v210 offset:512
    s_waitcnt vmcnt(11) lgkmcnt(8)
    s_add_u32 s36, s28, 1679360
    v_mfma_f32_32x32x16_bf16 v[32:47], v[68:71], v[200:203], v[32:47]
    buffer_load_dwordx4 v[120:123], v9, s[12:15], s36 offen sc1
    v_mfma_f32_32x32x16_bf16 v[16:31], v[64:67], v[200:203], v[16:31]
    ds_read_b64_tr_b16 v[56:57], v8 offset:2048
    ds_read_b64_tr_b16 v[58:59], v8 offset:2560
    ds_read_b64_tr_b16 v[60:61], v210 offset:2048
    ds_read_b64_tr_b16 v[62:63], v210 offset:2560
    s_waitcnt vmcnt(11) lgkmcnt(8)
    s_add_u32 s36, s28, 1699840
    v_mfma_f32_32x32x16_bf16 v[32:47], v[76:79], v[204:207], v[32:47]
    buffer_load_dwordx4 v[124:127], v9, s[12:15], s36 offen sc1
    v_mfma_f32_32x32x16_bf16 v[16:31], v[72:75], v[204:207], v[16:31]
    ds_read_b64_tr_b16 v[64:65], v8 offset:4096
    ds_read_b64_tr_b16 v[66:67], v8 offset:4608
    ds_read_b64_tr_b16 v[68:69], v210 offset:4096
    ds_read_b64_tr_b16 v[70:71], v210 offset:4608
    s_waitcnt vmcnt(11) lgkmcnt(8)
    s_add_u32 s36, s28, 1802240
    v_mfma_f32_32x32x16_bf16 v[32:47], v[52:55], v[80:83], v[32:47]
    buffer_load_dwordx4 v[128:131], v9, s[12:15], s36 offen sc1
    v_mfma_f32_32x32x16_bf16 v[16:31], v[48:51], v[80:83], v[16:31]
    ds_read_b64_tr_b16 v[72:73], v8 offset:6144
    ds_read_b64_tr_b16 v[74:75], v8 offset:6656
    ds_read_b64_tr_b16 v[76:77], v210 offset:6144
    ds_read_b64_tr_b16 v[78:79], v210 offset:6656
    s_waitcnt lgkmcnt(0)
    s_barrier
    s_waitcnt vmcnt(11) lgkmcnt(8)
    s_add_u32 s36, s28, 1822720
    v_mfma_f32_32x32x16_bf16 v[32:47], v[60:63], v[84:87], v[32:47]
    buffer_load_dwordx4 v[132:135], v9, s[12:15], s36 offen sc1
    v_mfma_f32_32x32x16_bf16 v[16:31], v[56:59], v[84:87], v[16:31]
    ds_read_b64_tr_b16 v[48:49], v6 offset:0
    ds_read_b64_tr_b16 v[50:51], v6 offset:512
    ds_read_b64_tr_b16 v[52:53], v208 offset:0
    ds_read_b64_tr_b16 v[54:55], v208 offset:512
    s_waitcnt vmcnt(11) lgkmcnt(8)
    s_add_u32 s36, s28, 1843200
    v_mfma_f32_32x32x16_bf16 v[32:47], v[68:71], v[88:91], v[32:47]
    buffer_load_dwordx4 v[136:139], v9, s[12:15], s36 offen sc1
    v_mfma_f32_32x32x16_bf16 v[16:31], v[64:67], v[88:91], v[16:31]
    ds_read_b64_tr_b16 v[56:57], v6 offset:2048
    ds_read_b64_tr_b16 v[58:59], v6 offset:2560
    ds_read_b64_tr_b16 v[60:61], v208 offset:2048
    ds_read_b64_tr_b16 v[62:63], v208 offset:2560
    s_waitcnt vmcnt(11) lgkmcnt(8)
    s_add_u32 s36, s28, 1863680
    v_mfma_f32_32x32x16_bf16 v[32:47], v[76:79], v[92:95], v[32:47]
    buffer_load_dwordx4 v[140:143], v9, s[12:15], s36 offen sc1
    v_mfma_f32_32x32x16_bf16 v[16:31], v[72:75], v[92:95], v[16:31]
    ds_read_b64_tr_b16 v[64:65], v6 offset:4096
    ds_read_b64_tr_b16 v[66:67], v6 offset:4608
    ds_read_b64_tr_b16 v[68:69], v208 offset:4096
    ds_read_b64_tr_b16 v[70:71], v208 offset:4608
    s_waitcnt vmcnt(11) lgkmcnt(8)
    s_add_u32 s36, s28, 1966080
    v_mfma_f32_32x32x16_bf16 v[32:47], v[52:55], v[96:99], v[32:47]
    buffer_load_dwordx4 v[144:147], v9, s[12:15], s36 offen sc1
    v_mfma_f32_32x32x16_bf16 v[16:31], v[48:51], v[96:99], v[16:31]
    ds_read_b64_tr_b16 v[72:73], v6 offset:6144
    ds_read_b64_tr_b16 v[74:75], v6 offset:6656
    ds_read_b64_tr_b16 v[76:77], v208 offset:6144
    ds_read_b64_tr_b16 v[78:79], v208 offset:6656
    s_waitcnt vmcnt(11) lgkmcnt(8)
    s_add_u32 s36, s28, 1986560
    v_mfma_f32_32x32x16_bf16 v[32:47], v[60:63], v[100:103], v[32:47]
    buffer_load_dwordx4 v[148:151], v9, s[12:15], s36 offen sc1
    v_mfma_f32_32x32x16_bf16 v[16:31], v[56:59], v[100:103], v[16:31]
    ds_read_b64_tr_b16 v[48:49], v6 offset:16384
    ds_read_b64_tr_b16 v[50:51], v6 offset:16896
    ds_read_b64_tr_b16 v[52:53], v208 offset:16384
    ds_read_b64_tr_b16 v[54:55], v208 offset:16896
    s_waitcnt vmcnt(11) lgkmcnt(8)
    s_add_u32 s36, s28, 2007040
    v_mfma_f32_32x32x16_bf16 v[32:47], v[68:71], v[104:107], v[32:47]
    buffer_load_dwordx4 v[152:155], v9, s[12:15], s36 offen sc1
    v_mfma_f32_32x32x16_bf16 v[16:31], v[64:67], v[104:107], v[16:31]
    ds_read_b64_tr_b16 v[56:57], v6 offset:18432
    ds_read_b64_tr_b16 v[58:59], v6 offset:18944
    ds_read_b64_tr_b16 v[60:61], v208 offset:18432
    ds_read_b64_tr_b16 v[62:63], v208 offset:18944
    s_waitcnt vmcnt(11) lgkmcnt(8)
    s_add_u32 s36, s28, 2027520
    v_mfma_f32_32x32x16_bf16 v[32:47], v[76:79], v[108:111], v[32:47]
    buffer_load_dwordx4 v[156:159], v9, s[12:15], s36 offen sc1
    v_mfma_f32_32x32x16_bf16 v[16:31], v[72:75], v[108:111], v[16:31]
    ds_read_b64_tr_b16 v[64:65], v6 offset:20480
    ds_read_b64_tr_b16 v[66:67], v6 offset:20992
    ds_read_b64_tr_b16 v[68:69], v208 offset:20480
    ds_read_b64_tr_b16 v[70:71], v208 offset:20992
    s_waitcnt vmcnt(11) lgkmcnt(8)
    s_add_u32 s36, s28, 2129920
    v_mfma_f32_32x32x16_bf16 v[32:47], v[52:55], v[112:115], v[32:47]
    buffer_load_dwordx4 v[160:163], v9, s[12:15], s36 offen sc1
    v_mfma_f32_32x32x16_bf16 v[16:31], v[48:51], v[112:115], v[16:31]
    ds_read_b64_tr_b16 v[72:73], v6 offset:22528
    ds_read_b64_tr_b16 v[74:75], v6 offset:23040
    ds_read_b64_tr_b16 v[76:77], v208 offset:22528
    ds_read_b64_tr_b16 v[78:79], v208 offset:23040
    s_waitcnt vmcnt(11) lgkmcnt(8)
    s_add_u32 s36, s28, 2150400
    v_mfma_f32_32x32x16_bf16 v[32:47], v[60:63], v[116:119], v[32:47]
    buffer_load_dwordx4 v[164:167], v9, s[12:15], s36 offen sc1
    v_mfma_f32_32x32x16_bf16 v[16:31], v[56:59], v[116:119], v[16:31]
    ds_read_b64_tr_b16 v[48:49], v6 offset:32768
    ds_read_b64_tr_b16 v[50:51], v6 offset:33280
    ds_read_b64_tr_b16 v[52:53], v208 offset:32768
    ds_read_b64_tr_b16 v[54:55], v208 offset:33280
    s_waitcnt vmcnt(11) lgkmcnt(8)
    s_add_u32 s36, s28, 2170880
    v_mfma_f32_32x32x16_bf16 v[32:47], v[68:71], v[120:123], v[32:47]
    buffer_load_dwordx4 v[168:171], v9, s[12:15], s36 offen sc1
    v_mfma_f32_32x32x16_bf16 v[16:31], v[64:67], v[120:123], v[16:31]
    ds_read_b64_tr_b16 v[56:57], v6 offset:34816
    ds_read_b64_tr_b16 v[58:59], v6 offset:35328
    ds_read_b64_tr_b16 v[60:61], v208 offset:34816
    ds_read_b64_tr_b16 v[62:63], v208 offset:35328
    s_waitcnt vmcnt(11) lgkmcnt(8)
    s_add_u32 s36, s28, 2191360
    v_mfma_f32_32x32x16_bf16 v[32:47], v[76:79], v[124:127], v[32:47]
    buffer_load_dwordx4 v[172:175], v9, s[12:15], s36 offen sc1
    v_mfma_f32_32x32x16_bf16 v[16:31], v[72:75], v[124:127], v[16:31]
    ds_read_b64_tr_b16 v[64:65], v6 offset:36864
    ds_read_b64_tr_b16 v[66:67], v6 offset:37376
    ds_read_b64_tr_b16 v[68:69], v208 offset:36864
    ds_read_b64_tr_b16 v[70:71], v208 offset:37376
    s_waitcnt vmcnt(11) lgkmcnt(8)
    s_add_u32 s36, s28, 2293760
    v_mfma_f32_32x32x16_bf16 v[32:47], v[52:55], v[128:131], v[32:47]
    buffer_load_dwordx4 v[176:179], v9, s[12:15], s36 offen sc1
    v_mfma_f32_32x32x16_bf16 v[16:31], v[48:51], v[128:131], v[16:31]
    ds_read_b64_tr_b16 v[72:73], v6 offset:38912
    ds_read_b64_tr_b16 v[74:75], v6 offset:39424
    ds_read_b64_tr_b16 v[76:77], v208 offset:38912
    ds_read_b64_tr_b16 v[78:79], v208 offset:39424
    s_waitcnt vmcnt(11) lgkmcnt(8)
    s_add_u32 s36, s28, 2314240
    v_mfma_f32_32x32x16_bf16 v[32:47], v[60:63], v[132:135], v[32:47]
    buffer_load_dwordx4 v[180:183], v9, s[12:15], s36 offen sc1
    v_mfma_f32_32x32x16_bf16 v[16:31], v[56:59], v[132:135], v[16:31]
    ds_read_b64_tr_b16 v[48:49], v6 offset:49152
    ds_read_b64_tr_b16 v[50:51], v6 offset:49664
    ds_read_b64_tr_b16 v[52:53], v208 offset:49152
    ds_read_b64_tr_b16 v[54:55], v208 offset:49664
    s_waitcnt vmcnt(11) lgkmcnt(8)
    s_add_u32 s36, s28, 2334720
    v_mfma_f32_32x32x16_bf16 v[32:47], v[68:71], v[136:139], v[32:47]
    buffer_load_dwordx4 v[184:187], v9, s[12:15], s36 offen sc1
    v_mfma_f32_32x32x16_bf16 v[16:31], v[64:67], v[136:139], v[16:31]
    ds_read_b64_tr_b16 v[56:57], v6 offset:51200
    ds_read_b64_tr_b16 v[58:59], v6 offset:51712
    ds_read_b64_tr_b16 v[60:61], v208 offset:51200
    ds_read_b64_tr_b16 v[62:63], v208 offset:51712
    s_waitcnt vmcnt(11) lgkmcnt(8)
    s_add_u32 s36, s28, 2355200
    v_mfma_f32_32x32x16_bf16 v[32:47], v[76:79], v[140:143], v[32:47]
    buffer_load_dwordx4 v[188:191], v9, s[12:15], s36 offen sc1
    v_mfma_f32_32x32x16_bf16 v[16:31], v[72:75], v[140:143], v[16:31]
    ds_read_b64_tr_b16 v[64:65], v6 offset:53248
    ds_read_b64_tr_b16 v[66:67], v6 offset:53760
    ds_read_b64_tr_b16 v[68:69], v208 offset:53248
    ds_read_b64_tr_b16 v[70:71], v208 offset:53760
    s_waitcnt vmcnt(11) lgkmcnt(8)
    s_add_u32 s36, s28, 2457600
    v_mfma_f32_32x32x16_bf16 v[32:47], v[52:55], v[144:147], v[32:47]
    buffer_load_dwordx4 v[192:195], v9, s[12:15], s36 offen sc1
    v_mfma_f32_32x32x16_bf16 v[16:31], v[48:51], v[144:147], v[16:31]
    ds_read_b64_tr_b16 v[72:73], v6 offset:55296
    ds_read_b64_tr_b16 v[74:75], v6 offset:55808
    ds_read_b64_tr_b16 v[76:77], v208 offset:55296
    ds_read_b64_tr_b16 v[78:79], v208 offset:55808
    s_waitcnt lgkmcnt(0)
    s_barrier
    s_waitcnt vmcnt(11) lgkmcnt(8)
    s_add_u32 s36, s28, 2478080
    v_mfma_f32_32x32x16_bf16 v[32:47], v[60:63], v[148:151], v[32:47]
    buffer_load_dwordx4 v[196:199], v9, s[12:15], s36 offen sc1
    v_mfma_f32_32x32x16_bf16 v[16:31], v[56:59], v[148:151], v[16:31]
    ds_read_b64_tr_b16 v[48:49], v7 offset:0
    ds_read_b64_tr_b16 v[50:51], v7 offset:512
    ds_read_b64_tr_b16 v[52:53], v209 offset:0
    ds_read_b64_tr_b16 v[54:55], v209 offset:512
    s_waitcnt vmcnt(11) lgkmcnt(8)
    s_add_u32 s36, s28, 2498560
    v_mfma_f32_32x32x16_bf16 v[32:47], v[68:71], v[152:155], v[32:47]
    buffer_load_dwordx4 v[200:203], v9, s[12:15], s36 offen sc1
    v_mfma_f32_32x32x16_bf16 v[16:31], v[64:67], v[152:155], v[16:31]
    ds_read_b64_tr_b16 v[56:57], v7 offset:2048
    ds_read_b64_tr_b16 v[58:59], v7 offset:2560
    ds_read_b64_tr_b16 v[60:61], v209 offset:2048
    ds_read_b64_tr_b16 v[62:63], v209 offset:2560
    s_waitcnt vmcnt(11) lgkmcnt(8)
    s_add_u32 s36, s28, 2519040
    v_mfma_f32_32x32x16_bf16 v[32:47], v[76:79], v[156:159], v[32:47]
    buffer_load_dwordx4 v[204:207], v9, s[12:15], s36 offen sc1
    v_mfma_f32_32x32x16_bf16 v[16:31], v[72:75], v[156:159], v[16:31]
    ds_read_b64_tr_b16 v[64:65], v7 offset:4096
    ds_read_b64_tr_b16 v[66:67], v7 offset:4608
    ds_read_b64_tr_b16 v[68:69], v209 offset:4096
    ds_read_b64_tr_b16 v[70:71], v209 offset:4608
    s_waitcnt vmcnt(11) lgkmcnt(8)
    v_mfma_f32_32x32x16_bf16 v[32:47], v[52:55], v[160:163], v[32:47]
    ds_read_b64_tr_b16 v[72:73], v7 offset:6144
    ds_read_b64_tr_b16 v[74:75], v7 offset:6656
    v_mfma_f32_32x32x16_bf16 v[16:31], v[48:51], v[160:163], v[16:31]
    ds_read_b64_tr_b16 v[76:77], v209 offset:6144
    ds_read_b64_tr_b16 v[78:79], v209 offset:6656
    s_waitcnt vmcnt(10) lgkmcnt(8)
    v_mfma_f32_32x32x16_bf16 v[32:47], v[60:63], v[164:167], v[32:47]
    ds_read_b64_tr_b16 v[48:49], v7 offset:16384
    ds_read_b64_tr_b16 v[50:51], v7 offset:16896
    v_mfma_f32_32x32x16_bf16 v[16:31], v[56:59], v[164:167], v[16:31]
    ds_read_b64_tr_b16 v[52:53], v209 offset:16384
    ds_read_b64_tr_b16 v[54:55], v209 offset:16896
    s_waitcnt vmcnt(9) lgkmcnt(8)
    v_mfma_f32_32x32x16_bf16 v[32:47], v[68:71], v[168:171], v[32:47]
    ds_read_b64_tr_b16 v[56:57], v7 offset:18432
    ds_read_b64_tr_b16 v[58:59], v7 offset:18944
    v_mfma_f32_32x32x16_bf16 v[16:31], v[64:67], v[168:171], v[16:31]
    ds_read_b64_tr_b16 v[60:61], v209 offset:18432
    ds_read_b64_tr_b16 v[62:63], v209 offset:18944
    s_waitcnt vmcnt(8) lgkmcnt(8)
    v_mfma_f32_32x32x16_bf16 v[32:47], v[76:79], v[172:175], v[32:47]
    ds_read_b64_tr_b16 v[64:65], v7 offset:20480
    ds_read_b64_tr_b16 v[66:67], v7 offset:20992
    v_mfma_f32_32x32x16_bf16 v[16:31], v[72:75], v[172:175], v[16:31]
    ds_read_b64_tr_b16 v[68:69], v209 offset:20480
    ds_read_b64_tr_b16 v[70:71], v209 offset:20992
    s_waitcnt vmcnt(7) lgkmcnt(8)
    v_mfma_f32_32x32x16_bf16 v[32:47], v[52:55], v[176:179], v[32:47]
    ds_read_b64_tr_b16 v[72:73], v7 offset:22528
    ds_read_b64_tr_b16 v[74:75], v7 offset:23040
    v_mfma_f32_32x32x16_bf16 v[16:31], v[48:51], v[176:179], v[16:31]
    ds_read_b64_tr_b16 v[76:77], v209 offset:22528
    ds_read_b64_tr_b16 v[78:79], v209 offset:23040
    s_waitcnt vmcnt(6) lgkmcnt(8)
    v_mfma_f32_32x32x16_bf16 v[32:47], v[60:63], v[180:183], v[32:47]
    ds_read_b64_tr_b16 v[48:49], v7 offset:32768
    ds_read_b64_tr_b16 v[50:51], v7 offset:33280
    v_mfma_f32_32x32x16_bf16 v[16:31], v[56:59], v[180:183], v[16:31]
    ds_read_b64_tr_b16 v[52:53], v209 offset:32768
    ds_read_b64_tr_b16 v[54:55], v209 offset:33280
    s_waitcnt vmcnt(5) lgkmcnt(8)
    v_mfma_f32_32x32x16_bf16 v[32:47], v[68:71], v[184:187], v[32:47]
    ds_read_b64_tr_b16 v[56:57], v7 offset:34816
    ds_read_b64_tr_b16 v[58:59], v7 offset:35328
    v_mfma_f32_32x32x16_bf16 v[16:31], v[64:67], v[184:187], v[16:31]
    ds_read_b64_tr_b16 v[60:61], v209 offset:34816
    ds_read_b64_tr_b16 v[62:63], v209 offset:35328
    s_waitcnt vmcnt(4) lgkmcnt(8)
    v_mfma_f32_32x32x16_bf16 v[32:47], v[76:79], v[188:191], v[32:47]
    ds_read_b64_tr_b16 v[64:65], v7 offset:36864
    ds_read_b64_tr_b16 v[66:67], v7 offset:37376
    v_mfma_f32_32x32x16_bf16 v[16:31], v[72:75], v[188:191], v[16:31]
    ds_read_b64_tr_b16 v[68:69], v209 offset:36864
    ds_read_b64_tr_b16 v[70:71], v209 offset:37376
    s_waitcnt vmcnt(3) lgkmcnt(8)
    v_mfma_f32_32x32x16_bf16 v[32:47], v[52:55], v[192:195], v[32:47]
    ds_read_b64_tr_b16 v[72:73], v7 offset:38912
    ds_read_b64_tr_b16 v[74:75], v7 offset:39424
    v_mfma_f32_32x32x16_bf16 v[16:31], v[48:51], v[192:195], v[16:31]
    ds_read_b64_tr_b16 v[76:77], v209 offset:38912
    ds_read_b64_tr_b16 v[78:79], v209 offset:39424
    s_waitcnt vmcnt(2) lgkmcnt(8)
    v_mfma_f32_32x32x16_bf16 v[32:47], v[60:63], v[196:199], v[32:47]
    v_mfma_f32_32x32x16_bf16 v[16:31], v[56:59], v[196:199], v[16:31]
    s_waitcnt vmcnt(1) lgkmcnt(4)
    v_mfma_f32_32x32x16_bf16 v[32:47], v[68:71], v[200:203], v[32:47]
    v_mfma_f32_32x32x16_bf16 v[16:31], v[64:67], v[200:203], v[16:31]
    s_waitcnt vmcnt(0) lgkmcnt(0)
    v_mfma_f32_32x32x16_bf16 v[32:47], v[76:79], v[204:207], v[32:47]
    v_mfma_f32_32x32x16_bf16 v[16:31], v[72:75], v[204:207], v[16:31]
    s_nop 10
    ds_write_b128 v211, v[32:35] offset:0
    ds_write_b128 v211, v[36:39] offset:1024
    ds_write_b128 v211, v[40:43] offset:2048
    ds_write_b128 v211, v[44:47] offset:3072
    s_waitcnt lgkmcnt(0)
    s_barrier
    ds_read_b128 v[48:51], v212 offset:0
    ds_read_b128 v[56:59], v212 offset:2048
    ds_read_b128 v[52:55], v212 offset:1024
    ds_read_b128 v[60:63], v212 offset:3072
    s_waitcnt lgkmcnt(2)
    v_pk_add_f32 v[48:49], v[48:49], v[16:17]
    v_pk_add_f32 v[50:51], v[50:51], v[18:19]
    v_pk_add_f32 v[56:57], v[56:57], v[24:25]
    v_pk_add_f32 v[58:59], v[58:59], v[26:27]
    v_pk_mul_f32 v[64:65], v[48:49], v[48:49]
    v_pk_mul_f32 v[66:67], v[50:51], v[50:51]
    v_pk_mul_f32 v[72:73], v[56:57], v[56:57]
    v_pk_mul_f32 v[74:75], v[58:59], v[58:59]
    v_pk_fma_f32 v[64:65], v[64:65], v[216:217], v[214:215]
    v_pk_fma_f32 v[66:67], v[66:67], v[216:217], v[214:215]
    v_pk_fma_f32 v[72:73], v[72:73], v[216:217], v[214:215]
    v_pk_fma_f32 v[74:75], v[74:75], v[216:217], v[214:215]
    v_pk_mul_f32 v[64:65], v[64:65], v[48:49]
    v_pk_mul_f32 v[66:67], v[66:67], v[50:51]
    v_pk_mul_f32 v[72:73], v[72:73], v[56:57]
    v_pk_mul_f32 v[74:75], v[74:75], v[58:59]
    v_exp_f32 v64, v64
    v_exp_f32 v65, v65
    v_exp_f32 v66, v66
    v_exp_f32 v67, v67
    v_exp_f32 v72, v72
    v_exp_f32 v73, v73
    v_exp_f32 v74, v74
    v_exp_f32 v75, v75
    v_pk_add_f32 v[64:65], v[64:65], v[218:219]
    v_pk_add_f32 v[66:67], v[66:67], v[218:219]
    v_pk_add_f32 v[72:73], v[72:73], v[218:219]
    v_pk_add_f32 v[74:75], v[74:75], v[218:219]
    v_rcp_f32 v64, v64
    v_rcp_f32 v65, v65
    v_rcp_f32 v66, v66
    v_rcp_f32 v67, v67
    v_rcp_f32 v72, v72
    v_rcp_f32 v73, v73
    v_rcp_f32 v74, v74
    v_rcp_f32 v75, v75
    v_pk_mul_f32 v[48:49], v[48:49], v[64:65]
    v_pk_mul_f32 v[50:51], v[50:51], v[66:67]
    v_pk_mul_f32 v[56:57], v[56:57], v[72:73]
    v_pk_mul_f32 v[58:59], v[58:59], v[74:75]
    v_cvt_pk_bf16_f32 v96, v48, v49
    v_cvt_pk_bf16_f32 v97, v50, v51
    v_cvt_pk_bf16_f32 v98, v56, v57
    v_cvt_pk_bf16_f32 v99, v58, v59
    buffer_store_dwordx4 v[96:99], v233, s[12:15], s49 offen offset:0 sc1
    s_waitcnt lgkmcnt(0)
    v_pk_add_f32 v[52:53], v[52:53], v[20:21]
    v_pk_add_f32 v[54:55], v[54:55], v[22:23]
    v_pk_add_f32 v[60:61], v[60:61], v[28:29]
    v_pk_add_f32 v[62:63], v[62:63], v[30:31]
    v_pk_mul_f32 v[68:69], v[52:53], v[52:53]
    v_pk_mul_f32 v[70:71], v[54:55], v[54:55]
    v_pk_mul_f32 v[76:77], v[60:61], v[60:61]
    v_pk_mul_f32 v[78:79], v[62:63], v[62:63]
    v_pk_fma_f32 v[68:69], v[68:69], v[216:217], v[214:215]
    v_pk_fma_f32 v[70:71], v[70:71], v[216:217], v[214:215]
    v_pk_fma_f32 v[76:77], v[76:77], v[216:217], v[214:215]
    v_pk_fma_f32 v[78:79], v[78:79], v[216:217], v[214:215]
    v_pk_mul_f32 v[68:69], v[68:69], v[52:53]
    v_pk_mul_f32 v[70:71], v[70:71], v[54:55]
    v_pk_mul_f32 v[76:77], v[76:77], v[60:61]
    v_pk_mul_f32 v[78:79], v[78:79], v[62:63]
    v_exp_f32 v68, v68
    v_exp_f32 v69, v69
    v_exp_f32 v70, v70
    v_exp_f32 v71, v71
    v_exp_f32 v76, v76
    v_exp_f32 v77, v77
    v_exp_f32 v78, v78
    v_exp_f32 v79, v79
    v_pk_add_f32 v[68:69], v[68:69], v[218:219]
    v_pk_add_f32 v[70:71], v[70:71], v[218:219]
    v_pk_add_f32 v[76:77], v[76:77], v[218:219]
    v_pk_add_f32 v[78:79], v[78:79], v[218:219]
    v_rcp_f32 v68, v68
    v_rcp_f32 v69, v69
    v_rcp_f32 v70, v70
    v_rcp_f32 v71, v71
    v_rcp_f32 v76, v76
    v_rcp_f32 v77, v77
    v_rcp_f32 v78, v78
    v_rcp_f32 v79, v79
    v_pk_mul_f32 v[52:53], v[52:53], v[68:69]
    v_pk_mul_f32 v[54:55], v[54:55], v[70:71]
    v_pk_mul_f32 v[60:61], v[60:61], v[76:77]
    v_pk_mul_f32 v[62:63], v[62:63], v[78:79]
    v_cvt_pk_bf16_f32 v100, v52, v53
    v_cvt_pk_bf16_f32 v101, v54, v55
    v_cvt_pk_bf16_f32 v102, v60, v61
    v_cvt_pk_bf16_f32 v103, v62, v63
    buffer_store_dwordx4 v[100:103], v233, s[12:15], s49 offen offset:512 sc1
    v_mov_b32 v13, 1
    v_mov_b32 v12, 159812
    s_mov_b64 exec, 1
    s_waitcnt vmcnt(0)
    ds_add_rtn_u32 v12, v12, v13
    s_waitcnt lgkmcnt(0)
    v_readfirstlane_b32 s37, v12
    s_mov_b64 exec, -1
    s_nop 2
    s_cmp_lg_u32 s37, 3
    s_cbranch_scc1 L_sg_60
    v_mul_u32_u24 v12, 1024, v1
    s_mov_b64 exec, 0xf
    buffer_store_dword v13, v12, s[12:15], s33 offen sc1
    s_mov_b64 exec, -1
L_sg_60:
tl_c_p3:
    v_lshlrev_b32 v2, 9, v5
    v_and_b32 v3, 1, v5
    v_lshl_add_u32 v2, v3, 5, v2
    v_bfe_u32 v3, v1, 2, 2
    v_lshl_add_u32 v2, v3, 6, v2
    v_and_b32 v3, 3, v1
    v_lshl_add_u32 v2, v3, 3, v2
    s_lshl_b32 s36, s24, 12
    v_add_u32 v6, s36, v2
    v_xor_b32 v9, 32, v6
    v_add_u32 v7, 65536, v6
    v_add_u32 v8, 131072, v6
    v_add_u32 v10, 65536, v9
    v_add_u32 v11, 131072, v9
    v_lshlrev_b32 v12, 4, v1
    s_mul_i32 s28, s39, 245760
    s_lshl_b32 s36, s24, 10
    s_add_u32 s28, s28, s36
    s_add_u32 s28, s28, 13107200
    v_mov_b32 v16, 0
    v_mov_b32 v17, 0
    v_mov_b32 v18, 0
    v_mov_b32 v19, 0
    v_mov_b32 v20, 0
    v_mov_b32 v21, 0
    v_mov_b32 v22, 0
    v_mov_b32 v23, 0
    v_mov_b32 v24, 0
    v_mov_b32 v25, 0
    v_mov_b32 v26, 0
    v_mov_b32 v27, 0
    v_mov_b32 v28, 0
    v_mov_b32 v29, 0
    v_mov_b32 v30, 0
    v_mov_b32 v31, 0
    v_mov_b32 v32, 0
    v_mov_b32 v33, 0
    v_mov_b32 v34, 0
    v_mov_b32 v35, 0
    v_mov_b32 v36, 0
    v_mov_b32 v37, 0
    v_mov_b32 v38, 0
    v_mov_b32 v39, 0
    v_mov_b32 v40, 0
    v_mov_b32 v41, 0
    v_mov_b32 v42, 0
    v_mov_b32 v43, 0
    v_mov_b32 v44, 0
    v_mov_b32 v45, 0
    v_mov_b32 v46, 0
    v_mov_b32 v47, 0
    v_mov_b32 v48, 0
    v_mov_b32 v49, 0
    v_mov_b32 v50, 0
    v_mov_b32 v51, 0
    v_mov_b32 v52, 0
    v_mov_b32 v53, 0
    v_mov_b32 v54, 0
    v_mov_b32 v55, 0
    v_mov_b32 v56, 0
    v_mov_b32 v57, 0
    v_mov_b32 v58, 0
    v_mov_b32 v59, 0
    v_mov_b32 v60, 0
    v_mov_b32 v61, 0
    v_mov_b32 v62, 0
    v_mov_b32 v63, 0
    v_mov_b32 v64, 0
    v_mov_b32 v65, 0
    v_mov_b32 v66, 0
    v_mov_b32 v67, 0
    v_mov_b32 v68, 0
    v_mov_b32 v69, 0
    v_mov_b32 v70, 0
    v_mov_b32 v71, 0
    v_mov_b32 v72, 0
    v_mov_b32 v73, 0
    v_mov_b32 v74, 0
    v_mov_b32 v75, 0
    v_mov_b32 v76, 0
    v_mov_b32 v77, 0
    v_mov_b32 v78, 0
    v_mov_b32 v79, 0
    v_mov_b32 v80, 0
    v_mov_b32 v81, 0
    v_mov_b32 v82, 0
    v_mov_b32 v83, 0
    v_mov_b32 v84, 0
    v_mov_b32 v85, 0
    v_mov_b32 v86, 0
    v_mov_b32 v87, 0
    v_mov_b32 v88, 0
    v_mov_b32 v89, 0
    v_mov_b32 v90, 0
    v_mov_b32 v91, 0
    v_mov_b32 v92, 0
    v_mov_b32 v93, 0
    v_mov_b32 v94, 0
    v_mov_b32 v95, 0
    s_mul_i32 s36, s24, 21504
    s_add_u32 s36, s36, 49152
    v_mul_u32_u24 v13, 336, v4
    v_lshl_add_u32 v13, v5, 4, v13
    v_add_u32 v13, s36, v13
    s_barrier
    s_add_u32 s36, s28, 0
    buffer_load_dwordx4 v[128:131], v12, s[12:15], s36 offen sc1
    s_add_u32 s36, s28, 49152
    buffer_load_dwordx4 v[132:135], v12, s[12:15], s36 offen sc1
    s_add_u32 s36, s28, 98304
    buffer_load_dwordx4 v[136:139], v12, s[12:15], s36 offen sc1
    s_add_u32 s36, s28, 147456
    buffer_load_dwordx4 v[140:143], v12, s[12:15], s36 offen sc1
    s_add_u32 s36, s28, 196608
    buffer_load_dwordx4 v[144:147], v12, s[12:15], s36 offen sc1
    ds_read_b64_tr_b16 v[96:97], v6 offset:0
    ds_read_b64_tr_b16 v[98:99], v6 offset:2048
    ds_read_b64_tr_b16 v[100:101], v9 offset:0
    ds_read_b64_tr_b16 v[102:103], v9 offset:2048
    ds_read_b64_tr_b16 v[104:105], v6 offset:256
    ds_read_b64_tr_b16 v[106:107], v6 offset:2304
    ds_read_b64_tr_b16 v[108:109], v9 offset:256
    ds_read_b64_tr_b16 v[110:111], v9 offset:2304
    s_add_u32 s36, s28, 4096
    buffer_load_dwordx4 v[148:151], v12, s[12:15], s36 offen sc1
    s_add_u32 s36, s28, 53248
    buffer_load_dwordx4 v[152:155], v12, s[12:15], s36 offen sc1
    s_add_u32 s36, s28, 102400
    buffer_load_dwordx4 v[156:159], v12, s[12:15], s36 offen sc1
    s_add_u32 s36, s28, 151552
    buffer_load_dwordx4 v[160:163], v12, s[12:15], s36 offen sc1
    s_add_u32 s36, s28, 200704
    buffer_load_dwordx4 v[164:167], v12, s[12:15], s36 offen sc1
    s_waitcnt lgkmcnt(0)
    s_waitcnt vmcnt(9)
    v_mfma_f32_16x16x32_bf16 v[16:19], v[128:131], v[96:99], v[16:19]
    ds_read_b64_tr_b16 v[112:113], v6 offset:16384
    v_mfma_f32_16x16x32_bf16 v[20:23], v[128:131], v[100:103], v[20:23]
    v_mfma_f32_16x16x32_bf16 v[24:27], v[128:131], v[104:107], v[24:27]
    ds_read_b64_tr_b16 v[114:115], v6 offset:18432
    v_mfma_f32_16x16x32_bf16 v[28:31], v[128:131], v[108:111], v[28:31]
    s_add_u32 s36, s28, 8192
    buffer_load_dwordx4 v[168:171], v12, s[12:15], s36 offen sc1
    s_waitcnt vmcnt(9)
    v_mfma_f32_16x16x32_bf16 v[32:35], v[132:135], v[96:99], v[32:35]
    ds_read_b64_tr_b16 v[116:117], v9 offset:16384
    v_mfma_f32_16x16x32_bf16 v[36:39], v[132:135], v[100:103], v[36:39]
    v_mfma_f32_16x16x32_bf16 v[40:43], v[132:135], v[104:107], v[40:43]
    ds_read_b64_tr_b16 v[118:119], v9 offset:18432
    v_mfma_f32_16x16x32_bf16 v[44:47], v[132:135], v[108:111], v[44:47]
    s_add_u32 s36, s28, 57344
    buffer_load_dwordx4 v[172:175], v12, s[12:15], s36 offen sc1
    s_waitcnt vmcnt(9)
    v_mfma_f32_16x16x32_bf16 v[48:51], v[136:139], v[96:99], v[48:51]
    ds_read_b64_tr_b16 v[120:121], v6 offset:16640
    v_mfma_f32_16x16x32_bf16 v[52:55], v[136:139], v[100:103], v[52:55]
    v_mfma_f32_16x16x32_bf16 v[56:59], v[136:139], v[104:107], v[56:59]
    ds_read_b64_tr_b16 v[122:123], v6 offset:18688
    v_mfma_f32_16x16x32_bf16 v[60:63], v[136:139], v[108:111], v[60:63]
    s_add_u32 s36, s28, 106496
    buffer_load_dwordx4 v[176:179], v12, s[12:15], s36 offen sc1
    s_waitcnt vmcnt(9)
    v_mfma_f32_16x16x32_bf16 v[64:67], v[140:143], v[96:99], v[64:67]
    ds_read_b64_tr_b16 v[124:125], v9 offset:16640
    v_mfma_f32_16x16x32_bf16 v[68:71], v[140:143], v[100:103], v[68:71]
    v_mfma_f32_16x16x32_bf16 v[72:75], v[140:143], v[104:107], v[72:75]
    ds_read_b64_tr_b16 v[126:127], v9 offset:18688
    v_mfma_f32_16x16x32_bf16 v[76:79], v[140:143], v[108:111], v[76:79]
    s_add_u32 s36, s28, 155648
    buffer_load_dwordx4 v[180:183], v12, s[12:15], s36 offen sc1
    s_waitcnt vmcnt(9)
    v_mfma_f32_16x16x32_bf16 v[80:83], v[144:147], v[96:99], v[80:83]
    v_mfma_f32_16x16x32_bf16 v[84:87], v[144:147], v[100:103], v[84:87]
    v_mfma_f32_16x16x32_bf16 v[88:91], v[144:147], v[104:107], v[88:91]
    v_mfma_f32_16x16x32_bf16 v[92:95], v[144:147], v[108:111], v[92:95]
    s_add_u32 s36, s28, 204800
    buffer_load_dwordx4 v[184:187], v12, s[12:15], s36 offen sc1
    s_waitcnt lgkmcnt(0)
    s_waitcnt vmcnt(9)
    v_mfma_f32_16x16x32_bf16 v[16:19], v[148:151], v[112:115], v[16:19]
    ds_read_b64_tr_b16 v[96:97], v6 offset:32768
    v_mfma_f32_16x16x32_bf16 v[20:23], v[148:151], v[116:119], v[20:23]
    v_mfma_f32_16x16x32_bf16 v[24:27], v[148:151], v[120:123], v[24:27]
    ds_read_b64_tr_b16 v[98:99], v6 offset:34816
    v_mfma_f32_16x16x32_bf16 v[28:31], v[148:151], v[124:127], v[28:31]
    s_add_u32 s36, s28, 12288
    buffer_load_dwordx4 v[188:191], v12, s[12:15], s36 offen sc1
    s_waitcnt vmcnt(9)
    v_mfma_f32_16x16x32_bf16 v[32:35], v[152:155], v[112:115], v[32:35]
    ds_read_b64_tr_b16 v[100:101], v9 offset:32768
    v_mfma_f32_16x16x32_bf16 v[36:39], v[152:155], v[116:119], v[36:39]
    v_mfma_f32_16x16x32_bf16 v[40:43], v[152:155], v[120:123], v[40:43]
    ds_read_b64_tr_b16 v[102:103], v9 offset:34816
    v_mfma_f32_16x16x32_bf16 v[44:47], v[152:155], v[124:127], v[44:47]
    s_add_u32 s36, s28, 61440
    buffer_load_dwordx4 v[192:195], v12, s[12:15], s36 offen sc1
    s_waitcnt vmcnt(9)
    v_mfma_f32_16x16x32_bf16 v[48:51], v[156:159], v[112:115], v[48:51]
    ds_read_b64_tr_b16 v[104:105], v6 offset:33024
    v_mfma_f32_16x16x32_bf16 v[52:55], v[156:159], v[116:119], v[52:55]
    v_mfma_f32_16x16x32_bf16 v[56:59], v[156:159], v[120:123], v[56:59]
    ds_read_b64_tr_b16 v[106:107], v6 offset:35072
    v_mfma_f32_16x16x32_bf16 v[60:63], v[156:159], v[124:127], v[60:63]
    s_add_u32 s36, s28, 110592
    buffer_load_dwordx4 v[196:199], v12, s[12:15], s36 offen sc1
    s_waitcnt vmcnt(9)
    v_mfma_f32_16x16x32_bf16 v[64:67], v[160:163], v[112:115], v[64:67]
    ds_read_b64_tr_b16 v[108:109], v9 offset:33024
    v_mfma_f32_16x16x32_bf16 v[68:71], v[160:163], v[116:119], v[68:71]
    v_mfma_f32_16x16x32_bf16 v[72:75], v[160:163], v[120:123], v[72:75]
    ds_read_b64_tr_b16 v[110:111], v9 offset:35072
    v_mfma_f32_16x16x32_bf16 v[76:79], v[160:163], v[124:127], v[76:79]
    s_add_u32 s36, s28, 159744
    buffer_load_dwordx4 v[200:203], v12, s[12:15], s36 offen sc1
    s_waitcnt vmcnt(9)
    v_mfma_f32_16x16x32_bf16 v[80:83], v[164:167], v[112:115], v[80:83]
    v_mfma_f32_16x16x32_bf16 v[84:87], v[164:167], v[116:119], v[84:87]
    v_mfma_f32_16x16x32_bf16 v[88:91], v[164:167], v[120:123], v[88:91]
    v_mfma_f32_16x16x32_bf16 v[92:95], v[164:167], v[124:127], v[92:95]
    s_add_u32 s36, s28, 208896
    buffer_load_dwordx4 v[204:207], v12, s[12:15], s36 offen sc1
    s_waitcnt lgkmcnt(0)
    s_barrier
    s_waitcnt vmcnt(9)
    v_mfma_f32_16x16x32_bf16 v[16:19], v[168:171], v[96:99], v[16:19]
    ds_read_b64_tr_b16 v[112:113], v6 offset:49152
    v_mfma_f32_16x16x32_bf16 v[20:23], v[168:171], v[100:103], v[20:23]
    v_mfma_f32_16x16x32_bf16 v[24:27], v[168:171], v[104:107], v[24:27]
    ds_read_b64_tr_b16 v[114:115], v6 offset:51200
    v_mfma_f32_16x16x32_bf16 v[28:31], v[168:171], v[108:111], v[28:31]
    s_add_u32 s36, s28, 16384
    buffer_load_dwordx4 v[208:211], v12, s[12:15], s36 offen sc1
    s_waitcnt vmcnt(9)
    v_mfma_f32_16x16x32_bf16 v[32:35], v[172:175], v[96:99], v[32:35]
    ds_read_b64_tr_b16 v[116:117], v9 offset:49152
    v_mfma_f32_16x16x32_bf16 v[36:39], v[172:175], v[100:103], v[36:39]
    v_mfma_f32_16x16x32_bf16 v[40:43], v[172:175], v[104:107], v[40:43]
    ds_read_b64_tr_b16 v[118:119], v9 offset:51200
    v_mfma_f32_16x16x32_bf16 v[44:47], v[172:175], v[108:111], v[44:47]
    s_add_u32 s36, s28, 65536
    buffer_load_dwordx4 v[212:215], v12, s[12:15], s36 offen sc1
    s_waitcnt vmcnt(9)
    v_mfma_f32_16x16x32_bf16 v[48:51], v[176:179], v[96:99], v[48:51]
    ds_read_b64_tr_b16 v[120:121], v6 offset:49408
    v_mfma_f32_16x16x32_bf16 v[52:55], v[176:179], v[100:103], v[52:55]
    v_mfma_f32_16x16x32_bf16 v[56:59], v[176:179], v[104:107], v[56:59]
    ds_read_b64_tr_b16 v[122:123], v6 offset:51456
    v_mfma_f32_16x16x32_bf16 v[60:63], v[176:179], v[108:111], v[60:63]
    s_add_u32 s36, s28, 114688
    buffer_load_dwordx4 v[216:219], v12, s[12:15], s36 offen sc1
    s_waitcnt vmcnt(9)
    v_mfma_f32_16x16x32_bf16 v[64:67], v[180:183], v[96:99], v[64:67]
    ds_read_b64_tr_b16 v[124:125], v9 offset:49408
    v_mfma_f32_16x16x32_bf16 v[68:71], v[180:183], v[100:103], v[68:71]
    v_mfma_f32_16x16x32_bf16 v[72:75], v[180:183], v[104:107], v[72:75]
    ds_read_b64_tr_b16 v[126:127], v9 offset:51456
    v_mfma_f32_16x16x32_bf16 v[76:79], v[180:183], v[108:111], v[76:79]
    s_add_u32 s36, s28, 163840
    buffer_load_dwordx4 v[220:223], v12, s[12:15], s36 offen sc1
    s_waitcnt vmcnt(9)
    v_mfma_f32_16x16x32_bf16 v[80:83], v[184:187], v[96:99], v[80:83]
    v_mfma_f32_16x16x32_bf16 v[84:87], v[184:187], v[100:103], v[84:87]
    v_mfma_f32_16x16x32_bf16 v[88:91], v[184:187], v[104:107], v[88:91]
    v_mfma_f32_16x16x32_bf16 v[92:95], v[184:187], v[108:111], v[92:95]
    s_add_u32 s36, s28, 212992
    buffer_load_dwordx4 v[224:227], v12, s[12:15], s36 offen sc1
    s_waitcnt lgkmcnt(0)
    s_waitcnt vmcnt(9)
    v_mfma_f32_16x16x32_bf16 v[16:19], v[188:191], v[112:115], v[16:19]
    ds_read_b64_tr_b16 v[96:97], v7 offset:0
    v_mfma_f32_16x16x32_bf16 v[20:23], v[188:191], v[116:119], v[20:23]
    v_mfma_f32_16x16x32_bf16 v[24:27], v[188:191], v[120:123], v[24:27]
    ds_read_b64_tr_b16 v[98:99], v7 offset:2048
    v_mfma_f32_16x16x32_bf16 v[28:31], v[188:191], v[124:127], v[28:31]
    s_add_u32 s36, s28, 20480
    buffer_load_dwordx4 v[128:131], v12, s[12:15], s36 offen sc1
    s_waitcnt vmcnt(9)
    v_mfma_f32_16x16x32_bf16 v[32:35], v[192:195], v[112:115], v[32:35]
    ds_read_b64_tr_b16 v[100:101], v10 offset:0
    v_mfma_f32_16x16x32_bf16 v[36:39], v[192:195], v[116:119], v[36:39]
    v_mfma_f32_16x16x32_bf16 v[40:43], v[192:195], v[120:123], v[40:43]
    ds_read_b64_tr_b16 v[102:103], v10 offset:2048
    v_mfma_f32_16x16x32_bf16 v[44:47], v[192:195], v[124:127], v[44:47]
    s_add_u32 s36, s28, 69632
    buffer_load_dwordx4 v[132:135], v12, s[12:15], s36 offen sc1
    s_waitcnt vmcnt(9)
    v_mfma_f32_16x16x32_bf16 v[48:51], v[196:199], v[112:115], v[48:51]
    ds_read_b64_tr_b16 v[104:105], v7 offset:256
    v_mfma_f32_16x16x32_bf16 v[52:55], v[196:199], v[116:119], v[52:55]
    v_mfma_f32_16x16x32_bf16 v[56:59], v[196:199], v[120:123], v[56:59]
    ds_read_b64_tr_b16 v[106:107], v7 offset:2304
    v_mfma_f32_16x16x32_bf16 v[60:63], v[196:199], v[124:127], v[60:63]
    s_add_u32 s36, s28, 118784
    buffer_load_dwordx4 v[136:139], v12, s[12:15], s36 offen sc1
    s_waitcnt vmcnt(9)
    v_mfma_f32_16x16x32_bf16 v[64:67], v[200:203], v[112:115], v[64:67]
    ds_read_b64_tr_b16 v[108:109], v10 offset:256
    v_mfma_f32_16x16x32_bf16 v[68:71], v[200:203], v[116:119], v[68:71]
    v_mfma_f32_16x16x32_bf16 v[72:75], v[200:203], v[120:123], v[72:75]
    ds_read_b64_tr_b16 v[110:111], v10 offset:2304
    v_mfma_f32_16x16x32_bf16 v[76:79], v[200:203], v[124:127], v[76:79]
    s_add_u32 s36, s28, 167936
    buffer_load_dwordx4 v[140:143], v12, s[12:15], s36 offen sc1
    s_waitcnt vmcnt(9)
    v_mfma_f32_16x16x32_bf16 v[80:83], v[204:207], v[112:115], v[80:83]
    v_mfma_f32_16x16x32_bf16 v[84:87], v[204:207], v[116:119], v[84:87]
    v_mfma_f32_16x16x32_bf16 v[88:91], v[204:207], v[120:123], v[88:91]
    v_mfma_f32_16x16x32_bf16 v[92:95], v[204:207], v[124:127], v[92:95]
    s_add_u32 s36, s28, 217088
    buffer_load_dwordx4 v[144:147], v12, s[12:15], s36 offen sc1
    s_waitcnt lgkmcnt(0)
    s_waitcnt vmcnt(9)
    v_mfma_f32_16x16x32_bf16 v[16:19], v[208:211], v[96:99], v[16:19]
    ds_read_b64_tr_b16 v[112:113], v7 offset:16384
    v_mfma_f32_16x16x32_bf16 v[20:23], v[208:211], v[100:103], v[20:23]
    v_mfma_f32_16x16x32_bf16 v[24:27], v[208:211], v[104:107], v[24:27]
    ds_read_b64_tr_b16 v[114:115], v7 offset:18432
    v_mfma_f32_16x16x32_bf16 v[28:31], v[208:211], v[108:111], v[28:31]
    s_add_u32 s36, s28, 24576
    buffer_load_dwordx4 v[148:151], v12, s[12:15], s36 offen sc1
    s_waitcnt vmcnt(9)
    v_mfma_f32_16x16x32_bf16 v[32:35], v[212:215], v[96:99], v[32:35]
    ds_read_b64_tr_b16 v[116:117], v10 offset:16384
    v_mfma_f32_16x16x32_bf16 v[36:39], v[212:215], v[100:103], v[36:39]
    v_mfma_f32_16x16x32_bf16 v[40:43], v[212:215], v[104:107], v[40:43]
    ds_read_b64_tr_b16 v[118:119], v10 offset:18432
    v_mfma_f32_16x16x32_bf16 v[44:47], v[212:215], v[108:111], v[44:47]
    s_add_u32 s36, s28, 73728
    buffer_load_dwordx4 v[152:155], v12, s[12:15], s36 offen sc1
    s_waitcnt vmcnt(9)
    v_mfma_f32_16x16x32_bf16 v[48:51], v[216:219], v[96:99], v[48:51]
    ds_read_b64_tr_b16 v[120:121], v7 offset:16640
    v_mfma_f32_16x16x32_bf16 v[52:55], v[216:219], v[100:103], v[52:55]
    v_mfma_f32_16x16x32_bf16 v[56:59], v[216:219], v[104:107], v[56:59]
    ds_read_b64_tr_b16 v[122:123], v7 offset:18688
    v_mfma_f32_16x16x32_bf16 v[60:63], v[216:219], v[108:111], v[60:63]
    s_add_u32 s36, s28, 122880
    buffer_load_dwordx4 v[156:159], v12, s[12:15], s36 offen sc1
    s_waitcnt vmcnt(9)
    v_mfma_f32_16x16x32_bf16 v[64:67], v[220:223], v[96:99], v[64:67]
    ds_read_b64_tr_b16 v[124:125], v10 offset:16640
    v_mfma_f32_16x16x32_bf16 v[68:71], v[220:223], v[100:103], v[68:71]
    v_mfma_f32_16x16x32_bf16 v[72:75], v[220:223], v[104:107], v[72:75]
    ds_read_b64_tr_b16 v[126:127], v10 offset:18688
    v_mfma_f32_16x16x32_bf16 v[76:79], v[220:223], v[108:111], v[76:79]
    s_add_u32 s36, s28, 172032
    buffer_load_dwordx4 v[160:163], v12, s[12:15], s36 offen sc1
    s_waitcnt vmcnt(9)
    v_mfma_f32_16x16x32_bf16 v[80:83], v[224:227], v[96:99], v[80:83]
    v_mfma_f32_16x16x32_bf16 v[84:87], v[224:227], v[100:103], v[84:87]
    v_mfma_f32_16x16x32_bf16 v[88:91], v[224:227], v[104:107], v[88:91]
    v_mfma_f32_16x16x32_bf16 v[92:95], v[224:227], v[108:111], v[92:95]
    s_add_u32 s36, s28, 221184
    buffer_load_dwordx4 v[164:167], v12, s[12:15], s36 offen sc1
    s_waitcnt lgkmcnt(0)
    s_barrier
    s_waitcnt vmcnt(9)
    v_mfma_f32_16x16x32_bf16 v[16:19], v[128:131], v[112:115], v[16:19]
    ds_read_b64_tr_b16 v[96:97], v7 offset:32768
    v_mfma_f32_16x16x32_bf16 v[20:23], v[128:131], v[116:119], v[20:23]
    v_mfma_f32_16x16x32_bf16 v[24:27], v[128:131], v[120:123], v[24:27]
    ds_read_b64_tr_b16 v[98:99], v7 offset:34816
    v_mfma_f32_16x16x32_bf16 v[28:31], v[128:131], v[124:127], v[28:31]
    s_add_u32 s36, s28, 28672
    buffer_load_dwordx4 v[168:171], v12, s[12:15], s36 offen sc1
    s_waitcnt vmcnt(9)
    v_mfma_f32_16x16x32_bf16 v[32:35], v[132:135], v[112:115], v[32:35]
    ds_read_b64_tr_b16 v[100:101], v10 offset:32768
    v_mfma_f32_16x16x32_bf16 v[36:39], v[132:135], v[116:119], v[36:39]
    v_mfma_f32_16x16x32_bf16 v[40:43], v[132:135], v[120:123], v[40:43]
    ds_read_b64_tr_b16 v[102:103], v10 offset:34816
    v_mfma_f32_16x16x32_bf16 v[44:47], v[132:135], v[124:127], v[44:47]
    s_add_u32 s36, s28, 77824
    buffer_load_dwordx4 v[172:175], v12, s[12:15], s36 offen sc1
    s_waitcnt vmcnt(9)
    v_mfma_f32_16x16x32_bf16 v[48:51], v[136:139], v[112:115], v[48:51]
    ds_read_b64_tr_b16 v[104:105], v7 offset:33024
    v_mfma_f32_16x16x32_bf16 v[52:55], v[136:139], v[116:119], v[52:55]
    v_mfma_f32_16x16x32_bf16 v[56:59], v[136:139], v[120:123], v[56:59]
    ds_read_b64_tr_b16 v[106:107], v7 offset:35072
    v_mfma_f32_16x16x32_bf16 v[60:63], v[136:139], v[124:127], v[60:63]
    s_add_u32 s36, s28, 126976
    buffer_load_dwordx4 v[176:179], v12, s[12:15], s36 offen sc1
    s_waitcnt vmcnt(9)
    v_mfma_f32_16x16x32_bf16 v[64:67], v[140:143], v[112:115], v[64:67]
    ds_read_b64_tr_b16 v[108:109], v10 offset:33024
    v_mfma_f32_16x16x32_bf16 v[68:71], v[140:143], v[116:119], v[68:71]
    v_mfma_f32_16x16x32_bf16 v[72:75], v[140:143], v[120:123], v[72:75]
    ds_read_b64_tr_b16 v[110:111], v10 offset:35072
    v_mfma_f32_16x16x32_bf16 v[76:79], v[140:143], v[124:127], v[76:79]
    s_add_u32 s36, s28, 176128
    buffer_load_dwordx4 v[180:183], v12, s[12:15], s36 offen sc1
    s_waitcnt vmcnt(9)
    v_mfma_f32_16x16x32_bf16 v[80:83], v[144:147], v[112:115], v[80:83]
    v_mfma_f32_16x16x32_bf16 v[84:87], v[144:147], v[116:119], v[84:87]
    v_mfma_f32_16x16x32_bf16 v[88:91], v[144:147], v[120:123], v[88:91]
    v_mfma_f32_16x16x32_bf16 v[92:95], v[144:147], v[124:127], v[92:95]
    s_add_u32 s36, s28, 225280
    buffer_load_dwordx4 v[184:187], v12, s[12:15], s36 offen sc1
    s_waitcnt lgkmcnt(0)
    s_waitcnt vmcnt(9)
    v_mfma_f32_16x16x32_bf16 v[16:19], v[148:151], v[96:99], v[16:19]
    ds_read_b64_tr_b16 v[112:113], v7 offset:49152
    v_mfma_f32_16x16x32_bf16 v[20:23], v[148:151], v[100:103], v[20:23]
    v_mfma_f32_16x16x32_bf16 v[24:27], v[148:151], v[104:107], v[24:27]
    ds_read_b64_tr_b16 v[114:115], v7 offset:51200
    v_mfma_f32_16x16x32_bf16 v[28:31], v[148:151], v[108:111], v[28:31]
    s_add_u32 s36, s28, 32768
    buffer_load_dwordx4 v[188:191], v12, s[12:15], s36 offen sc1
    s_waitcnt vmcnt(9)
    v_mfma_f32_16x16x32_bf16 v[32:35], v[152:155], v[96:99], v[32:35]
    ds_read_b64_tr_b16 v[116:117], v10 offset:49152
    v_mfma_f32_16x16x32_bf16 v[36:39], v[152:155], v[100:103], v[36:39]
    v_mfma_f32_16x16x32_bf16 v[40:43], v[152:155], v[104:107], v[40:43]
    ds_read_b64_tr_b16 v[118:119], v10 offset:51200
    v_mfma_f32_16x16x32_bf16 v[44:47], v[152:155], v[108:111], v[44:47]
    s_add_u32 s36, s28, 81920
    buffer_load_dwordx4 v[192:195], v12, s[12:15], s36 offen sc1
    s_waitcnt vmcnt(9)
    v_mfma_f32_16x16x32_bf16 v[48:51], v[156:159], v[96:99], v[48:51]
    ds_read_b64_tr_b16 v[120:121], v7 offset:49408
    v_mfma_f32_16x16x32_bf16 v[52:55], v[156:159], v[100:103], v[52:55]
    v_mfma_f32_16x16x32_bf16 v[56:59], v[156:159], v[104:107], v[56:59]
    ds_read_b64_tr_b16 v[122:123], v7 offset:51456
    v_mfma_f32_16x16x32_bf16 v[60:63], v[156:159], v[108:111], v[60:63]
    s_add_u32 s36, s28, 131072
    buffer_load_dwordx4 v[196:199], v12, s[12:15], s36 offen sc1
    s_waitcnt vmcnt(9)
    v_mfma_f32_16x16x32_bf16 v[64:67], v[160:163], v[96:99], v[64:67]
    ds_read_b64_tr_b16 v[124:125], v10 offset:49408
    v_mfma_f32_16x16x32_bf16 v[68:71], v[160:163], v[100:103], v[68:71]
    v_mfma_f32_16x16x32_bf16 v[72:75], v[160:163], v[104:107], v[72:75]
    ds_read_b64_tr_b16 v[126:127], v10 offset:51456
    v_mfma_f32_16x16x32_bf16 v[76:79], v[160:163], v[108:111], v[76:79]
    s_add_u32 s36, s28, 180224
    buffer_load_dwordx4 v[200:203], v12, s[12:15], s36 offen sc1
    s_waitcnt vmcnt(9)
    v_mfma_f32_16x16x32_bf16 v[80:83], v[164:167], v[96:99], v[80:83]
    v_mfma_f32_16x16x32_bf16 v[84:87], v[164:167], v[100:103], v[84:87]
    v_mfma_f32_16x16x32_bf16 v[88:91], v[164:167], v[104:107], v[88:91]
    v_mfma_f32_16x16x32_bf16 v[92:95], v[164:167], v[108:111], v[92:95]
    s_add_u32 s36, s28, 229376
    buffer_load_dwordx4 v[204:207], v12, s[12:15], s36 offen sc1
    s_waitcnt lgkmcnt(0)
    s_waitcnt vmcnt(9)
    v_mfma_f32_16x16x32_bf16 v[16:19], v[168:171], v[112:115], v[16:19]
    ds_read_b64_tr_b16 v[96:97], v8 offset:0
    v_mfma_f32_16x16x32_bf16 v[20:23], v[168:171], v[116:119], v[20:23]
    v_mfma_f32_16x16x32_bf16 v[24:27], v[168:171], v[120:123], v[24:27]
    ds_read_b64_tr_b16 v[98:99], v8 offset:2048
    v_mfma_f32_16x16x32_bf16 v[28:31], v[168:171], v[124:127], v[28:31]
    s_add_u32 s36, s28, 36864
    buffer_load_dwordx4 v[208:211], v12, s[12:15], s36 offen sc1
    s_waitcnt vmcnt(9)
    v_mfma_f32_16x16x32_bf16 v[32:35], v[172:175], v[112:115], v[32:35]
    ds_read_b64_tr_b16 v[100:101], v11 offset:0
    v_mfma_f32_16x16x32_bf16 v[36:39], v[172:175], v[116:119], v[36:39]
    v_mfma_f32_16x16x32_bf16 v[40:43], v[172:175], v[120:123], v[40:43]
    ds_read_b64_tr_b16 v[102:103], v11 offset:2048
    v_mfma_f32_16x16x32_bf16 v[44:47], v[172:175], v[124:127], v[44:47]
    s_add_u32 s36, s28, 86016
    buffer_load_dwordx4 v[212:215], v12, s[12:15], s36 offen sc1
    s_waitcnt vmcnt(9)
    v_mfma_f32_16x16x32_bf16 v[48:51], v[176:179], v[112:115], v[48:51]
    ds_read_b64_tr_b16 v[104:105], v8 offset:256
    v_mfma_f32_16x16x32_bf16 v[52:55], v[176:179], v[116:119], v[52:55]
    v_mfma_f32_16x16x32_bf16 v[56:59], v[176:179], v[120:123], v[56:59]
    ds_read_b64_tr_b16 v[106:107], v8 offset:2304
    v_mfma_f32_16x16x32_bf16 v[60:63], v[176:179], v[124:127], v[60:63]
    s_add_u32 s36, s28, 135168
    buffer_load_dwordx4 v[216:219], v12, s[12:15], s36 offen sc1
    s_waitcnt vmcnt(9)
    v_mfma_f32_16x16x32_bf16 v[64:67], v[180:183], v[112:115], v[64:67]
    ds_read_b64_tr_b16 v[108:109], v11 offset:256
    v_mfma_f32_16x16x32_bf16 v[68:71], v[180:183], v[116:119], v[68:71]
    v_mfma_f32_16x16x32_bf16 v[72:75], v[180:183], v[120:123], v[72:75]
    ds_read_b64_tr_b16 v[110:111], v11 offset:2304
    v_mfma_f32_16x16x32_bf16 v[76:79], v[180:183], v[124:127], v[76:79]
    s_add_u32 s36, s28, 184320
    buffer_load_dwordx4 v[220:223], v12, s[12:15], s36 offen sc1
    s_waitcnt vmcnt(9)
    v_mfma_f32_16x16x32_bf16 v[80:83], v[184:187], v[112:115], v[80:83]
    v_mfma_f32_16x16x32_bf16 v[84:87], v[184:187], v[116:119], v[84:87]
    v_mfma_f32_16x16x32_bf16 v[88:91], v[184:187], v[120:123], v[88:91]
    v_mfma_f32_16x16x32_bf16 v[92:95], v[184:187], v[124:127], v[92:95]
    s_add_u32 s36, s28, 233472
    buffer_load_dwordx4 v[224:227], v12, s[12:15], s36 offen sc1
    s_waitcnt lgkmcnt(0)
    s_barrier
    s_waitcnt vmcnt(9)
    v_mfma_f32_16x16x32_bf16 v[16:19], v[188:191], v[96:99], v[16:19]
    ds_read_b64_tr_b16 v[112:113], v6 offset:0
    v_mfma_f32_16x16x32_bf16 v[20:23], v[188:191], v[100:103], v[20:23]
    v_mfma_f32_16x16x32_bf16 v[24:27], v[188:191], v[104:107], v[24:27]
    ds_read_b64_tr_b16 v[114:115], v6 offset:2048
    v_mfma_f32_16x16x32_bf16 v[28:31], v[188:191], v[108:111], v[28:31]
    s_add_u32 s36, s28, 40960
    buffer_load_dwordx4 v[128:131], v12, s[12:15], s36 offen sc1
    s_waitcnt vmcnt(9)
    v_mfma_f32_16x16x32_bf16 v[32:35], v[192:195], v[96:99], v[32:35]
    ds_read_b64_tr_b16 v[116:117], v9 offset:0
    v_mfma_f32_16x16x32_bf16 v[36:39], v[192:195], v[100:103], v[36:39]
    v_mfma_f32_16x16x32_bf16 v[40:43], v[192:195], v[104:107], v[40:43]
    ds_read_b64_tr_b16 v[118:119], v9 offset:2048
    v_mfma_f32_16x16x32_bf16 v[44:47], v[192:195], v[108:111], v[44:47]
    s_add_u32 s36, s28, 90112
    buffer_load_dwordx4 v[132:135], v12, s[12:15], s36 offen sc1
    s_waitcnt vmcnt(9)
    v_mfma_f32_16x16x32_bf16 v[48:51], v[196:199], v[96:99], v[48:51]
    ds_read_b64_tr_b16 v[120:121], v6 offset:256
    v_mfma_f32_16x16x32_bf16 v[52:55], v[196:199], v[100:103], v[52:55]
    v_mfma_f32_16x16x32_bf16 v[56:59], v[196:199], v[104:107], v[56:59]
    ds_read_b64_tr_b16 v[122:123], v6 offset:2304
    v_mfma_f32_16x16x32_bf16 v[60:63], v[196:199], v[108:111], v[60:63]
    s_add_u32 s36, s28, 139264
    buffer_load_dwordx4 v[136:139], v12, s[12:15], s36 offen sc1
    s_waitcnt vmcnt(9)
    v_mfma_f32_16x16x32_bf16 v[64:67], v[200:203], v[96:99], v[64:67]
    ds_read_b64_tr_b16 v[124:125], v9 offset:256
    v_mfma_f32_16x16x32_bf16 v[68:71], v[200:203], v[100:103], v[68:71]
    v_mfma_f32_16x16x32_bf16 v[72:75], v[200:203], v[104:107], v[72:75]
    ds_read_b64_tr_b16 v[126:127], v9 offset:2304
    v_mfma_f32_16x16x32_bf16 v[76:79], v[200:203], v[108:111], v[76:79]
    s_add_u32 s36, s28, 188416
    buffer_load_dwordx4 v[140:143], v12, s[12:15], s36 offen sc1
    s_waitcnt vmcnt(9)
    v_mfma_f32_16x16x32_bf16 v[80:83], v[204:207], v[96:99], v[80:83]
    v_mfma_f32_16x16x32_bf16 v[84:87], v[204:207], v[100:103], v[84:87]
    v_mfma_f32_16x16x32_bf16 v[88:91], v[204:207], v[104:107], v[88:91]
    v_mfma_f32_16x16x32_bf16 v[92:95], v[204:207], v[108:111], v[92:95]
    s_add_u32 s36, s28, 237568
    buffer_load_dwordx4 v[144:147], v12, s[12:15], s36 offen sc1
    s_waitcnt lgkmcnt(0)
    s_waitcnt vmcnt(9)
    v_mfma_f32_16x16x32_bf16 v[16:19], v[208:211], v[112:115], v[16:19]
    ds_read_b64_tr_b16 v[96:97], v6 offset:16384
    v_mfma_f32_16x16x32_bf16 v[20:23], v[208:211], v[116:119], v[20:23]
    v_mfma_f32_16x16x32_bf16 v[24:27], v[208:211], v[120:123], v[24:27]
    ds_read_b64_tr_b16 v[98:99], v6 offset:18432
    v_mfma_f32_16x16x32_bf16 v[28:31], v[208:211], v[124:127], v[28:31]
    s_add_u32 s36, s28, 45056
    buffer_load_dwordx4 v[148:151], v12, s[12:15], s36 offen sc1
    s_waitcnt vmcnt(9)
    v_mfma_f32_16x16x32_bf16 v[32:35], v[212:215], v[112:115], v[32:35]
    ds_read_b64_tr_b16 v[100:101], v9 offset:16384
    v_mfma_f32_16x16x32_bf16 v[36:39], v[212:215], v[116:119], v[36:39]
    v_mfma_f32_16x16x32_bf16 v[40:43], v[212:215], v[120:123], v[40:43]
    ds_read_b64_tr_b16 v[102:103], v9 offset:18432
    v_mfma_f32_16x16x32_bf16 v[44:47], v[212:215], v[124:127], v[44:47]
    s_add_u32 s36, s28, 94208
    buffer_load_dwordx4 v[152:155], v12, s[12:15], s36 offen sc1
    s_waitcnt vmcnt(9)
    v_mfma_f32_16x16x32_bf16 v[48:51], v[216:219], v[112:115], v[48:51]
    ds_read_b64_tr_b16 v[104:105], v6 offset:16640
    v_mfma_f32_16x16x32_bf16 v[52:55], v[216:219], v[116:119], v[52:55]
    v_mfma_f32_16x16x32_bf16 v[56:59], v[216:219], v[120:123], v[56:59]
    ds_read_b64_tr_b16 v[106:107], v6 offset:18688
    v_mfma_f32_16x16x32_bf16 v[60:63], v[216:219], v[124:127], v[60:63]
    s_add_u32 s36, s28, 143360
    buffer_load_dwordx4 v[156:159], v12, s[12:15], s36 offen sc1
    s_waitcnt vmcnt(9)
    v_mfma_f32_16x16x32_bf16 v[64:67], v[220:223], v[112:115], v[64:67]
    ds_read_b64_tr_b16 v[108:109], v9 offset:16640
    v_mfma_f32_16x16x32_bf16 v[68:71], v[220:223], v[116:119], v[68:71]
    v_mfma_f32_16x16x32_bf16 v[72:75], v[220:223], v[120:123], v[72:75]
    ds_read_b64_tr_b16 v[110:111], v9 offset:18688
    v_mfma_f32_16x16x32_bf16 v[76:79], v[220:223], v[124:127], v[76:79]
    s_add_u32 s36, s28, 192512
    buffer_load_dwordx4 v[160:163], v12, s[12:15], s36 offen sc1
    s_waitcnt vmcnt(9)
    v_mfma_f32_16x16x32_bf16 v[80:83], v[224:227], v[112:115], v[80:83]
    v_mfma_f32_16x16x32_bf16 v[84:87], v[224:227], v[116:119], v[84:87]
    v_mfma_f32_16x16x32_bf16 v[88:91], v[224:227], v[120:123], v[88:91]
    v_mfma_f32_16x16x32_bf16 v[92:95], v[224:227], v[124:127], v[92:95]
    s_add_u32 s36, s28, 241664
    buffer_load_dwordx4 v[164:167], v12, s[12:15], s36 offen sc1
    s_waitcnt lgkmcnt(0)
    s_waitcnt vmcnt(9)
    v_mfma_f32_16x16x32_bf16 v[16:19], v[128:131], v[96:99], v[16:19]
    ds_read_b64_tr_b16 v[112:113], v6 offset:32768
    v_mfma_f32_16x16x32_bf16 v[20:23], v[128:131], v[100:103], v[20:23]
    v_mfma_f32_16x16x32_bf16 v[24:27], v[128:131], v[104:107], v[24:27]
    ds_read_b64_tr_b16 v[114:115], v6 offset:34816
    v_mfma_f32_16x16x32_bf16 v[28:31], v[128:131], v[108:111], v[28:31]
    s_waitcnt vmcnt(8)
    v_mfma_f32_16x16x32_bf16 v[32:35], v[132:135], v[96:99], v[32:35]
    ds_read_b64_tr_b16 v[116:117], v9 offset:32768
    v_mfma_f32_16x16x32_bf16 v[36:39], v[132:135], v[100:103], v[36:39]
    v_mfma_f32_16x16x32_bf16 v[40:43], v[132:135], v[104:107], v[40:43]
    ds_read_b64_tr_b16 v[118:119], v9 offset:34816
    v_mfma_f32_16x16x32_bf16 v[44:47], v[132:135], v[108:111], v[44:47]
    s_waitcnt vmcnt(7)
    v_mfma_f32_16x16x32_bf16 v[48:51], v[136:139], v[96:99], v[48:51]
    ds_read_b64_tr_b16 v[120:121], v6 offset:33024
    v_mfma_f32_16x16x32_bf16 v[52:55], v[136:139], v[100:103], v[52:55]
    v_mfma_f32_16x16x32_bf16 v[56:59], v[136:139], v[104:107], v[56:59]
    ds_read_b64_tr_b16 v[122:123], v6 offset:35072
    v_mfma_f32_16x16x32_bf16 v[60:63], v[136:139], v[108:111], v[60:63]
    s_waitcnt vmcnt(6)
    v_mfma_f32_16x16x32_bf16 v[64:67], v[140:143], v[96:99], v[64:67]
    ds_read_b64_tr_b16 v[124:125], v9 offset:33024
    v_mfma_f32_16x16x32_bf16 v[68:71], v[140:143], v[100:103], v[68:71]
    v_mfma_f32_16x16x32_bf16 v[72:75], v[140:143], v[104:107], v[72:75]
    ds_read_b64_tr_b16 v[126:127], v9 offset:35072
    v_mfma_f32_16x16x32_bf16 v[76:79], v[140:143], v[108:111], v[76:79]
    s_waitcnt vmcnt(5)
    v_mfma_f32_16x16x32_bf16 v[80:83], v[144:147], v[96:99], v[80:83]
    v_mfma_f32_16x16x32_bf16 v[84:87], v[144:147], v[100:103], v[84:87]
    v_mfma_f32_16x16x32_bf16 v[88:91], v[144:147], v[104:107], v[88:91]
    v_mfma_f32_16x16x32_bf16 v[92:95], v[144:147], v[108:111], v[92:95]
    s_waitcnt lgkmcnt(0)
    s_waitcnt vmcnt(4)
    v_mfma_f32_16x16x32_bf16 v[16:19], v[148:151], v[112:115], v[16:19]
    v_mfma_f32_16x16x32_bf16 v[20:23], v[148:151], v[116:119], v[20:23]
    v_mfma_f32_16x16x32_bf16 v[24:27], v[148:151], v[120:123], v[24:27]
    v_mfma_f32_16x16x32_bf16 v[28:31], v[148:151], v[124:127], v[28:31]
    s_waitcnt vmcnt(3)
    v_mfma_f32_16x16x32_bf16 v[32:35], v[152:155], v[112:115], v[32:35]
    v_mfma_f32_16x16x32_bf16 v[36:39], v[152:155], v[116:119], v[36:39]
    v_mfma_f32_16x16x32_bf16 v[40:43], v[152:155], v[120:123], v[40:43]
    v_mfma_f32_16x16x32_bf16 v[44:47], v[152:155], v[124:127], v[44:47]
    s_waitcnt vmcnt(2)
    v_mfma_f32_16x16x32_bf16 v[48:51], v[156:159], v[112:115], v[48:51]
    ds_write_b128 v13, v[16:19] offset:0
    v_mfma_f32_16x16x32_bf16 v[52:55], v[156:159], v[116:119], v[52:55]
    ds_write_b128 v13, v[20:23] offset:5376
    v_mfma_f32_16x16x32_bf16 v[56:59], v[156:159], v[120:123], v[56:59]
    ds_write_b128 v13, v[24:27] offset:10752
    v_mfma_f32_16x16x32_bf16 v[60:63], v[156:159], v[124:127], v[60:63]
    ds_write_b128 v13, v[28:31] offset:16128
    s_waitcnt vmcnt(1)
    v_mfma_f32_16x16x32_bf16 v[64:67], v[160:163], v[112:115], v[64:67]
    ds_write_b128 v13, v[32:35] offset:64
    v_mfma_f32_16x16x32_bf16 v[68:71], v[160:163], v[116:119], v[68:71]
    ds_write_b128 v13, v[36:39] offset:5440
    v_mfma_f32_16x16x32_bf16 v[72:75], v[160:163], v[120:123], v[72:75]
    ds_write_b128 v13, v[40:43] offset:10816
    v_mfma_f32_16x16x32_bf16 v[76:79], v[160:163], v[124:127], v[76:79]
    ds_write_b128 v13, v[44:47] offset:16192
    s_waitcnt vmcnt(0)
    v_mfma_f32_16x16x32_bf16 v[80:83], v[164:167], v[112:115], v[80:83]
    ds_write_b128 v13, v[48:51] offset:128
    v_mfma_f32_16x16x32_bf16 v[84:87], v[164:167], v[116:119], v[84:87]
    ds_write_b128 v13, v[52:55] offset:5504
    v_mfma_f32_16x16x32_bf16 v[88:91], v[164:167], v[120:123], v[88:91]
    ds_write_b128 v13, v[56:59] offset:10880
    v_mfma_f32_16x16x32_bf16 v[92:95], v[164:167], v[124:127], v[92:95]
    ds_write_b128 v13, v[60:63] offset:16256
    ds_write_b128 v13, v[64:67] offset:192
    ds_write_b128 v13, v[68:71] offset:5568
    ds_write_b128 v13, v[72:75] offset:10944
    ds_write_b128 v13, v[76:79] offset:16320
    s_nop 3
    ds_write_b128 v13, v[80:83] offset:256
    ds_write_b128 v13, v[84:87] offset:5632
    ds_write_b128 v13, v[88:91] offset:11008
    ds_write_b128 v13, v[92:95] offset:16384
tl_ep2:
    s_add_u32 s36, s8, 15073280
    s_addc_u32 s37, s9, 0
    s_cmp_eq_u32 s3, 0
    s_cselect_b32 s10, s36, s10
    s_cselect_b32 s11, s37, s11
    s_mov_b32 s16, s10
    s_mov_b32 s17, s11
    s_mov_b32 s18, 2621440
    s_mov_b32 s19, 0x00020000
    s_mul_i32 s28, s38, 81920
    s_movk_i32 s36, 160
    s_cmp_eq_u32 s3, 0
    s_cselect_b32 s36, 5120, s36
    s_mul_i32 s36, s39, s36
    s_add_u32 s28, s28, s36
    v_mov_b32 v3, 0x3f803f80
    v_lshlrev_b32 v2, 3, v0
    v_add_u32 v2, 139264, v2
    ds_read_b128 v[212:215], v238
    ds_read_b128 v[216:219], v239
    s_waitcnt vmcnt(0) lgkmcnt(0)
    s_barrier
    ds_read_b128 v[180:183], v236
    ds_read_b128 v[184:187], v236 offset:16
    ds_read_b128 v[188:191], v236 offset:21504
    ds_read_b128 v[192:195], v236 offset:21520
    ds_read_b128 v[164:167], v236 offset:43008
    ds_read_b128 v[168:171], v236 offset:43024
    ds_read_b128 v[172:175], v236 offset:64512
    ds_read_b128 v[176:179], v236 offset:64528
    v_lshlrev_b32 v240, 16, v240
    v_lshlrev_b32 v196, 16, v212
    v_and_b32 v197, s45, v212
    v_lshlrev_b32 v198, 16, v213
    v_and_b32 v199, s45, v213
    v_lshlrev_b32 v200, 16, v214
    v_and_b32 v201, s45, v214
    v_lshlrev_b32 v202, 16, v215
    v_and_b32 v203, s45, v215
    v_pk_add_f32 v[196:197], v[196:197], v[240:241] op_sel:[0,0] op_sel_hi:[1,0]
    v_pk_add_f32 v[198:199], v[198:199], v[240:241] op_sel:[0,0] op_sel_hi:[1,0]
    v_pk_add_f32 v[200:201], v[200:201], v[240:241] op_sel:[0,0] op_sel_hi:[1,0]
    v_pk_add_f32 v[202:203], v[202:203], v[240:241] op_sel:[0,0] op_sel_hi:[1,0]
    s_waitcnt lgkmcnt(4)
    v_pk_add_f32 v[180:181], v[180:181], v[188:189]
    v_pk_add_f32 v[182:183], v[182:183], v[190:191]
    v_pk_add_f32 v[184:185], v[184:185], v[192:193]
    v_pk_add_f32 v[186:187], v[186:187], v[194:195]
    v_pk_add_f32 v[180:181], v[180:181], v[196:197]
    v_pk_add_f32 v[182:183], v[182:183], v[198:199]
    v_pk_add_f32 v[184:185], v[184:185], v[200:201]
    v_pk_add_f32 v[186:187], v[186:187], v[202:203]
    s_waitcnt lgkmcnt(0)
    v_pk_add_f32 v[164:165], v[164:165], v[172:173]
    v_pk_add_f32 v[166:167], v[166:167], v[174:175]
    v_pk_add_f32 v[168:169], v[168:169], v[176:177]
    v_pk_add_f32 v[170:171], v[170:171], v[178:179]
    v_pk_add_f32 v[180:181], v[180:181], v[164:165]
    v_pk_add_f32 v[182:183], v[182:183], v[166:167]
    v_pk_add_f32 v[184:185], v[184:185], v[168:169]
    v_pk_add_f32 v[186:187], v[186:187], v[170:171]
    v_cvt_pk_bf16_f32 v204, v180, v181
    v_cvt_pk_bf16_f32 v205, v182, v183
    v_cvt_pk_bf16_f32 v206, v184, v185
    v_cvt_pk_bf16_f32 v207, v186, v187
    s_cmp_eq_u32 s3, 0
    s_cbranch_scc1 tl_e0a
    buffer_store_dwordx4 v[204:207], v234, s[16:19], s28 offen nt
    s_branch tl_e0b
tl_e0a:
    buffer_store_dwordx4 v[204:207], v234, s[16:19], s28 offen sc1
    v_mov_b32 v188, 0
    v_mov_b32 v189, 0
    v_dot2c_f32_bf16 v188, v204, v3
    v_dot2c_f32_bf16 v189, v204, v204
    v_dot2c_f32_bf16 v188, v205, v3
    v_dot2c_f32_bf16 v189, v205, v205
    v_dot2c_f32_bf16 v188, v206, v3
    v_dot2c_f32_bf16 v189, v206, v206
    v_dot2c_f32_bf16 v188, v207, v3
    v_dot2c_f32_bf16 v189, v207, v207
    s_nop 2
    ds_write_b64 v2, v[188:189] offset:0
tl_e0b:
    s_cmp_ge_u32 s24, 4
    s_cbranch_scc1 tl_st
    ds_read_b128 v[180:183], v237
    ds_read_b128 v[184:187], v237 offset:16
    ds_read_b128 v[188:191], v237 offset:21504
    ds_read_b128 v[192:195], v237 offset:21520
    ds_read_b128 v[164:167], v237 offset:43008
    ds_read_b128 v[168:171], v237 offset:43024
    ds_read_b128 v[172:175], v237 offset:64512
    ds_read_b128 v[176:179], v237 offset:64528
    v_lshlrev_b32 v241, 16, v241
    v_lshlrev_b32 v148, 16, v216
    v_and_b32 v149, s45, v216
    v_lshlrev_b32 v150, 16, v217
    v_and_b32 v151, s45, v217
    v_lshlrev_b32 v152, 16, v218
    v_and_b32 v153, s45, v218
    v_lshlrev_b32 v154, 16, v219
    v_and_b32 v155, s45, v219
    v_pk_add_f32 v[148:149], v[148:149], v[240:241] op_sel:[0,1] op_sel_hi:[1,1]
    v_pk_add_f32 v[150:151], v[150:151], v[240:241] op_sel:[0,1] op_sel_hi:[1,1]
    v_pk_add_f32 v[152:153], v[152:153], v[240:241] op_sel:[0,1] op_sel_hi:[1,1]
    v_pk_add_f32 v[154:155], v[154:155], v[240:241] op_sel:[0,1] op_sel_hi:[1,1]
    s_waitcnt lgkmcnt(4)
    v_pk_add_f32 v[180:181], v[180:181], v[188:189]
    v_pk_add_f32 v[182:183], v[182:183], v[190:191]
    v_pk_add_f32 v[184:185], v[184:185], v[192:193]
    v_pk_add_f32 v[186:187], v[186:187], v[194:195]
    v_pk_add_f32 v[180:181], v[180:181], v[148:149]
    v_pk_add_f32 v[182:183], v[182:183], v[150:151]
    v_pk_add_f32 v[184:185], v[184:185], v[152:153]
    v_pk_add_f32 v[186:187], v[186:187], v[154:155]
    s_waitcnt lgkmcnt(0)
    v_pk_add_f32 v[164:165], v[164:165], v[172:173]
    v_pk_add_f32 v[166:167], v[166:167], v[174:175]
    v_pk_add_f32 v[168:169], v[168:169], v[176:177]
    v_pk_add_f32 v[170:171], v[170:171], v[178:179]
    v_pk_add_f32 v[180:181], v[180:181], v[164:165]
    v_pk_add_f32 v[182:183], v[182:183], v[166:167]
    v_pk_add_f32 v[184:185], v[184:185], v[168:169]
    v_pk_add_f32 v[186:187], v[186:187], v[170:171]
    v_cvt_pk_bf16_f32 v208, v180, v181
    v_cvt_pk_bf16_f32 v209, v182, v183
    v_cvt_pk_bf16_f32 v210, v184, v185
    v_cvt_pk_bf16_f32 v211, v186, v187
    s_cmp_eq_u32 s3, 0
    s_cbranch_scc1 tl_e1a
    buffer_store_dwordx4 v[208:211], v235, s[16:19], s28 offen nt
    s_branch tl_e1b
tl_e1a:
    buffer_store_dwordx4 v[208:211], v235, s[16:19], s28 offen sc1
    v_mov_b32 v188, 0
    v_mov_b32 v189, 0
    v_dot2c_f32_bf16 v188, v208, v3
    v_dot2c_f32_bf16 v189, v208, v208
    v_dot2c_f32_bf16 v188, v209, v3
    v_dot2c_f32_bf16 v189, v209, v209
    v_dot2c_f32_bf16 v188, v210, v3
    v_dot2c_f32_bf16 v189, v210, v210
    v_dot2c_f32_bf16 v188, v211, v3
    v_dot2c_f32_bf16 v189, v211, v211
    s_nop 2
    ds_write_b64 v2, v[188:189] offset:3072
tl_e1b:
tl_st:
    s_cmp_lg_u32 s3, 0
    s_cbranch_scc1 tl_done
    s_lshr_b32 s28, s38, 1
    s_and_b32 s29, s38, 1
    s_lshl_b32 s29, s29, 3
    s_add_u32 s29, s29, s39
    s_mul_i32 s33, s28, 4096
    s_mul_i32 s37, s29, 32
    s_add_u32 s33, s33, s37
    s_add_u32 s33, s33, 20840448
    s_add_u32 s33, s33, s50
    s_waitcnt lgkmcnt(0)
    s_barrier
    v_mov_b32 v13, 1
    v_mov_b32 v12, 159816
    s_mov_b64 exec, 1
    s_waitcnt vmcnt(0)
    ds_add_rtn_u32 v12, v12, v13
    s_waitcnt lgkmcnt(0)
    v_readfirstlane_b32 s37, v12
    s_mov_b64 exec, -1
    s_nop 2
    s_cmp_lg_u32 s37, 5
    s_cbranch_scc1 L_sg_61
    v_mul_u32_u24 v12, 1024, v1
    s_mov_b64 exec, 0xf
    buffer_store_dword v13, v12, s[12:15], s33 offen sc1
    s_mov_b64 exec, -1
L_sg_61:
    s_cmp_lt_u32 s24, 4
    s_cbranch_scc1 tl_c_p4
    s_cmp_eq_u32 s24, 4
    s_cbranch_scc1 tl_s_p4
    v_lshlrev_b32 v2, 3, v1
    v_add_u32 v3, 139264, v2
    ds_read_b64 v[180:181], v3 offset:0
    ds_read_b64 v[182:183], v3 offset:512
    ds_read_b64 v[184:185], v3 offset:1024
    ds_read_b64 v[186:187], v3 offset:1536
    ds_read_b64 v[188:189], v3 offset:2048
    ds_read_b64 v[190:191], v3 offset:2560
    ds_read_b64 v[192:193], v3 offset:3072
    ds_read_b64 v[194:195], v3 offset:3584
    ds_read_b64 v[196:197], v3 offset:4096
    ds_read_b64 v[198:199], v3 offset:4608
    s_lshl_b32 s36, s38, 12
    s_lshl_b32 s37, s39, 9
    s_add_u32 s36, s36, s37
    s_add_u32 s36, s36, 20578304
    s_waitcnt lgkmcnt(0)
    v_add_f32 v180, v180, v182
    v_add_f32 v181, v181, v183
    v_add_f32 v180, v180, v184
    v_add_f32 v181, v181, v185
    v_add_f32 v180, v180, v186
    v_add_f32 v181, v181, v187
    v_add_f32 v180, v180, v188
    v_add_f32 v181, v181, v189
    v_add_f32 v180, v180, v190
    v_add_f32 v181, v181, v191
    v_add_f32 v180, v180, v192
    v_add_f32 v181, v181, v193
    v_add_f32 v180, v180, v194
    v_add_f32 v181, v181, v195
    v_add_f32 v180, v180, v196
    v_add_f32 v181, v181, v197
    v_add_f32 v180, v180, v198
    v_add_f32 v181, v181, v199
    v_and_b32 v181, 0x7fffffff, v181
    buffer_store_dwordx2 v[180:181], v2, s[12:15], s36 offen sc1
    s_cmp_eq_u32 s61, 15
    s_cbranch_scc1 tl_again
    v_add_u32 v2, 161792, v2
    ds_write_b64 v2, v[250:251]
    s_waitcnt lgkmcnt(0)
    s_barrier
    s_barrier
    s_barrier
    s_branch tl_again
tl_s_p4:
    s_cmp_lg_u32 s61, 15
    s_cbranch_scc1 tl_s_p4b
    v_mov_b32 v2, 159824
    v_mov_b32 v3, 4
    ds_write_b32 v2, v3
    s_branch tl_again
tl_s_p4b:
    v_lshlrev_b32 v6, 3, v1
    s_lshr_b32 s36, s2, 3
    s_and_b32 s36, s36, 3
    s_mul_i32 s36, s36, 1024
    s_add_u32 s30, s36, 20840448
    s_add_u32 s30, s30, s50
    s_mul_i32 s36, s60, 4096
    s_mul_i32 s37, s60, 4096
    v_mov_b32 v2, s36
    v_mov_b32 v3, s37
    v_cmp_gt_u32 vcc, 32, v1
    v_and_b32 v15, 31, v1
    v_min_u32 v15, 15, v15
    v_mul_u32_u24 v15, 32, v15
    v_cndmask_b32 v2, v3, v2, vcc
    v_add_u32 v2, v15, v2
    v_mov_b32 v15, 159816
    s_mov_b32 s35, 0
tl_px_own:
    ds_read_b32 v3, v15
    s_add_u32 s35, s35, 1
    s_waitcnt lgkmcnt(0)
    v_readfirstlane_b32 s36, v3
    s_cmp_gt_u32 s35, 524288
    s_cbranch_scc1 tl_px_ownx
    s_cmp_ge_u32 s36, 6
    s_cbranch_scc1 tl_px_ownx
    s_sleep 1
    s_branch tl_px_own
tl_px_ownx:
    s_sleep 20
tl_px_nod:
    s_mov_b32 s35, 0
    s_mov_b64 exec, 0xffff
tl_px_wait:
    buffer_load_dword v3, v2, s[12:15], s30 offen sc1
    s_add_u32 s35, s35, 1
    s_waitcnt vmcnt(0)
    v_cmp_eq_u32 vcc, 0, v3
    s_cmp_gt_u32 s35, 524288
    s_cbranch_scc1 tl_px_go
    s_and_b64 exec, exec, vcc
    s_cbranch_scc1 tl_px_wait
tl_px_go:
    s_mov_b64 exec, -1
    s_barrier
    s_lshl_b32 s31, s60, 13
    s_add_u32 s31, s31, 20578304
    s_add_u32 s32, s31, 4096
    s_mov_b32 s35, 0
tl_g2poll:
    buffer_load_dwordx2 v[8:9], v6, s[12:15], s31 offen offset:0 sc1
    buffer_load_dwordx2 v[10:11], v6, s[12:15], s31 offen offset:512 sc1
    buffer_load_dwordx2 v[12:13], v6, s[12:15], s31 offen offset:1024 sc1
    buffer_load_dwordx2 v[14:15], v6, s[12:15], s31 offen offset:1536 sc1
    buffer_load_dwordx2 v[16:17], v6, s[12:15], s31 offen offset:2048 sc1
    buffer_load_dwordx2 v[18:19], v6, s[12:15], s31 offen offset:2560 sc1
    buffer_load_dwordx2 v[20:21], v6, s[12:15], s31 offen offset:3072 sc1
    buffer_load_dwordx2 v[22:23], v6, s[12:15], s31 offen offset:3584 sc1
    buffer_load_dwordx2 v[24:25], v6, s[12:15], s32 offen offset:0 sc1
    buffer_load_dwordx2 v[26:27], v6, s[12:15], s32 offen offset:512 sc1
    buffer_load_dwordx2 v[28:29], v6, s[12:15], s32 offen offset:1024 sc1
    buffer_load_dwordx2 v[30:31], v6, s[12:15], s32 offen offset:1536 sc1
    buffer_load_dwordx2 v[32:33], v6, s[12:15], s32 offen offset:2048 sc1
    buffer_load_dwordx2 v[34:35], v6, s[12:15], s32 offen offset:2560 sc1
    buffer_load_dwordx2 v[36:37], v6, s[12:15], s32 offen offset:3072 sc1
    buffer_load_dwordx2 v[38:39], v6, s[12:15], s32 offen offset:3584 sc1
    s_add_u32 s35, s35, 1
    s_waitcnt vmcnt(0)
    v_max_u32 v2, v9, v11
    v_max3_u32 v2, v13, v15, v2
    v_max3_u32 v2, v17, v19, v2
    v_max3_u32 v2, v21, v23, v2
    v_max3_u32 v2, v25, v27, v2
    v_max3_u32 v2, v29, v31, v2
    v_max3_u32 v2, v33, v35, v2
    v_max3_u32 v2, v37, v39, v2
    v_cmp_eq_u32 vcc, -1, v2
    s_cmp_gt_u32 s35, 524288
    s_cbranch_scc1 tl_got2
    s_cmp_lg_u64 vcc, 0
    s_cbranch_scc1 tl_g2poll
tl_got2:
    s_cmp_lt_u32 s61, 5
    s_cselect_b32 s36, 0x3ea52b5c, 1.0
    v_lshlrev_b32 v7, 2, v1
    v_add_u32 v7, 160768, v7
    v_add_f32 v8, v8, v16
    v_add_f32 v9, v9, v17
    v_add_f32 v10, v10, v18
    v_add_f32 v11, v11, v19
    v_add_f32 v12, v12, v20
    v_add_f32 v13, v13, v21
    v_add_f32 v14, v14, v22
    v_add_f32 v15, v15, v23
    v_add_f32 v8, v8, v12
    v_add_f32 v9, v9, v13
    v_add_f32 v10, v10, v14
    v_add_f32 v11, v11, v15
    v_add_f32 v8, v8, v10
    v_add_f32 v9, v9, v11
    v_mul_f32 v8, 0x3acccccd, v8
    v_mul_f32 v9, 0x3acccccd, v9
    v_fma_f32 v9, -v8, v8, v9
    v_max_f32 v9, 0, v9
    v_add_f32 v9, 0x3727c5ac, v9
    v_rsq_f32 v9, v9
    s_nop 0
    v_mul_f32 v9, s36, v9
    ds_write_b32 v7, v9 offset:0
    ds_write_b32 v7, v8 offset:512
    v_add_f32 v24, v24, v32
    v_add_f32 v25, v25, v33
    v_add_f32 v26, v26, v34
    v_add_f32 v27, v27, v35
    v_add_f32 v28, v28, v36
    v_add_f32 v29, v29, v37
    v_add_f32 v30, v30, v38
    v_add_f32 v31, v31, v39
    v_add_f32 v24, v24, v28
    v_add_f32 v25, v25, v29
    v_add_f32 v26, v26, v30
    v_add_f32 v27, v27, v31
    v_add_f32 v24, v24, v26
    v_add_f32 v25, v25, v27
    v_mul_f32 v24, 0x3acccccd, v24
    v_mul_f32 v25, 0x3acccccd, v25
    v_fma_f32 v25, -v24, v24, v25
    v_max_f32 v25, 0, v25
    v_add_f32 v25, 0x3727c5ac, v25
    v_rsq_f32 v25, v25
    s_nop 0
    v_mul_f32 v25, s36, v25
    ds_write_b32 v7, v25 offset:256
    ds_write_b32 v7, v24 offset:768
    s_waitcnt lgkmcnt(0)
    s_barrier
    s_barrier
    s_branch tl_again
tl_c_p4:
    s_cmp_eq_u32 s61, 15
    s_cbranch_scc1 tl_again
    v_lshrrev_b32 v10, 5, v1
    v_and_b32 v11, 31, v1
    v_and_b32 v2, 3, v1
    v_lshlrev_b32 v2, 3, v2
    v_bfe_u32 v3, v1, 4, 1
    v_lshl_add_u32 v2, v3, 5, v2
    v_bfe_u32 v3, v1, 2, 2
    v_lshl_add_u32 v2, v3, 6, v2
    v_lshl_add_u32 v6, v10, 11, v2
    v_add_u32 v7, 65536, v6
    v_add_u32 v8, 131072, v6
    v_lshlrev_b32 v9, 4, v1
    s_lshl_b32 s41, s60, 2
    s_add_u32 s41, s41, s24
    s_mul_i32 s28, s41, 40960
    s_add_u32 s28, s28, 15073280
    v_mov_b32 v28, 0
    v_mov_b32 v29, 0
    v_mov_b32 v30, 0
    v_mov_b32 v31, 0
    v_mov_b32 v32, 0
    v_mov_b32 v33, 0
    v_mov_b32 v34, 0
    v_mov_b32 v35, 0
    v_mov_b32 v36, 0
    v_mov_b32 v37, 0
    v_mov_b32 v38, 0
    v_mov_b32 v39, 0
    v_mov_b32 v40, 0
    v_mov_b32 v41, 0
    v_mov_b32 v42, 0
    v_mov_b32 v43, 0
    v_mov_b32 v44, 0
    v_mov_b32 v45, 0
    v_mov_b32 v46, 0
    v_mov_b32 v47, 0
    v_mov_b32 v48, 0
    v_mov_b32 v49, 0
    v_mov_b32 v50, 0
    v_mov_b32 v51, 0
    v_mov_b32 v52, 0
    v_mov_b32 v53, 0
    v_mov_b32 v54, 0
    v_mov_b32 v55, 0
    v_mov_b32 v56, 0
    v_mov_b32 v57, 0
    v_mov_b32 v58, 0
    v_mov_b32 v59, 0
    v_mov_b32 v60, 0
    v_mov_b32 v61, 0
    v_mov_b32 v62, 0
    v_mov_b32 v63, 0
    v_mov_b32 v64, 0
    v_mov_b32 v65, 0
    v_mov_b32 v66, 0
    v_mov_b32 v67, 0
    v_mov_b32 v68, 0
    v_mov_b32 v69, 0
    v_mov_b32 v70, 0
    v_mov_b32 v71, 0
    v_mov_b32 v72, 0
    v_mov_b32 v73, 0
    v_mov_b32 v74, 0
    v_mov_b32 v75, 0
    v_mov_b32 v76, 0
    v_mov_b32 v77, 0
    v_mov_b32 v78, 0
    v_mov_b32 v79, 0
    v_mov_b32 v80, 0
    v_mov_b32 v81, 0
    v_mov_b32 v82, 0
    v_mov_b32 v83, 0
    v_mov_b32 v84, 0
    v_mov_b32 v85, 0
    v_mov_b32 v86, 0
    v_mov_b32 v87, 0
    v_mov_b32 v88, 0
    v_mov_b32 v89, 0
    v_mov_b32 v90, 0
    v_mov_b32 v91, 0
    s_cmp_ge_u32 s61, 10
    s_cbranch_scc1 tl_p4v
    s_cmp_lt_u32 s61, 5
    s_movk_i32 s42, 2560
    s_cselect_b32 s42, 1280, s42
    s_cselect_b32 s43, 0, 2621440
    s_cselect_b32 s36, 0, 5
    s_sub_u32 s36, s61, s36
    s_lshl_b32 s44, s36, 4
    s_mul_i32 s37, s41, s42
    s_add_u32 s43, s43, s37
    s_add_u32 s43, s43, 23068672
    s_lshl_b32 s42, s42, 6
    v_lshl_add_u32 v12, v10, 30, v9
    v_mul_lo_u32 v13, v10, s42
    v_lshl_add_u32 v13, v11, 3, v13
    s_lshl_b32 s36, s24, 7
    s_add_u32 s36, s36, 160768
    v_lshl_add_u32 v2, v11, 2, s36
    v_lshlrev_b32 v3, 4, v10
    v_add_u32 v3, 161792, v3
    s_barrier
    s_add_u32 s36, s28, 0
    buffer_load_dwordx4 v[140:143], v9, s[12:15], s36 offen sc1
    ds_read_b64_tr_b16 v[92:93], v6 offset:0
    ds_read_b64_tr_b16 v[94:95], v6 offset:512
    ds_read_b64_tr_b16 v[96:97], v6 offset:256
    ds_read_b64_tr_b16 v[98:99], v6 offset:768
    ds_read_b64_tr_b16 v[100:101], v6 offset:1024
    ds_read_b64_tr_b16 v[102:103], v6 offset:1536
    ds_read_b64_tr_b16 v[104:105], v6 offset:1280
    ds_read_b64_tr_b16 v[106:107], v6 offset:1792
    s_add_u32 s36, s28, 1024
    buffer_load_dwordx4 v[144:147], v9, s[12:15], s36 offen sc1
    ds_read_b64_tr_b16 v[108:109], v6 offset:4096
    ds_read_b64_tr_b16 v[110:111], v6 offset:4608
    ds_read_b64_tr_b16 v[112:113], v6 offset:4352
    ds_read_b64_tr_b16 v[114:115], v6 offset:4864
    ds_read_b64_tr_b16 v[116:117], v6 offset:5120
    ds_read_b64_tr_b16 v[118:119], v6 offset:5632
    ds_read_b64_tr_b16 v[120:121], v6 offset:5376
    ds_read_b64_tr_b16 v[122:123], v6 offset:5888
    s_add_u32 s36, s28, 2048
    buffer_load_dwordx4 v[148:151], v9, s[12:15], s36 offen sc1
    s_add_u32 s36, s28, 3072
    buffer_load_dwordx4 v[152:155], v9, s[12:15], s36 offen sc1
    s_add_u32 s36, s28, 4096
    buffer_load_dwordx4 v[156:159], v9, s[12:15], s36 offen sc1
    s_add_u32 s36, s28, 5120
    buffer_load_dwordx4 v[160:163], v9, s[12:15], s36 offen sc1
    s_add_u32 s36, s28, 6144
    buffer_load_dwordx4 v[164:167], v9, s[12:15], s36 offen sc1
    s_add_u32 s36, s28, 7168
    buffer_load_dwordx4 v[168:171], v9, s[12:15], s36 offen sc1
    s_waitcnt vmcnt(7) lgkmcnt(8)
    v_mfma_f32_32x32x16_bf16 v[28:43], v[92:95], v[140:143], v[28:43]
    s_add_u32 s36, s28, 8192
    buffer_load_dwordx4 v[172:175], v9, s[12:15], s36 offen sc1
    s_add_u32 s36, s28, 9216
    v_mfma_f32_32x32x16_bf16 v[44:59], v[96:99], v[140:143], v[44:59]
    buffer_load_dwordx4 v[176:179], v9, s[12:15], s36 offen sc1
    ds_read_b64_tr_b16 v[124:125], v6 offset:8192
    ds_read_b64_tr_b16 v[126:127], v6 offset:8704
    v_mfma_f32_32x32x16_bf16 v[60:75], v[100:103], v[140:143], v[60:75]
    ds_read_b64_tr_b16 v[128:129], v6 offset:8448
    ds_read_b64_tr_b16 v[130:131], v6 offset:8960
    ds_read_b64_tr_b16 v[132:133], v6 offset:9216
    v_mfma_f32_32x32x16_bf16 v[76:91], v[104:107], v[140:143], v[76:91]
    ds_read_b64_tr_b16 v[134:135], v6 offset:9728
    ds_read_b64_tr_b16 v[136:137], v6 offset:9472
    ds_read_b64_tr_b16 v[138:139], v6 offset:9984
    s_waitcnt vmcnt(8) lgkmcnt(8)
    v_mfma_f32_32x32x16_bf16 v[28:43], v[108:111], v[144:147], v[28:43]
    s_add_u32 s36, s28, 10240
    buffer_load_dwordx4 v[180:183], v9, s[12:15], s36 offen sc1
    s_add_u32 s36, s28, 11264
    v_mfma_f32_32x32x16_bf16 v[44:59], v[112:115], v[144:147], v[44:59]
    buffer_load_dwordx4 v[184:187], v9, s[12:15], s36 offen sc1
    ds_read_b64_tr_b16 v[92:93], v6 offset:12288
    ds_read_b64_tr_b16 v[94:95], v6 offset:12800
    v_mfma_f32_32x32x16_bf16 v[60:75], v[116:119], v[144:147], v[60:75]
    ds_read_b64_tr_b16 v[96:97], v6 offset:12544
    ds_read_b64_tr_b16 v[98:99], v6 offset:13056
    ds_read_b64_tr_b16 v[100:101], v6 offset:13312
    v_mfma_f32_32x32x16_bf16 v[76:91], v[120:123], v[144:147], v[76:91]
    ds_read_b64_tr_b16 v[102:103], v6 offset:13824
    ds_read_b64_tr_b16 v[104:105], v6 offset:13568
    ds_read_b64_tr_b16 v[106:107], v6 offset:14080
    s_waitcnt vmcnt(9) lgkmcnt(8)
    v_mfma_f32_32x32x16_bf16 v[28:43], v[124:127], v[148:151], v[28:43]
    s_add_u32 s36, s28, 12288
    buffer_load_dwordx4 v[140:143], v9, s[12:15], s36 offen sc1
    s_add_u32 s36, s28, 13312
    v_mfma_f32_32x32x16_bf16 v[44:59], v[128:131], v[148:151], v[44:59]
    buffer_load_dwordx4 v[144:147], v9, s[12:15], s36 offen sc1
    ds_read_b64_tr_b16 v[108:109], v6 offset:16384
    ds_read_b64_tr_b16 v[110:111], v6 offset:16896
    v_mfma_f32_32x32x16_bf16 v[60:75], v[132:135], v[148:151], v[60:75]
    ds_read_b64_tr_b16 v[112:113], v6 offset:16640
    ds_read_b64_tr_b16 v[114:115], v6 offset:17152
    ds_read_b64_tr_b16 v[116:117], v6 offset:17408
    v_mfma_f32_32x32x16_bf16 v[76:91], v[136:139], v[148:151], v[76:91]
    ds_read_b64_tr_b16 v[118:119], v6 offset:17920
    ds_read_b64_tr_b16 v[120:121], v6 offset:17664
    ds_read_b64_tr_b16 v[122:123], v6 offset:18176
    s_waitcnt vmcnt(10) lgkmcnt(8)
    v_mfma_f32_32x32x16_bf16 v[28:43], v[92:95], v[152:155], v[28:43]
    s_add_u32 s36, s28, 14336
    buffer_load_dwordx4 v[148:151], v9, s[12:15], s36 offen sc1
    ds_read_b64_tr_b16 v[124:125], v6 offset:20480
    v_mfma_f32_32x32x16_bf16 v[44:59], v[96:99], v[152:155], v[44:59]
    ds_read_b64_tr_b16 v[126:127], v6 offset:20992
    ds_read_b64_tr_b16 v[128:129], v6 offset:20736
    v_mfma_f32_32x32x16_bf16 v[60:75], v[100:103], v[152:155], v[60:75]
    ds_read_b64_tr_b16 v[130:131], v6 offset:21248
    ds_read_b64_tr_b16 v[132:133], v6 offset:21504
    ds_read_b64_tr_b16 v[134:135], v6 offset:22016
    v_mfma_f32_32x32x16_bf16 v[76:91], v[104:107], v[152:155], v[76:91]
    ds_read_b64_tr_b16 v[136:137], v6 offset:21760
    ds_read_b64_tr_b16 v[138:139], v6 offset:22272
    s_waitcnt vmcnt(10) lgkmcnt(8)
    v_mfma_f32_32x32x16_bf16 v[28:43], v[108:111], v[156:159], v[28:43]
    s_add_u32 s36, s28, 15360
    buffer_load_dwordx4 v[152:155], v9, s[12:15], s36 offen sc1
    ds_read_b64_tr_b16 v[92:93], v6 offset:24576
    v_mfma_f32_32x32x16_bf16 v[44:59], v[112:115], v[156:159], v[44:59]
    ds_read_b64_tr_b16 v[94:95], v6 offset:25088
    ds_read_b64_tr_b16 v[96:97], v6 offset:24832
    v_mfma_f32_32x32x16_bf16 v[60:75], v[116:119], v[156:159], v[60:75]
    ds_read_b64_tr_b16 v[98:99], v6 offset:25344
    ds_read_b64_tr_b16 v[100:101], v6 offset:25600
    ds_read_b64_tr_b16 v[102:103], v6 offset:26112
    v_mfma_f32_32x32x16_bf16 v[76:91], v[120:123], v[156:159], v[76:91]
    ds_read_b64_tr_b16 v[104:105], v6 offset:25856
    ds_read_b64_tr_b16 v[106:107], v6 offset:26368
    s_waitcnt vmcnt(10) lgkmcnt(8)
    v_mfma_f32_32x32x16_bf16 v[28:43], v[124:127], v[160:163], v[28:43]
    s_add_u32 s36, s28, 16384
    buffer_load_dwordx4 v[156:159], v9, s[12:15], s36 offen sc1
    ds_read_b64_tr_b16 v[108:109], v6 offset:28672
    v_mfma_f32_32x32x16_bf16 v[44:59], v[128:131], v[160:163], v[44:59]
    ds_read_b64_tr_b16 v[110:111], v6 offset:29184
    ds_read_b64_tr_b16 v[112:113], v6 offset:28928
    v_mfma_f32_32x32x16_bf16 v[60:75], v[132:135], v[160:163], v[60:75]
    ds_read_b64_tr_b16 v[114:115], v6 offset:29440
    ds_read_b64_tr_b16 v[116:117], v6 offset:29696
    ds_read_b64_tr_b16 v[118:119], v6 offset:30208
    v_mfma_f32_32x32x16_bf16 v[76:91], v[136:139], v[160:163], v[76:91]
    ds_read_b64_tr_b16 v[120:121], v6 offset:29952
    ds_read_b64_tr_b16 v[122:123], v6 offset:30464
    s_waitcnt vmcnt(10) lgkmcnt(8)
    v_mfma_f32_32x32x16_bf16 v[28:43], v[92:95], v[164:167], v[28:43]
    s_add_u32 s36, s28, 17408
    buffer_load_dwordx4 v[160:163], v9, s[12:15], s36 offen sc1
    ds_read_b64_tr_b16 v[124:125], v6 offset:32768
    v_mfma_f32_32x32x16_bf16 v[44:59], v[96:99], v[164:167], v[44:59]
    ds_read_b64_tr_b16 v[126:127], v6 offset:33280
    ds_read_b64_tr_b16 v[128:129], v6 offset:33024
    v_mfma_f32_32x32x16_bf16 v[60:75], v[100:103], v[164:167], v[60:75]
    ds_read_b64_tr_b16 v[130:131], v6 offset:33536
    ds_read_b64_tr_b16 v[132:133], v6 offset:33792
    ds_read_b64_tr_b16 v[134:135], v6 offset:34304
    v_mfma_f32_32x32x16_bf16 v[76:91], v[104:107], v[164:167], v[76:91]
    ds_read_b64_tr_b16 v[136:137], v6 offset:34048
    ds_read_b64_tr_b16 v[138:139], v6 offset:34560
    s_waitcnt vmcnt(10) lgkmcnt(8)
    v_mfma_f32_32x32x16_bf16 v[28:43], v[108:111], v[168:171], v[28:43]
    s_add_u32 s36, s28, 18432
    buffer_load_dwordx4 v[164:167], v9, s[12:15], s36 offen sc1
    ds_read_b64_tr_b16 v[92:93], v6 offset:36864
    v_mfma_f32_32x32x16_bf16 v[44:59], v[112:115], v[168:171], v[44:59]
    ds_read_b64_tr_b16 v[94:95], v6 offset:37376
    ds_read_b64_tr_b16 v[96:97], v6 offset:37120
    v_mfma_f32_32x32x16_bf16 v[60:75], v[116:119], v[168:171], v[60:75]
    ds_read_b64_tr_b16 v[98:99], v6 offset:37632
    ds_read_b64_tr_b16 v[100:101], v6 offset:37888
    ds_read_b64_tr_b16 v[102:103], v6 offset:38400
    v_mfma_f32_32x32x16_bf16 v[76:91], v[120:123], v[168:171], v[76:91]
    ds_read_b64_tr_b16 v[104:105], v6 offset:38144
    ds_read_b64_tr_b16 v[106:107], v6 offset:38656
    s_waitcnt vmcnt(10) lgkmcnt(8)
    v_mfma_f32_32x32x16_bf16 v[28:43], v[124:127], v[172:175], v[28:43]
    s_add_u32 s36, s28, 19456
    buffer_load_dwordx4 v[168:171], v9, s[12:15], s36 offen sc1
    ds_read_b64_tr_b16 v[108:109], v6 offset:40960
    v_mfma_f32_32x32x16_bf16 v[44:59], v[128:131], v[172:175], v[44:59]
    ds_read_b64_tr_b16 v[110:111], v6 offset:41472
    ds_read_b64_tr_b16 v[112:113], v6 offset:41216
    v_mfma_f32_32x32x16_bf16 v[60:75], v[132:135], v[172:175], v[60:75]
    ds_read_b64_tr_b16 v[114:115], v6 offset:41728
    ds_read_b64_tr_b16 v[116:117], v6 offset:41984
    ds_read_b64_tr_b16 v[118:119], v6 offset:42496
    v_mfma_f32_32x32x16_bf16 v[76:91], v[136:139], v[172:175], v[76:91]
    ds_read_b64_tr_b16 v[120:121], v6 offset:42240
    ds_read_b64_tr_b16 v[122:123], v6 offset:42752
    s_waitcnt vmcnt(10) lgkmcnt(8)
    v_mfma_f32_32x32x16_bf16 v[28:43], v[92:95], v[176:179], v[28:43]
    s_add_u32 s36, s28, 20480
    buffer_load_dwordx4 v[172:175], v9, s[12:15], s36 offen sc1
    ds_read_b64_tr_b16 v[124:125], v6 offset:45056
    v_mfma_f32_32x32x16_bf16 v[44:59], v[96:99], v[176:179], v[44:59]
    ds_read_b64_tr_b16 v[126:127], v6 offset:45568
    ds_read_b64_tr_b16 v[128:129], v6 offset:45312
    v_mfma_f32_32x32x16_bf16 v[60:75], v[100:103], v[176:179], v[60:75]
    ds_read_b64_tr_b16 v[130:131], v6 offset:45824
    ds_read_b64_tr_b16 v[132:133], v6 offset:46080
    ds_read_b64_tr_b16 v[134:135], v6 offset:46592
    v_mfma_f32_32x32x16_bf16 v[76:91], v[104:107], v[176:179], v[76:91]
    ds_read_b64_tr_b16 v[136:137], v6 offset:46336
    ds_read_b64_tr_b16 v[138:139], v6 offset:46848
    s_waitcnt vmcnt(10) lgkmcnt(8)
    v_mfma_f32_32x32x16_bf16 v[28:43], v[108:111], v[180:183], v[28:43]
    s_add_u32 s36, s28, 21504
    buffer_load_dwordx4 v[176:179], v9, s[12:15], s36 offen sc1
    ds_read_b64_tr_b16 v[92:93], v6 offset:49152
    v_mfma_f32_32x32x16_bf16 v[44:59], v[112:115], v[180:183], v[44:59]
    ds_read_b64_tr_b16 v[94:95], v6 offset:49664
    ds_read_b64_tr_b16 v[96:97], v6 offset:49408
    v_mfma_f32_32x32x16_bf16 v[60:75], v[116:119], v[180:183], v[60:75]
    ds_read_b64_tr_b16 v[98:99], v6 offset:49920
    ds_read_b64_tr_b16 v[100:101], v6 offset:50176
    ds_read_b64_tr_b16 v[102:103], v6 offset:50688
    v_mfma_f32_32x32x16_bf16 v[76:91], v[120:123], v[180:183], v[76:91]
    ds_read_b64_tr_b16 v[104:105], v6 offset:50432
    ds_read_b64_tr_b16 v[106:107], v6 offset:50944
    s_waitcnt vmcnt(10) lgkmcnt(8)
    v_mfma_f32_32x32x16_bf16 v[28:43], v[124:127], v[184:187], v[28:43]
    s_add_u32 s36, s28, 22528
    buffer_load_dwordx4 v[180:183], v9, s[12:15], s36 offen sc1
    ds_read_b64_tr_b16 v[108:109], v6 offset:53248
    v_mfma_f32_32x32x16_bf16 v[44:59], v[128:131], v[184:187], v[44:59]
    ds_read_b64_tr_b16 v[110:111], v6 offset:53760
    ds_read_b64_tr_b16 v[112:113], v6 offset:53504
    v_mfma_f32_32x32x16_bf16 v[60:75], v[132:135], v[184:187], v[60:75]
    ds_read_b64_tr_b16 v[114:115], v6 offset:54016
    ds_read_b64_tr_b16 v[116:117], v6 offset:54272
    ds_read_b64_tr_b16 v[118:119], v6 offset:54784
    v_mfma_f32_32x32x16_bf16 v[76:91], v[136:139], v[184:187], v[76:91]
    ds_read_b64_tr_b16 v[120:121], v6 offset:54528
    ds_read_b64_tr_b16 v[122:123], v6 offset:55040
    s_waitcnt vmcnt(10) lgkmcnt(8)
    v_mfma_f32_32x32x16_bf16 v[28:43], v[92:95], v[140:143], v[28:43]
    s_add_u32 s36, s28, 23552
    buffer_load_dwordx4 v[184:187], v9, s[12:15], s36 offen sc1
    ds_read_b64_tr_b16 v[124:125], v6 offset:57344
    v_mfma_f32_32x32x16_bf16 v[44:59], v[96:99], v[140:143], v[44:59]
    ds_read_b64_tr_b16 v[126:127], v6 offset:57856
    ds_read_b64_tr_b16 v[128:129], v6 offset:57600
    v_mfma_f32_32x32x16_bf16 v[60:75], v[100:103], v[140:143], v[60:75]
    ds_read_b64_tr_b16 v[130:131], v6 offset:58112
    ds_read_b64_tr_b16 v[132:133], v6 offset:58368
    ds_read_b64_tr_b16 v[134:135], v6 offset:58880
    v_mfma_f32_32x32x16_bf16 v[76:91], v[104:107], v[140:143], v[76:91]
    ds_read_b64_tr_b16 v[136:137], v6 offset:58624
    ds_read_b64_tr_b16 v[138:139], v6 offset:59136
    s_waitcnt vmcnt(10) lgkmcnt(8)
    v_mfma_f32_32x32x16_bf16 v[28:43], v[108:111], v[144:147], v[28:43]
    s_add_u32 s36, s28, 24576
    buffer_load_dwordx4 v[140:143], v9, s[12:15], s36 offen sc1
    ds_read_b64_tr_b16 v[92:93], v6 offset:61440
    v_mfma_f32_32x32x16_bf16 v[44:59], v[112:115], v[144:147], v[44:59]
    ds_read_b64_tr_b16 v[94:95], v6 offset:61952
    ds_read_b64_tr_b16 v[96:97], v6 offset:61696
    v_mfma_f32_32x32x16_bf16 v[60:75], v[116:119], v[144:147], v[60:75]
    ds_read_b64_tr_b16 v[98:99], v6 offset:62208
    ds_read_b64_tr_b16 v[100:101], v6 offset:62464
    ds_read_b64_tr_b16 v[102:103], v6 offset:62976
    v_mfma_f32_32x32x16_bf16 v[76:91], v[120:123], v[144:147], v[76:91]
    ds_read_b64_tr_b16 v[104:105], v6 offset:62720
    ds_read_b64_tr_b16 v[106:107], v6 offset:63232
    s_waitcnt vmcnt(10) lgkmcnt(8)
    v_mfma_f32_32x32x16_bf16 v[28:43], v[124:127], v[148:151], v[28:43]
    s_add_u32 s36, s28, 25600
    buffer_load_dwordx4 v[144:147], v9, s[12:15], s36 offen sc1
    ds_read_b64_tr_b16 v[108:109], v7 offset:0
    v_mfma_f32_32x32x16_bf16 v[44:59], v[128:131], v[148:151], v[44:59]
    ds_read_b64_tr_b16 v[110:111], v7 offset:512
    ds_read_b64_tr_b16 v[112:113], v7 offset:256
    v_mfma_f32_32x32x16_bf16 v[60:75], v[132:135], v[148:151], v[60:75]
    ds_read_b64_tr_b16 v[114:115], v7 offset:768
    ds_read_b64_tr_b16 v[116:117], v7 offset:1024
    ds_read_b64_tr_b16 v[118:119], v7 offset:1536
    v_mfma_f32_32x32x16_bf16 v[76:91], v[136:139], v[148:151], v[76:91]
    ds_read_b64_tr_b16 v[120:121], v7 offset:1280
    ds_read_b64_tr_b16 v[122:123], v7 offset:1792
    s_waitcnt vmcnt(10) lgkmcnt(8)
    v_mfma_f32_32x32x16_bf16 v[28:43], v[92:95], v[152:155], v[28:43]
    s_add_u32 s36, s28, 26624
    buffer_load_dwordx4 v[148:151], v9, s[12:15], s36 offen sc1
    ds_read_b64_tr_b16 v[124:125], v7 offset:4096
    v_mfma_f32_32x32x16_bf16 v[44:59], v[96:99], v[152:155], v[44:59]
    ds_read_b64_tr_b16 v[126:127], v7 offset:4608
    ds_read_b64_tr_b16 v[128:129], v7 offset:4352
    v_mfma_f32_32x32x16_bf16 v[60:75], v[100:103], v[152:155], v[60:75]
    ds_read_b64_tr_b16 v[130:131], v7 offset:4864
    ds_read_b64_tr_b16 v[132:133], v7 offset:5120
    ds_read_b64_tr_b16 v[134:135], v7 offset:5632
    v_mfma_f32_32x32x16_bf16 v[76:91], v[104:107], v[152:155], v[76:91]
    ds_read_b64_tr_b16 v[136:137], v7 offset:5376
    ds_read_b64_tr_b16 v[138:139], v7 offset:5888
    s_waitcnt vmcnt(10) lgkmcnt(8)
    v_mfma_f32_32x32x16_bf16 v[28:43], v[108:111], v[156:159], v[28:43]
    s_add_u32 s36, s28, 27648
    buffer_load_dwordx4 v[152:155], v9, s[12:15], s36 offen sc1
    ds_read_b64_tr_b16 v[92:93], v7 offset:8192
    v_mfma_f32_32x32x16_bf16 v[44:59], v[112:115], v[156:159], v[44:59]
    ds_read_b64_tr_b16 v[94:95], v7 offset:8704
    ds_read_b64_tr_b16 v[96:97], v7 offset:8448
    v_mfma_f32_32x32x16_bf16 v[60:75], v[116:119], v[156:159], v[60:75]
    ds_read_b64_tr_b16 v[98:99], v7 offset:8960
    ds_read_b64_tr_b16 v[100:101], v7 offset:9216
    ds_read_b64_tr_b16 v[102:103], v7 offset:9728
    v_mfma_f32_32x32x16_bf16 v[76:91], v[120:123], v[156:159], v[76:91]
    ds_read_b64_tr_b16 v[104:105], v7 offset:9472
    ds_read_b64_tr_b16 v[106:107], v7 offset:9984
    s_waitcnt vmcnt(10) lgkmcnt(8)
    v_mfma_f32_32x32x16_bf16 v[28:43], v[124:127], v[160:163], v[28:43]
    s_add_u32 s36, s28, 28672
    buffer_load_dwordx4 v[156:159], v9, s[12:15], s36 offen sc1
    ds_read_b64_tr_b16 v[108:109], v7 offset:12288
    v_mfma_f32_32x32x16_bf16 v[44:59], v[128:131], v[160:163], v[44:59]
    ds_read_b64_tr_b16 v[110:111], v7 offset:12800
    ds_read_b64_tr_b16 v[112:113], v7 offset:12544
    v_mfma_f32_32x32x16_bf16 v[60:75], v[132:135], v[160:163], v[60:75]
    ds_read_b64_tr_b16 v[114:115], v7 offset:13056
    ds_read_b64_tr_b16 v[116:117], v7 offset:13312
    ds_read_b64_tr_b16 v[118:119], v7 offset:13824
    v_mfma_f32_32x32x16_bf16 v[76:91], v[136:139], v[160:163], v[76:91]
    ds_read_b64_tr_b16 v[120:121], v7 offset:13568
    ds_read_b64_tr_b16 v[122:123], v7 offset:14080
    s_waitcnt lgkmcnt(0)
    s_barrier
    s_waitcnt vmcnt(10) lgkmcnt(8)
    v_mfma_f32_32x32x16_bf16 v[28:43], v[92:95], v[164:167], v[28:43]
    s_add_u32 s36, s28, 29696
    buffer_load_dwordx4 v[160:163], v9, s[12:15], s36 offen sc1
    ds_read_b64_tr_b16 v[124:125], v7 offset:16384
    v_mfma_f32_32x32x16_bf16 v[44:59], v[96:99], v[164:167], v[44:59]
    ds_read_b64_tr_b16 v[126:127], v7 offset:16896
    ds_read_b64_tr_b16 v[128:129], v7 offset:16640
    v_mfma_f32_32x32x16_bf16 v[60:75], v[100:103], v[164:167], v[60:75]
    ds_read_b64_tr_b16 v[130:131], v7 offset:17152
    ds_read_b64_tr_b16 v[132:133], v7 offset:17408
    ds_read_b64_tr_b16 v[134:135], v7 offset:17920
    v_mfma_f32_32x32x16_bf16 v[76:91], v[104:107], v[164:167], v[76:91]
    ds_read_b64_tr_b16 v[136:137], v7 offset:17664
    ds_read_b64_tr_b16 v[138:139], v7 offset:18176
    s_waitcnt vmcnt(10) lgkmcnt(8)
    v_mfma_f32_32x32x16_bf16 v[28:43], v[108:111], v[168:171], v[28:43]
    s_add_u32 s36, s28, 30720
    buffer_load_dwordx4 v[164:167], v9, s[12:15], s36 offen sc1
    ds_read_b64_tr_b16 v[92:93], v7 offset:20480
    v_mfma_f32_32x32x16_bf16 v[44:59], v[112:115], v[168:171], v[44:59]
    ds_read_b64_tr_b16 v[94:95], v7 offset:20992
    ds_read_b64_tr_b16 v[96:97], v7 offset:20736
    v_mfma_f32_32x32x16_bf16 v[60:75], v[116:119], v[168:171], v[60:75]
    ds_read_b64_tr_b16 v[98:99], v7 offset:21248
    ds_read_b64_tr_b16 v[100:101], v7 offset:21504
    ds_read_b64_tr_b16 v[102:103], v7 offset:22016
    v_mfma_f32_32x32x16_bf16 v[76:91], v[120:123], v[168:171], v[76:91]
    ds_read_b64_tr_b16 v[104:105], v7 offset:21760
    ds_read_b64_tr_b16 v[106:107], v7 offset:22272
    s_waitcnt vmcnt(10) lgkmcnt(8)
    v_mfma_f32_32x32x16_bf16 v[28:43], v[124:127], v[172:175], v[28:43]
    s_add_u32 s36, s28, 31744
    buffer_load_dwordx4 v[168:171], v9, s[12:15], s36 offen sc1
    ds_read_b64_tr_b16 v[108:109], v7 offset:24576
    v_mfma_f32_32x32x16_bf16 v[44:59], v[128:131], v[172:175], v[44:59]
    ds_read_b64_tr_b16 v[110:111], v7 offset:25088
    ds_read_b64_tr_b16 v[112:113], v7 offset:24832
    v_mfma_f32_32x32x16_bf16 v[60:75], v[132:135], v[172:175], v[60:75]
    ds_read_b64_tr_b16 v[114:115], v7 offset:25344
    ds_read_b64_tr_b16 v[116:117], v7 offset:25600
    ds_read_b64_tr_b16 v[118:119], v7 offset:26112
    v_mfma_f32_32x32x16_bf16 v[76:91], v[136:139], v[172:175], v[76:91]
    ds_read_b64_tr_b16 v[120:121], v7 offset:25856
    ds_read_b64_tr_b16 v[122:123], v7 offset:26368
    s_waitcnt vmcnt(10) lgkmcnt(8)
    v_mfma_f32_32x32x16_bf16 v[28:43], v[92:95], v[176:179], v[28:43]
    s_add_u32 s36, s28, 32768
    buffer_load_dwordx4 v[172:175], v9, s[12:15], s36 offen sc1
    ds_read_b64_tr_b16 v[124:125], v7 offset:28672
    v_mfma_f32_32x32x16_bf16 v[44:59], v[96:99], v[176:179], v[44:59]
    ds_read_b64_tr_b16 v[126:127], v7 offset:29184
    ds_read_b64_tr_b16 v[128:129], v7 offset:28928
    v_mfma_f32_32x32x16_bf16 v[60:75], v[100:103], v[176:179], v[60:75]
    ds_read_b64_tr_b16 v[130:131], v7 offset:29440
    ds_read_b64_tr_b16 v[132:133], v7 offset:29696
    ds_read_b64_tr_b16 v[134:135], v7 offset:30208
    v_mfma_f32_32x32x16_bf16 v[76:91], v[104:107], v[176:179], v[76:91]
    ds_read_b64_tr_b16 v[136:137], v7 offset:29952
    ds_read_b64_tr_b16 v[138:139], v7 offset:30464
    s_waitcnt vmcnt(10) lgkmcnt(8)
    v_mfma_f32_32x32x16_bf16 v[28:43], v[108:111], v[180:183], v[28:43]
    s_add_u32 s36, s28, 33792
    buffer_load_dwordx4 v[176:179], v9, s[12:15], s36 offen sc1
    ds_read_b32 v252, v2
    ds_read_b32 v253, v2 offset:512
    v_mfma_f32_32x32x16_bf16 v[44:59], v[112:115], v[180:183], v[44:59]
    ds_read_b128 v[188:191], v3 offset:0
    ds_read_b64_tr_b16 v[92:93], v7 offset:32768
    ds_read_b64_tr_b16 v[94:95], v7 offset:33280
    v_mfma_f32_32x32x16_bf16 v[60:75], v[116:119], v[180:183], v[60:75]
    ds_read_b64_tr_b16 v[96:97], v7 offset:33024
    ds_read_b64_tr_b16 v[98:99], v7 offset:33536
    ds_read_b64_tr_b16 v[100:101], v7 offset:33792
    v_mfma_f32_32x32x16_bf16 v[76:91], v[120:123], v[180:183], v[76:91]
    ds_read_b64_tr_b16 v[102:103], v7 offset:34304
    ds_read_b64_tr_b16 v[104:105], v7 offset:34048
    ds_read_b64_tr_b16 v[106:107], v7 offset:34560
    s_waitcnt vmcnt(10) lgkmcnt(8)
    v_mfma_f32_32x32x16_bf16 v[28:43], v[124:127], v[184:187], v[28:43]
    s_add_u32 s36, s28, 34816
    buffer_load_dwordx4 v[180:183], v9, s[12:15], s36 offen sc1
    ds_read_b128 v[192:195], v3 offset:32
    ds_read_b128 v[196:199], v3 offset:64
    v_mfma_f32_32x32x16_bf16 v[44:59], v[128:131], v[184:187], v[44:59]
    ds_read_b128 v[200:203], v3 offset:96
    ds_read_b64_tr_b16 v[108:109], v7 offset:36864
    ds_read_b64_tr_b16 v[110:111], v7 offset:37376
    v_mfma_f32_32x32x16_bf16 v[60:75], v[132:135], v[184:187], v[60:75]
    ds_read_b64_tr_b16 v[112:113], v7 offset:37120
    ds_read_b64_tr_b16 v[114:115], v7 offset:37632
    ds_read_b64_tr_b16 v[116:117], v7 offset:37888
    v_mfma_f32_32x32x16_bf16 v[76:91], v[136:139], v[184:187], v[76:91]
    ds_read_b64_tr_b16 v[118:119], v7 offset:38400
    ds_read_b64_tr_b16 v[120:121], v7 offset:38144
    ds_read_b64_tr_b16 v[122:123], v7 offset:38656
    s_waitcnt vmcnt(10) lgkmcnt(8)
    v_mfma_f32_32x32x16_bf16 v[28:43], v[92:95], v[140:143], v[28:43]
    s_add_u32 s36, s28, 35840
    buffer_load_dwordx4 v[184:187], v9, s[12:15], s36 offen sc1
    ds_read_b128 v[204:207], v3 offset:128
    ds_read_b128 v[208:211], v3 offset:160
    v_mfma_f32_32x32x16_bf16 v[44:59], v[96:99], v[140:143], v[44:59]
    ds_read_b128 v[212:215], v3 offset:192
    ds_read_b64_tr_b16 v[124:125], v7 offset:40960
    ds_read_b64_tr_b16 v[126:127], v7 offset:41472
    v_mfma_f32_32x32x16_bf16 v[60:75], v[100:103], v[140:143], v[60:75]
    ds_read_b64_tr_b16 v[128:129], v7 offset:41216
    ds_read_b64_tr_b16 v[130:131], v7 offset:41728
    ds_read_b64_tr_b16 v[132:133], v7 offset:41984
    v_mfma_f32_32x32x16_bf16 v[76:91], v[104:107], v[140:143], v[76:91]
    ds_read_b64_tr_b16 v[134:135], v7 offset:42496
    ds_read_b64_tr_b16 v[136:137], v7 offset:42240
    ds_read_b64_tr_b16 v[138:139], v7 offset:42752
    s_waitcnt vmcnt(10) lgkmcnt(8)
    v_mfma_f32_32x32x16_bf16 v[28:43], v[108:111], v[144:147], v[28:43]
    s_add_u32 s36, s28, 36864
    buffer_load_dwordx4 v[140:143], v9, s[12:15], s36 offen sc1
    ds_read_b128 v[216:219], v3 offset:224
    ds_read_b128 v[220:223], v3 offset:256
    v_mfma_f32_32x32x16_bf16 v[44:59], v[112:115], v[144:147], v[44:59]
    ds_read_b128 v[224:227], v3 offset:288
    ds_read_b64_tr_b16 v[92:93], v7 offset:45056
    ds_read_b64_tr_b16 v[94:95], v7 offset:45568
    v_mfma_f32_32x32x16_bf16 v[60:75], v[116:119], v[144:147], v[60:75]
    ds_read_b64_tr_b16 v[96:97], v7 offset:45312
    ds_read_b64_tr_b16 v[98:99], v7 offset:45824
    ds_read_b64_tr_b16 v[100:101], v7 offset:46080
    v_mfma_f32_32x32x16_bf16 v[76:91], v[120:123], v[144:147], v[76:91]
    ds_read_b64_tr_b16 v[102:103], v7 offset:46592
    ds_read_b64_tr_b16 v[104:105], v7 offset:46336
    ds_read_b64_tr_b16 v[106:107], v7 offset:46848
    s_waitcnt vmcnt(10) lgkmcnt(8)
    v_mfma_f32_32x32x16_bf16 v[28:43], v[124:127], v[148:151], v[28:43]
    s_add_u32 s36, s28, 37888
    buffer_load_dwordx4 v[144:147], v9, s[12:15], s36 offen sc1
    ds_read_b128 v[228:231], v3 offset:320
    ds_read_b128 v[232:235], v3 offset:352
    v_mfma_f32_32x32x16_bf16 v[44:59], v[128:131], v[148:151], v[44:59]
    ds_read_b128 v[236:239], v3 offset:384
    ds_read_b64_tr_b16 v[108:109], v7 offset:49152
    ds_read_b64_tr_b16 v[110:111], v7 offset:49664
    v_mfma_f32_32x32x16_bf16 v[60:75], v[132:135], v[148:151], v[60:75]
    ds_read_b64_tr_b16 v[112:113], v7 offset:49408
    ds_read_b64_tr_b16 v[114:115], v7 offset:49920
    ds_read_b64_tr_b16 v[116:117], v7 offset:50176
    v_mfma_f32_32x32x16_bf16 v[76:91], v[136:139], v[148:151], v[76:91]
    ds_read_b64_tr_b16 v[118:119], v7 offset:50688
    ds_read_b64_tr_b16 v[120:121], v7 offset:50432
    ds_read_b64_tr_b16 v[122:123], v7 offset:50944
    s_waitcnt vmcnt(10) lgkmcnt(8)
    v_mfma_f32_32x32x16_bf16 v[28:43], v[92:95], v[152:155], v[28:43]
    s_add_u32 s36, s28, 38912
    buffer_load_dwordx4 v[148:151], v9, s[12:15], s36 offen sc1
    ds_read_b128 v[240:243], v3 offset:416
    ds_read_b128 v[244:247], v3 offset:448
    v_mfma_f32_32x32x16_bf16 v[44:59], v[96:99], v[152:155], v[44:59]
    ds_read_b128 v[248:251], v3 offset:480
    ds_read_b64_tr_b16 v[124:125], v7 offset:53248
    ds_read_b64_tr_b16 v[126:127], v7 offset:53760
    v_mfma_f32_32x32x16_bf16 v[60:75], v[100:103], v[152:155], v[60:75]
    ds_read_b64_tr_b16 v[128:129], v7 offset:53504
    ds_read_b64_tr_b16 v[130:131], v7 offset:54016
    ds_read_b64_tr_b16 v[132:133], v7 offset:54272
    v_mfma_f32_32x32x16_bf16 v[76:91], v[104:107], v[152:155], v[76:91]
    ds_read_b64_tr_b16 v[134:135], v7 offset:54784
    ds_read_b64_tr_b16 v[136:137], v7 offset:54528
    ds_read_b64_tr_b16 v[138:139], v7 offset:55040
    s_waitcnt vmcnt(10) lgkmcnt(8)
    v_mfma_f32_32x32x16_bf16 v[28:43], v[108:111], v[156:159], v[28:43]
    s_add_u32 s36, s28, 39936
    buffer_load_dwordx4 v[152:155], v9, s[12:15], s36 offen sc1
    ds_read_b64_tr_b16 v[92:93], v7 offset:57344
    v_mfma_f32_32x32x16_bf16 v[44:59], v[112:115], v[156:159], v[44:59]
    ds_read_b64_tr_b16 v[94:95], v7 offset:57856
    ds_read_b64_tr_b16 v[96:97], v7 offset:57600
    v_mfma_f32_32x32x16_bf16 v[60:75], v[116:119], v[156:159], v[60:75]
    ds_read_b64_tr_b16 v[98:99], v7 offset:58112
    ds_read_b64_tr_b16 v[100:101], v7 offset:58368
    ds_read_b64_tr_b16 v[102:103], v7 offset:58880
    v_mfma_f32_32x32x16_bf16 v[76:91], v[120:123], v[156:159], v[76:91]
    ds_read_b64_tr_b16 v[104:105], v7 offset:58624
    ds_read_b64_tr_b16 v[106:107], v7 offset:59136
    s_waitcnt vmcnt(10) lgkmcnt(8)
    v_mfma_f32_32x32x16_bf16 v[28:43], v[124:127], v[160:163], v[28:43]
    ds_read_b64_tr_b16 v[108:109], v7 offset:61440
    ds_read_b64_tr_b16 v[110:111], v7 offset:61952
    v_mfma_f32_32x32x16_bf16 v[44:59], v[128:131], v[160:163], v[44:59]
    ds_read_b64_tr_b16 v[112:113], v7 offset:61696
    ds_read_b64_tr_b16 v[114:115], v7 offset:62208
    v_mfma_f32_32x32x16_bf16 v[60:75], v[132:135], v[160:163], v[60:75]
    ds_read_b64_tr_b16 v[116:117], v7 offset:62464
    ds_read_b64_tr_b16 v[118:119], v7 offset:62976
    v_mfma_f32_32x32x16_bf16 v[76:91], v[136:139], v[160:163], v[76:91]
    ds_read_b64_tr_b16 v[120:121], v7 offset:62720
    ds_read_b64_tr_b16 v[122:123], v7 offset:63232
    s_waitcnt lgkmcnt(0)
    s_barrier
    s_waitcnt vmcnt(9) lgkmcnt(8)
    v_mfma_f32_32x32x16_bf16 v[28:43], v[92:95], v[164:167], v[28:43]
    ds_read_b64_tr_b16 v[124:125], v8 offset:0
    ds_read_b64_tr_b16 v[126:127], v8 offset:512
    v_mfma_f32_32x32x16_bf16 v[44:59], v[96:99], v[164:167], v[44:59]
    ds_read_b64_tr_b16 v[128:129], v8 offset:4096
    ds_read_b64_tr_b16 v[130:131], v8 offset:4608
    v_mfma_f32_32x32x16_bf16 v[60:75], v[100:103], v[164:167], v[60:75]
    ds_read_b64_tr_b16 v[132:133], v8 offset:8192
    ds_read_b64_tr_b16 v[134:135], v8 offset:8704
    v_mfma_f32_32x32x16_bf16 v[76:91], v[104:107], v[164:167], v[76:91]
    ds_read_b64_tr_b16 v[136:137], v8 offset:12288
    ds_read_b64_tr_b16 v[138:139], v8 offset:12800
    s_waitcnt vmcnt(8) lgkmcnt(8)
    v_mfma_f32_32x32x16_bf16 v[28:43], v[108:111], v[168:171], v[28:43]
    ds_read_b64_tr_b16 v[92:93], v6 offset:0
    ds_read_b64_tr_b16 v[94:95], v6 offset:512
    v_mfma_f32_32x32x16_bf16 v[44:59], v[112:115], v[168:171], v[44:59]
    ds_read_b64_tr_b16 v[96:97], v6 offset:4096
    ds_read_b64_tr_b16 v[98:99], v6 offset:4608
    v_mfma_f32_32x32x16_bf16 v[60:75], v[116:119], v[168:171], v[60:75]
    ds_read_b64_tr_b16 v[100:101], v6 offset:8192
    ds_read_b64_tr_b16 v[102:103], v6 offset:8704
    v_mfma_f32_32x32x16_bf16 v[76:91], v[120:123], v[168:171], v[76:91]
    ds_read_b64_tr_b16 v[104:105], v6 offset:12288
    ds_read_b64_tr_b16 v[106:107], v6 offset:12800
    s_waitcnt vmcnt(4) lgkmcnt(8)
    v_mfma_f32_32x32x16_bf16 v[28:43], v[124:127], v[172:175], v[28:43]
    ds_read_b64_tr_b16 v[108:109], v8 offset:256
    ds_read_b64_tr_b16 v[110:111], v8 offset:768
    v_mfma_f32_32x32x16_bf16 v[28:43], v[128:131], v[176:179], v[28:43]
    ds_read_b64_tr_b16 v[112:113], v8 offset:4352
    ds_read_b64_tr_b16 v[114:115], v8 offset:4864
    v_mfma_f32_32x32x16_bf16 v[28:43], v[132:135], v[180:183], v[28:43]
    ds_read_b64_tr_b16 v[116:117], v8 offset:8448
    ds_read_b64_tr_b16 v[118:119], v8 offset:8960
    v_mfma_f32_32x32x16_bf16 v[28:43], v[136:139], v[184:187], v[28:43]
    ds_read_b64_tr_b16 v[120:121], v8 offset:12544
    ds_read_b64_tr_b16 v[122:123], v8 offset:13056
    s_waitcnt vmcnt(0) lgkmcnt(8)
    v_mfma_f32_32x32x16_bf16 v[28:43], v[92:95], v[140:143], v[28:43]
    ds_read_b64_tr_b16 v[124:125], v6 offset:256
    ds_read_b64_tr_b16 v[126:127], v6 offset:768
    v_mfma_f32_32x32x16_bf16 v[28:43], v[96:99], v[144:147], v[28:43]
    ds_read_b64_tr_b16 v[128:129], v6 offset:4352
    ds_read_b64_tr_b16 v[130:131], v6 offset:4864
    v_mfma_f32_32x32x16_bf16 v[28:43], v[100:103], v[148:151], v[28:43]
    ds_read_b64_tr_b16 v[132:133], v6 offset:8448
    ds_read_b64_tr_b16 v[134:135], v6 offset:8960
    v_mfma_f32_32x32x16_bf16 v[28:43], v[104:107], v[152:155], v[28:43]
    ds_read_b64_tr_b16 v[136:137], v6 offset:12544
    ds_read_b64_tr_b16 v[138:139], v6 offset:13056
    s_mul_i32 s36, s44, 205
    s_lshr_b32 s36, s36, 10
    s_mul_i32 s37, s36, 5
    s_sub_u32 s35, s44, s37
    s_mul_i32 s36, s36, s42
    s_lshl_b32 s36, s36, 1
    s_add_u32 s43, s43, s36
    s_cmp_eq_u32 s35, 1
    s_cbranch_scc1 tl_qs_1
    s_cmp_eq_u32 s35, 2
    s_cbranch_scc1 tl_qs_2
    s_cmp_eq_u32 s35, 3
    s_cbranch_scc1 tl_qs_3
    s_cmp_eq_u32 s35, 4
    s_cbranch_scc1 tl_qs_4
    s_waitcnt lgkmcnt(8)
    v_mfma_f32_32x32x16_bf16 v[44:59], v[108:111], v[172:175], v[44:59]
    ds_read_b64_tr_b16 v[92:93], v8 offset:1024
    ds_read_b64_tr_b16 v[94:95], v8 offset:1536
    ds_read_b64_tr_b16 v[96:97], v8 offset:5120
    ds_read_b64_tr_b16 v[98:99], v8 offset:5632
    ds_read_b64_tr_b16 v[100:101], v8 offset:9216
    ds_read_b64_tr_b16 v[102:103], v8 offset:9728
    ds_read_b64_tr_b16 v[104:105], v8 offset:13312
    ds_read_b64_tr_b16 v[106:107], v8 offset:13824
    s_nop 1
    v_mfma_f32_32x32x16_bf16 v[44:59], v[112:115], v[176:179], v[44:59]
    v_fma_f32 v28, -v253, v188, v28
    v_fma_f32 v29, -v253, v189, v29
    v_fma_f32 v30, -v253, v190, v30
    v_fma_f32 v31, -v253, v191, v31
    v_fma_f32 v32, -v253, v192, v32
    v_fma_f32 v33, -v253, v193, v33
    v_mfma_f32_32x32x16_bf16 v[44:59], v[116:119], v[180:183], v[44:59]
    v_fma_f32 v34, -v253, v194, v34
    v_fma_f32 v35, -v253, v195, v35
    v_fma_f32 v36, -v253, v196, v36
    v_fma_f32 v37, -v253, v197, v37
    v_fma_f32 v38, -v253, v198, v38
    v_fma_f32 v39, -v253, v199, v39
    v_mfma_f32_32x32x16_bf16 v[44:59], v[120:123], v[184:187], v[44:59]
    v_fma_f32 v40, -v253, v200, v40
    v_fma_f32 v41, -v253, v201, v41
    v_fma_f32 v42, -v253, v202, v42
    v_fma_f32 v43, -v253, v203, v43
    v_mul_f32 v28, v252, v28
    s_waitcnt lgkmcnt(8)
    v_mfma_f32_32x32x16_bf16 v[44:59], v[124:127], v[140:143], v[44:59]
    ds_read_b64_tr_b16 v[108:109], v6 offset:1024
    ds_read_b64_tr_b16 v[110:111], v6 offset:1536
    ds_read_b64_tr_b16 v[112:113], v6 offset:5120
    ds_read_b64_tr_b16 v[114:115], v6 offset:5632
    ds_read_b64_tr_b16 v[116:117], v6 offset:9216
    ds_read_b64_tr_b16 v[118:119], v6 offset:9728
    ds_read_b64_tr_b16 v[120:121], v6 offset:13312
    ds_read_b64_tr_b16 v[122:123], v6 offset:13824
    v_mfma_f32_32x32x16_bf16 v[44:59], v[128:131], v[144:147], v[44:59]
    v_mul_f32 v29, v252, v29
    v_mul_f32 v30, v252, v30
    v_mul_f32 v31, v252, v31
    v_mul_f32 v32, v252, v32
    v_mul_f32 v33, v252, v33
    v_mul_f32 v34, v252, v34
    v_mul_f32 v35, v252, v35
    v_mul_f32 v36, v252, v36
    v_mfma_f32_32x32x16_bf16 v[44:59], v[132:135], v[148:151], v[44:59]
    v_mul_f32 v37, v252, v37
    v_mul_f32 v38, v252, v38
    v_mul_f32 v39, v252, v39
    v_mul_f32 v40, v252, v40
    v_mul_f32 v41, v252, v41
    v_mul_f32 v42, v252, v42
    v_mul_f32 v43, v252, v43
    v_cvt_pk_bf16_f32 v28, v28, v29
    v_mfma_f32_32x32x16_bf16 v[44:59], v[136:139], v[152:155], v[44:59]
    v_cvt_pk_bf16_f32 v29, v30, v31
    v_cvt_pk_bf16_f32 v30, v32, v33
    v_cvt_pk_bf16_f32 v31, v34, v35
    v_cvt_pk_bf16_f32 v32, v36, v37
    v_cvt_pk_bf16_f32 v33, v38, v39
    v_cvt_pk_bf16_f32 v34, v40, v41
    v_cvt_pk_bf16_f32 v35, v42, v43
    s_nop 0
    s_mul_i32 s36, s42, 0
    s_add_u32 s37, s43, s36
    v_permlane32_swap_b32 v28, v30
    v_permlane32_swap_b32 v29, v31
    buffer_store_dwordx4 v[28:31], v9, s[12:15], s37 offen sc1
    s_mul_i32 s36, s42, 0
    s_add_u32 s37, s43, s36
    buffer_store_dwordx2 v[32:33], v13, s[12:15], s37 offen offset:1024 sc1
    s_waitcnt lgkmcnt(8)
    v_mfma_f32_32x32x16_bf16 v[60:75], v[92:95], v[172:175], v[60:75]
    ds_read_b64_tr_b16 v[124:125], v8 offset:1280
    ds_read_b64_tr_b16 v[126:127], v8 offset:1792
    ds_read_b64_tr_b16 v[128:129], v8 offset:5376
    ds_read_b64_tr_b16 v[130:131], v8 offset:5888
    ds_read_b64_tr_b16 v[132:133], v8 offset:9472
    ds_read_b64_tr_b16 v[134:135], v8 offset:9984
    ds_read_b64_tr_b16 v[136:137], v8 offset:13568
    ds_read_b64_tr_b16 v[138:139], v8 offset:14080
    s_nop 1
    v_mfma_f32_32x32x16_bf16 v[60:75], v[96:99], v[176:179], v[60:75]
    v_fma_f32 v44, -v253, v204, v44
    v_fma_f32 v45, -v253, v205, v45
    v_fma_f32 v46, -v253, v206, v46
    v_fma_f32 v47, -v253, v207, v47
    v_fma_f32 v48, -v253, v208, v48
    v_fma_f32 v49, -v253, v209, v49
    v_mfma_f32_32x32x16_bf16 v[60:75], v[100:103], v[180:183], v[60:75]
    v_fma_f32 v50, -v253, v210, v50
    v_fma_f32 v51, -v253, v211, v51
    v_fma_f32 v52, -v253, v212, v52
    v_fma_f32 v53, -v253, v213, v53
    v_fma_f32 v54, -v253, v214, v54
    v_fma_f32 v55, -v253, v215, v55
    v_mfma_f32_32x32x16_bf16 v[60:75], v[104:107], v[184:187], v[60:75]
    v_fma_f32 v56, -v253, v216, v56
    v_fma_f32 v57, -v253, v217, v57
    v_fma_f32 v58, -v253, v218, v58
    v_fma_f32 v59, -v253, v219, v59
    v_mul_f32 v44, v252, v44
    s_waitcnt lgkmcnt(8)
    v_mfma_f32_32x32x16_bf16 v[60:75], v[108:111], v[140:143], v[60:75]
    ds_read_b64_tr_b16 v[92:93], v6 offset:1280
    ds_read_b64_tr_b16 v[94:95], v6 offset:1792
    ds_read_b64_tr_b16 v[96:97], v6 offset:5376
    ds_read_b64_tr_b16 v[98:99], v6 offset:5888
    ds_read_b64_tr_b16 v[100:101], v6 offset:9472
    ds_read_b64_tr_b16 v[102:103], v6 offset:9984
    ds_read_b64_tr_b16 v[104:105], v6 offset:13568
    ds_read_b64_tr_b16 v[106:107], v6 offset:14080
    v_mfma_f32_32x32x16_bf16 v[60:75], v[112:115], v[144:147], v[60:75]
    v_mul_f32 v45, v252, v45
    v_mul_f32 v46, v252, v46
    v_mul_f32 v47, v252, v47
    v_mul_f32 v48, v252, v48
    v_mul_f32 v49, v252, v49
    v_mul_f32 v50, v252, v50
    v_mul_f32 v51, v252, v51
    v_mul_f32 v52, v252, v52
    v_mfma_f32_32x32x16_bf16 v[60:75], v[116:119], v[148:151], v[60:75]
    v_mul_f32 v53, v252, v53
    v_mul_f32 v54, v252, v54
    v_mul_f32 v55, v252, v55
    v_mul_f32 v56, v252, v56
    v_mul_f32 v57, v252, v57
    v_mul_f32 v58, v252, v58
    v_mul_f32 v59, v252, v59
    v_cvt_pk_bf16_f32 v36, v44, v45
    v_mfma_f32_32x32x16_bf16 v[60:75], v[120:123], v[152:155], v[60:75]
    v_cvt_pk_bf16_f32 v37, v46, v47
    v_cvt_pk_bf16_f32 v38, v48, v49
    v_cvt_pk_bf16_f32 v39, v50, v51
    v_cvt_pk_bf16_f32 v40, v52, v53
    v_cvt_pk_bf16_f32 v41, v54, v55
    v_cvt_pk_bf16_f32 v42, v56, v57
    v_cvt_pk_bf16_f32 v43, v58, v59
    s_nop 0
    s_mul_i32 s36, s42, 1
    s_add_u32 s37, s43, s36
    v_permlane32_swap_b32 v34, v36
    v_permlane32_swap_b32 v35, v37
    buffer_store_dwordx4 v[34:37], v9, s[12:15], s37 offen sc1
    s_mul_i32 s36, s42, 2
    s_add_u32 s37, s43, s36
    v_permlane32_swap_b32 v38, v40
    v_permlane32_swap_b32 v39, v41
    buffer_store_dwordx4 v[38:41], v9, s[12:15], s37 offen sc1
    s_mul_i32 s36, s42, 2
    s_add_u32 s37, s43, s36
    buffer_store_dwordx2 v[42:43], v13, s[12:15], s37 offen offset:1024 sc1
    s_waitcnt lgkmcnt(8)
    v_mfma_f32_32x32x16_bf16 v[76:91], v[124:127], v[172:175], v[76:91]
    s_nop 9
    v_mfma_f32_32x32x16_bf16 v[76:91], v[128:131], v[176:179], v[76:91]
    v_fma_f32 v60, -v253, v220, v60
    v_fma_f32 v61, -v253, v221, v61
    v_fma_f32 v62, -v253, v222, v62
    v_fma_f32 v63, -v253, v223, v63
    v_fma_f32 v64, -v253, v224, v64
    v_fma_f32 v65, -v253, v225, v65
    v_mfma_f32_32x32x16_bf16 v[76:91], v[132:135], v[180:183], v[76:91]
    v_fma_f32 v66, -v253, v226, v66
    v_fma_f32 v67, -v253, v227, v67
    v_fma_f32 v68, -v253, v228, v68
    v_fma_f32 v69, -v253, v229, v69
    v_fma_f32 v70, -v253, v230, v70
    v_fma_f32 v71, -v253, v231, v71
    v_mfma_f32_32x32x16_bf16 v[76:91], v[136:139], v[184:187], v[76:91]
    v_fma_f32 v72, -v253, v232, v72
    v_fma_f32 v73, -v253, v233, v73
    v_fma_f32 v74, -v253, v234, v74
    v_fma_f32 v75, -v253, v235, v75
    v_mul_f32 v60, v252, v60
    s_waitcnt lgkmcnt(0)
    v_mfma_f32_32x32x16_bf16 v[76:91], v[92:95], v[140:143], v[76:91]
    v_mul_f32 v61, v252, v61
    v_mul_f32 v62, v252, v62
    v_mul_f32 v63, v252, v63
    v_mul_f32 v64, v252, v64
    v_mul_f32 v65, v252, v65
    v_mul_f32 v66, v252, v66
    v_mfma_f32_32x32x16_bf16 v[76:91], v[96:99], v[144:147], v[76:91]
    v_mul_f32 v67, v252, v67
    v_mul_f32 v68, v252, v68
    v_mul_f32 v69, v252, v69
    v_mul_f32 v70, v252, v70
    v_mul_f32 v71, v252, v71
    v_mul_f32 v72, v252, v72
    v_mfma_f32_32x32x16_bf16 v[76:91], v[100:103], v[148:151], v[76:91]
    v_mul_f32 v73, v252, v73
    v_mul_f32 v74, v252, v74
    v_mul_f32 v75, v252, v75
    v_cvt_pk_bf16_f32 v44, v60, v61
    v_cvt_pk_bf16_f32 v45, v62, v63
    v_cvt_pk_bf16_f32 v46, v64, v65
    v_mfma_f32_32x32x16_bf16 v[76:91], v[104:107], v[152:155], v[76:91]
    v_cvt_pk_bf16_f32 v47, v66, v67
    v_cvt_pk_bf16_f32 v48, v68, v69
    v_cvt_pk_bf16_f32 v49, v70, v71
    v_cvt_pk_bf16_f32 v50, v72, v73
    v_cvt_pk_bf16_f32 v51, v74, v75
    s_nop 0
    s_mul_i32 s36, s42, 3
    s_add_u32 s37, s43, s36
    v_permlane32_swap_b32 v44, v46
    v_permlane32_swap_b32 v45, v47
    buffer_store_dwordx4 v[44:47], v9, s[12:15], s37 offen sc1
    s_mul_i32 s36, s42, 4
    s_add_u32 s37, s43, s36
    v_permlane32_swap_b32 v48, v50
    v_permlane32_swap_b32 v49, v51
    buffer_store_dwordx4 v[48:51], v9, s[12:15], s37 offen sc1
    s_nop 7
    v_pk_fma_f32 v[76:77], v[252:253], v[236:237], v[76:77] op_sel:[1,0,0] op_sel_hi:[1,1,1] neg_lo:[1,0,0] neg_hi:[1,0,0]
    v_pk_fma_f32 v[78:79], v[252:253], v[238:239], v[78:79] op_sel:[1,0,0] op_sel_hi:[1,1,1] neg_lo:[1,0,0] neg_hi:[1,0,0]
    v_pk_fma_f32 v[80:81], v[252:253], v[240:241], v[80:81] op_sel:[1,0,0] op_sel_hi:[1,1,1] neg_lo:[1,0,0] neg_hi:[1,0,0]
    v_pk_fma_f32 v[82:83], v[252:253], v[242:243], v[82:83] op_sel:[1,0,0] op_sel_hi:[1,1,1] neg_lo:[1,0,0] neg_hi:[1,0,0]
    v_pk_fma_f32 v[84:85], v[252:253], v[244:245], v[84:85] op_sel:[1,0,0] op_sel_hi:[1,1,1] neg_lo:[1,0,0] neg_hi:[1,0,0]
    v_pk_fma_f32 v[86:87], v[252:253], v[246:247], v[86:87] op_sel:[1,0,0] op_sel_hi:[1,1,1] neg_lo:[1,0,0] neg_hi:[1,0,0]
    v_pk_fma_f32 v[88:89], v[252:253], v[248:249], v[88:89] op_sel:[1,0,0] op_sel_hi:[1,1,1] neg_lo:[1,0,0] neg_hi:[1,0,0]
    v_pk_fma_f32 v[90:91], v[252:253], v[250:251], v[90:91] op_sel:[1,0,0] op_sel_hi:[1,1,1] neg_lo:[1,0,0] neg_hi:[1,0,0]
    v_pk_mul_f32 v[76:77], v[252:253], v[76:77] op_sel_hi:[0,1]
    v_pk_mul_f32 v[78:79], v[252:253], v[78:79] op_sel_hi:[0,1]
    v_pk_mul_f32 v[80:81], v[252:253], v[80:81] op_sel_hi:[0,1]
    v_pk_mul_f32 v[82:83], v[252:253], v[82:83] op_sel_hi:[0,1]
    v_pk_mul_f32 v[84:85], v[252:253], v[84:85] op_sel_hi:[0,1]
    v_pk_mul_f32 v[86:87], v[252:253], v[86:87] op_sel_hi:[0,1]
    v_pk_mul_f32 v[88:89], v[252:253], v[88:89] op_sel_hi:[0,1]
    v_pk_mul_f32 v[90:91], v[252:253], v[90:91] op_sel_hi:[0,1]
    v_cvt_pk_bf16_f32 v52, v76, v77
    v_cvt_pk_bf16_f32 v53, v78, v79
    v_cvt_pk_bf16_f32 v54, v80, v81
    v_cvt_pk_bf16_f32 v55, v82, v83
    v_cvt_pk_bf16_f32 v56, v84, v85
    v_cvt_pk_bf16_f32 v57, v86, v87
    v_cvt_pk_bf16_f32 v58, v88, v89
    v_cvt_pk_bf16_f32 v59, v90, v91
    s_nop 0
    s_mul_i32 s36, s42, 4
    s_add_u32 s37, s43, s36
    buffer_store_dwordx2 v[52:53], v13, s[12:15], s37 offen offset:1024 sc1
    s_mul_i32 s36, s42, 5
    s_add_u32 s37, s43, s36
    v_permlane32_swap_b32 v54, v56
    v_permlane32_swap_b32 v55, v57
    buffer_store_dwordx4 v[54:57], v9, s[12:15], s37 offen sc1
    s_mul_i32 s36, s42, 6
    s_add_u32 s37, s43, s36
    v_mov_b32 v20, v58
    v_mov_b32 v21, v59
    v_mov_b32 v22, v58
    v_mov_b32 v23, v59
    s_nop 1
    v_permlane32_swap_b32 v20, v22
    v_permlane32_swap_b32 v21, v23
    buffer_store_dwordx4 v[20:23], v12, s[12:15], s37 offen offset:0 sc1
    s_branch tl_qsig
tl_qs_1:
    s_waitcnt lgkmcnt(8)
    v_mfma_f32_32x32x16_bf16 v[44:59], v[108:111], v[172:175], v[44:59]
    ds_read_b64_tr_b16 v[92:93], v8 offset:1024
    ds_read_b64_tr_b16 v[94:95], v8 offset:1536
    ds_read_b64_tr_b16 v[96:97], v8 offset:5120
    ds_read_b64_tr_b16 v[98:99], v8 offset:5632
    ds_read_b64_tr_b16 v[100:101], v8 offset:9216
    ds_read_b64_tr_b16 v[102:103], v8 offset:9728
    ds_read_b64_tr_b16 v[104:105], v8 offset:13312
    ds_read_b64_tr_b16 v[106:107], v8 offset:13824
    s_nop 1
    v_mfma_f32_32x32x16_bf16 v[44:59], v[112:115], v[176:179], v[44:59]
    v_fma_f32 v28, -v253, v188, v28
    v_fma_f32 v29, -v253, v189, v29
    v_fma_f32 v30, -v253, v190, v30
    v_fma_f32 v31, -v253, v191, v31
    v_fma_f32 v32, -v253, v192, v32
    v_fma_f32 v33, -v253, v193, v33
    v_mfma_f32_32x32x16_bf16 v[44:59], v[116:119], v[180:183], v[44:59]
    v_fma_f32 v34, -v253, v194, v34
    v_fma_f32 v35, -v253, v195, v35
    v_fma_f32 v36, -v253, v196, v36
    v_fma_f32 v37, -v253, v197, v37
    v_fma_f32 v38, -v253, v198, v38
    v_fma_f32 v39, -v253, v199, v39
    v_mfma_f32_32x32x16_bf16 v[44:59], v[120:123], v[184:187], v[44:59]
    v_fma_f32 v40, -v253, v200, v40
    v_fma_f32 v41, -v253, v201, v41
    v_fma_f32 v42, -v253, v202, v42
    v_fma_f32 v43, -v253, v203, v43
    v_mul_f32 v28, v252, v28
    s_waitcnt lgkmcnt(8)
    v_mfma_f32_32x32x16_bf16 v[44:59], v[124:127], v[140:143], v[44:59]
    ds_read_b64_tr_b16 v[108:109], v6 offset:1024
    ds_read_b64_tr_b16 v[110:111], v6 offset:1536
    ds_read_b64_tr_b16 v[112:113], v6 offset:5120
    ds_read_b64_tr_b16 v[114:115], v6 offset:5632
    ds_read_b64_tr_b16 v[116:117], v6 offset:9216
    ds_read_b64_tr_b16 v[118:119], v6 offset:9728
    ds_read_b64_tr_b16 v[120:121], v6 offset:13312
    ds_read_b64_tr_b16 v[122:123], v6 offset:13824
    v_mfma_f32_32x32x16_bf16 v[44:59], v[128:131], v[144:147], v[44:59]
    v_mul_f32 v29, v252, v29
    v_mul_f32 v30, v252, v30
    v_mul_f32 v31, v252, v31
    v_mul_f32 v32, v252, v32
    v_mul_f32 v33, v252, v33
    v_mul_f32 v34, v252, v34
    v_mul_f32 v35, v252, v35
    v_mul_f32 v36, v252, v36
    v_mfma_f32_32x32x16_bf16 v[44:59], v[132:135], v[148:151], v[44:59]
    v_mul_f32 v37, v252, v37
    v_mul_f32 v38, v252, v38
    v_mul_f32 v39, v252, v39
    v_mul_f32 v40, v252, v40
    v_mul_f32 v41, v252, v41
    v_mul_f32 v42, v252, v42
    v_mul_f32 v43, v252, v43
    v_cvt_pk_bf16_f32 v28, v28, v29
    v_mfma_f32_32x32x16_bf16 v[44:59], v[136:139], v[152:155], v[44:59]
    v_cvt_pk_bf16_f32 v29, v30, v31
    v_cvt_pk_bf16_f32 v30, v32, v33
    v_cvt_pk_bf16_f32 v31, v34, v35
    v_cvt_pk_bf16_f32 v32, v36, v37
    v_cvt_pk_bf16_f32 v33, v38, v39
    v_cvt_pk_bf16_f32 v34, v40, v41
    v_cvt_pk_bf16_f32 v35, v42, v43
    s_nop 0
    s_mul_i32 s36, s42, 0
    s_add_u32 s37, s43, s36
    v_mov_b32 v16, v28
    v_mov_b32 v17, v29
    v_mov_b32 v18, v28
    v_mov_b32 v19, v29
    s_nop 1
    v_permlane32_swap_b32 v16, v18
    v_permlane32_swap_b32 v17, v19
    buffer_store_dwordx4 v[16:19], v12, s[12:15], s37 offen offset:512 sc1
    s_mul_i32 s36, s42, 0
    s_add_u32 s37, s43, s36
    buffer_store_dwordx2 v[30:31], v13, s[12:15], s37 offen offset:1024 sc1
    s_mul_i32 s36, s42, 1
    s_add_u32 s37, s43, s36
    v_permlane32_swap_b32 v32, v34
    v_permlane32_swap_b32 v33, v35
    buffer_store_dwordx4 v[32:35], v9, s[12:15], s37 offen sc1
    s_waitcnt lgkmcnt(8)
    v_mfma_f32_32x32x16_bf16 v[60:75], v[92:95], v[172:175], v[60:75]
    ds_read_b64_tr_b16 v[124:125], v8 offset:1280
    ds_read_b64_tr_b16 v[126:127], v8 offset:1792
    ds_read_b64_tr_b16 v[128:129], v8 offset:5376
    ds_read_b64_tr_b16 v[130:131], v8 offset:5888
    ds_read_b64_tr_b16 v[132:133], v8 offset:9472
    ds_read_b64_tr_b16 v[134:135], v8 offset:9984
    ds_read_b64_tr_b16 v[136:137], v8 offset:13568
    ds_read_b64_tr_b16 v[138:139], v8 offset:14080
    s_nop 1
    v_mfma_f32_32x32x16_bf16 v[60:75], v[96:99], v[176:179], v[60:75]
    v_fma_f32 v44, -v253, v204, v44
    v_fma_f32 v45, -v253, v205, v45
    v_fma_f32 v46, -v253, v206, v46
    v_fma_f32 v47, -v253, v207, v47
    v_fma_f32 v48, -v253, v208, v48
    v_fma_f32 v49, -v253, v209, v49
    v_mfma_f32_32x32x16_bf16 v[60:75], v[100:103], v[180:183], v[60:75]
    v_fma_f32 v50, -v253, v210, v50
    v_fma_f32 v51, -v253, v211, v51
    v_fma_f32 v52, -v253, v212, v52
    v_fma_f32 v53, -v253, v213, v53
    v_fma_f32 v54, -v253, v214, v54
    v_fma_f32 v55, -v253, v215, v55
    v_mfma_f32_32x32x16_bf16 v[60:75], v[104:107], v[184:187], v[60:75]
    v_fma_f32 v56, -v253, v216, v56
    v_fma_f32 v57, -v253, v217, v57
    v_fma_f32 v58, -v253, v218, v58
    v_fma_f32 v59, -v253, v219, v59
    v_mul_f32 v44, v252, v44
    s_waitcnt lgkmcnt(8)
    v_mfma_f32_32x32x16_bf16 v[60:75], v[108:111], v[140:143], v[60:75]
    ds_read_b64_tr_b16 v[92:93], v6 offset:1280
    ds_read_b64_tr_b16 v[94:95], v6 offset:1792
    ds_read_b64_tr_b16 v[96:97], v6 offset:5376
    ds_read_b64_tr_b16 v[98:99], v6 offset:5888
    ds_read_b64_tr_b16 v[100:101], v6 offset:9472
    ds_read_b64_tr_b16 v[102:103], v6 offset:9984
    ds_read_b64_tr_b16 v[104:105], v6 offset:13568
    ds_read_b64_tr_b16 v[106:107], v6 offset:14080
    v_mfma_f32_32x32x16_bf16 v[60:75], v[112:115], v[144:147], v[60:75]
    v_mul_f32 v45, v252, v45
    v_mul_f32 v46, v252, v46
    v_mul_f32 v47, v252, v47
    v_mul_f32 v48, v252, v48
    v_mul_f32 v49, v252, v49
    v_mul_f32 v50, v252, v50
    v_mul_f32 v51, v252, v51
    v_mul_f32 v52, v252, v52
    v_mfma_f32_32x32x16_bf16 v[60:75], v[116:119], v[148:151], v[60:75]
    v_mul_f32 v53, v252, v53
    v_mul_f32 v54, v252, v54
    v_mul_f32 v55, v252, v55
    v_mul_f32 v56, v252, v56
    v_mul_f32 v57, v252, v57
    v_mul_f32 v58, v252, v58
    v_mul_f32 v59, v252, v59
    v_cvt_pk_bf16_f32 v36, v44, v45
    v_mfma_f32_32x32x16_bf16 v[60:75], v[120:123], v[152:155], v[60:75]
    v_cvt_pk_bf16_f32 v37, v46, v47
    v_cvt_pk_bf16_f32 v38, v48, v49
    v_cvt_pk_bf16_f32 v39, v50, v51
    v_cvt_pk_bf16_f32 v40, v52, v53
    v_cvt_pk_bf16_f32 v41, v54, v55
    v_cvt_pk_bf16_f32 v42, v56, v57
    v_cvt_pk_bf16_f32 v43, v58, v59
    s_nop 0
    s_mul_i32 s36, s42, 2
    s_add_u32 s37, s43, s36
    v_permlane32_swap_b32 v36, v38
    v_permlane32_swap_b32 v37, v39
    buffer_store_dwordx4 v[36:39], v9, s[12:15], s37 offen sc1
    s_mul_i32 s36, s42, 2
    s_add_u32 s37, s43, s36
    buffer_store_dwordx2 v[40:41], v13, s[12:15], s37 offen offset:1024 sc1
    s_waitcnt lgkmcnt(8)
    v_mfma_f32_32x32x16_bf16 v[76:91], v[124:127], v[172:175], v[76:91]
    s_nop 9
    v_mfma_f32_32x32x16_bf16 v[76:91], v[128:131], v[176:179], v[76:91]
    v_fma_f32 v60, -v253, v220, v60
    v_fma_f32 v61, -v253, v221, v61
    v_fma_f32 v62, -v253, v222, v62
    v_fma_f32 v63, -v253, v223, v63
    v_fma_f32 v64, -v253, v224, v64
    v_fma_f32 v65, -v253, v225, v65
    v_mfma_f32_32x32x16_bf16 v[76:91], v[132:135], v[180:183], v[76:91]
    v_fma_f32 v66, -v253, v226, v66
    v_fma_f32 v67, -v253, v227, v67
    v_fma_f32 v68, -v253, v228, v68
    v_fma_f32 v69, -v253, v229, v69
    v_fma_f32 v70, -v253, v230, v70
    v_fma_f32 v71, -v253, v231, v71
    v_mfma_f32_32x32x16_bf16 v[76:91], v[136:139], v[184:187], v[76:91]
    v_fma_f32 v72, -v253, v232, v72
    v_fma_f32 v73, -v253, v233, v73
    v_fma_f32 v74, -v253, v234, v74
    v_fma_f32 v75, -v253, v235, v75
    v_mul_f32 v60, v252, v60
    s_waitcnt lgkmcnt(0)
    v_mfma_f32_32x32x16_bf16 v[76:91], v[92:95], v[140:143], v[76:91]
    v_mul_f32 v61, v252, v61
    v_mul_f32 v62, v252, v62
    v_mul_f32 v63, v252, v63
    v_mul_f32 v64, v252, v64
    v_mul_f32 v65, v252, v65
    v_mul_f32 v66, v252, v66
    v_mfma_f32_32x32x16_bf16 v[76:91], v[96:99], v[144:147], v[76:91]
    v_mul_f32 v67, v252, v67
    v_mul_f32 v68, v252, v68
    v_mul_f32 v69, v252, v69
    v_mul_f32 v70, v252, v70
    v_mul_f32 v71, v252, v71
    v_mul_f32 v72, v252, v72
    v_mfma_f32_32x32x16_bf16 v[76:91], v[100:103], v[148:151], v[76:91]
    v_mul_f32 v73, v252, v73
    v_mul_f32 v74, v252, v74
    v_mul_f32 v75, v252, v75
    v_cvt_pk_bf16_f32 v44, v60, v61
    v_cvt_pk_bf16_f32 v45, v62, v63
    v_cvt_pk_bf16_f32 v46, v64, v65
    v_mfma_f32_32x32x16_bf16 v[76:91], v[104:107], v[152:155], v[76:91]
    v_cvt_pk_bf16_f32 v47, v66, v67
    v_cvt_pk_bf16_f32 v48, v68, v69
    v_cvt_pk_bf16_f32 v49, v70, v71
    v_cvt_pk_bf16_f32 v50, v72, v73
    v_cvt_pk_bf16_f32 v51, v74, v75
    s_nop 0
    s_mul_i32 s36, s42, 3
    s_add_u32 s37, s43, s36
    v_permlane32_swap_b32 v42, v44
    v_permlane32_swap_b32 v43, v45
    buffer_store_dwordx4 v[42:45], v9, s[12:15], s37 offen sc1
    s_mul_i32 s36, s42, 4
    s_add_u32 s37, s43, s36
    v_permlane32_swap_b32 v46, v48
    v_permlane32_swap_b32 v47, v49
    buffer_store_dwordx4 v[46:49], v9, s[12:15], s37 offen sc1
    s_mul_i32 s36, s42, 4
    s_add_u32 s37, s43, s36
    buffer_store_dwordx2 v[50:51], v13, s[12:15], s37 offen offset:1024 sc1
    s_nop 7
    v_pk_fma_f32 v[76:77], v[252:253], v[236:237], v[76:77] op_sel:[1,0,0] op_sel_hi:[1,1,1] neg_lo:[1,0,0] neg_hi:[1,0,0]
    v_pk_fma_f32 v[78:79], v[252:253], v[238:239], v[78:79] op_sel:[1,0,0] op_sel_hi:[1,1,1] neg_lo:[1,0,0] neg_hi:[1,0,0]
    v_pk_fma_f32 v[80:81], v[252:253], v[240:241], v[80:81] op_sel:[1,0,0] op_sel_hi:[1,1,1] neg_lo:[1,0,0] neg_hi:[1,0,0]
    v_pk_fma_f32 v[82:83], v[252:253], v[242:243], v[82:83] op_sel:[1,0,0] op_sel_hi:[1,1,1] neg_lo:[1,0,0] neg_hi:[1,0,0]
    v_pk_fma_f32 v[84:85], v[252:253], v[244:245], v[84:85] op_sel:[1,0,0] op_sel_hi:[1,1,1] neg_lo:[1,0,0] neg_hi:[1,0,0]
    v_pk_fma_f32 v[86:87], v[252:253], v[246:247], v[86:87] op_sel:[1,0,0] op_sel_hi:[1,1,1] neg_lo:[1,0,0] neg_hi:[1,0,0]
    v_pk_fma_f32 v[88:89], v[252:253], v[248:249], v[88:89] op_sel:[1,0,0] op_sel_hi:[1,1,1] neg_lo:[1,0,0] neg_hi:[1,0,0]
    v_pk_fma_f32 v[90:91], v[252:253], v[250:251], v[90:91] op_sel:[1,0,0] op_sel_hi:[1,1,1] neg_lo:[1,0,0] neg_hi:[1,0,0]
    v_pk_mul_f32 v[76:77], v[252:253], v[76:77] op_sel_hi:[0,1]
    v_pk_mul_f32 v[78:79], v[252:253], v[78:79] op_sel_hi:[0,1]
    v_pk_mul_f32 v[80:81], v[252:253], v[80:81] op_sel_hi:[0,1]
    v_pk_mul_f32 v[82:83], v[252:253], v[82:83] op_sel_hi:[0,1]
    v_pk_mul_f32 v[84:85], v[252:253], v[84:85] op_sel_hi:[0,1]
    v_pk_mul_f32 v[86:87], v[252:253], v[86:87] op_sel_hi:[0,1]
    v_pk_mul_f32 v[88:89], v[252:253], v[88:89] op_sel_hi:[0,1]
    v_pk_mul_f32 v[90:91], v[252:253], v[90:91] op_sel_hi:[0,1]
    v_cvt_pk_bf16_f32 v52, v76, v77
    v_cvt_pk_bf16_f32 v53, v78, v79
    v_cvt_pk_bf16_f32 v54, v80, v81
    v_cvt_pk_bf16_f32 v55, v82, v83
    v_cvt_pk_bf16_f32 v56, v84, v85
    v_cvt_pk_bf16_f32 v57, v86, v87
    v_cvt_pk_bf16_f32 v58, v88, v89
    v_cvt_pk_bf16_f32 v59, v90, v91
    s_nop 0
    s_mul_i32 s36, s42, 5
    s_add_u32 s37, s43, s36
    v_permlane32_swap_b32 v52, v54
    v_permlane32_swap_b32 v53, v55
    buffer_store_dwordx4 v[52:55], v9, s[12:15], s37 offen sc1
    s_mul_i32 s36, s42, 6
    s_add_u32 s37, s43, s36
    v_permlane32_swap_b32 v56, v58
    v_permlane32_swap_b32 v57, v59
    buffer_store_dwordx4 v[56:59], v9, s[12:15], s37 offen sc1
    s_branch tl_qsig
tl_qs_2:
    s_waitcnt lgkmcnt(8)
    v_mfma_f32_32x32x16_bf16 v[44:59], v[108:111], v[172:175], v[44:59]
    ds_read_b64_tr_b16 v[92:93], v8 offset:1024
    ds_read_b64_tr_b16 v[94:95], v8 offset:1536
    ds_read_b64_tr_b16 v[96:97], v8 offset:5120
    ds_read_b64_tr_b16 v[98:99], v8 offset:5632
    ds_read_b64_tr_b16 v[100:101], v8 offset:9216
    ds_read_b64_tr_b16 v[102:103], v8 offset:9728
    ds_read_b64_tr_b16 v[104:105], v8 offset:13312
    ds_read_b64_tr_b16 v[106:107], v8 offset:13824
    s_nop 1
    v_mfma_f32_32x32x16_bf16 v[44:59], v[112:115], v[176:179], v[44:59]
    v_fma_f32 v28, -v253, v188, v28
    v_fma_f32 v29, -v253, v189, v29
    v_fma_f32 v30, -v253, v190, v30
    v_fma_f32 v31, -v253, v191, v31
    v_fma_f32 v32, -v253, v192, v32
    v_fma_f32 v33, -v253, v193, v33
    v_mfma_f32_32x32x16_bf16 v[44:59], v[116:119], v[180:183], v[44:59]
    v_fma_f32 v34, -v253, v194, v34
    v_fma_f32 v35, -v253, v195, v35
    v_fma_f32 v36, -v253, v196, v36
    v_fma_f32 v37, -v253, v197, v37
    v_fma_f32 v38, -v253, v198, v38
    v_fma_f32 v39, -v253, v199, v39
    v_mfma_f32_32x32x16_bf16 v[44:59], v[120:123], v[184:187], v[44:59]
    v_fma_f32 v40, -v253, v200, v40
    v_fma_f32 v41, -v253, v201, v41
    v_fma_f32 v42, -v253, v202, v42
    v_fma_f32 v43, -v253, v203, v43
    v_mul_f32 v28, v252, v28
    s_waitcnt lgkmcnt(8)
    v_mfma_f32_32x32x16_bf16 v[44:59], v[124:127], v[140:143], v[44:59]
    ds_read_b64_tr_b16 v[108:109], v6 offset:1024
    ds_read_b64_tr_b16 v[110:111], v6 offset:1536
    ds_read_b64_tr_b16 v[112:113], v6 offset:5120
    ds_read_b64_tr_b16 v[114:115], v6 offset:5632
    ds_read_b64_tr_b16 v[116:117], v6 offset:9216
    ds_read_b64_tr_b16 v[118:119], v6 offset:9728
    ds_read_b64_tr_b16 v[120:121], v6 offset:13312
    ds_read_b64_tr_b16 v[122:123], v6 offset:13824
    v_mfma_f32_32x32x16_bf16 v[44:59], v[128:131], v[144:147], v[44:59]
    v_mul_f32 v29, v252, v29
    v_mul_f32 v30, v252, v30
    v_mul_f32 v31, v252, v31
    v_mul_f32 v32, v252, v32
    v_mul_f32 v33, v252, v33
    v_mul_f32 v34, v252, v34
    v_mul_f32 v35, v252, v35
    v_mul_f32 v36, v252, v36
    v_mfma_f32_32x32x16_bf16 v[44:59], v[132:135], v[148:151], v[44:59]
    v_mul_f32 v37, v252, v37
    v_mul_f32 v38, v252, v38
    v_mul_f32 v39, v252, v39
    v_mul_f32 v40, v252, v40
    v_mul_f32 v41, v252, v41
    v_mul_f32 v42, v252, v42
    v_mul_f32 v43, v252, v43
    v_cvt_pk_bf16_f32 v28, v28, v29
    v_mfma_f32_32x32x16_bf16 v[44:59], v[136:139], v[152:155], v[44:59]
    v_cvt_pk_bf16_f32 v29, v30, v31
    v_cvt_pk_bf16_f32 v30, v32, v33
    v_cvt_pk_bf16_f32 v31, v34, v35
    v_cvt_pk_bf16_f32 v32, v36, v37
    v_cvt_pk_bf16_f32 v33, v38, v39
    v_cvt_pk_bf16_f32 v34, v40, v41
    v_cvt_pk_bf16_f32 v35, v42, v43
    s_nop 0
    s_mul_i32 s36, s42, 0
    s_add_u32 s37, s43, s36
    buffer_store_dwordx2 v[28:29], v13, s[12:15], s37 offen offset:1024 sc1
    s_mul_i32 s36, s42, 1
    s_add_u32 s37, s43, s36
    v_permlane32_swap_b32 v30, v32
    v_permlane32_swap_b32 v31, v33
    buffer_store_dwordx4 v[30:33], v9, s[12:15], s37 offen sc1
    s_waitcnt lgkmcnt(8)
    v_mfma_f32_32x32x16_bf16 v[60:75], v[92:95], v[172:175], v[60:75]
    ds_read_b64_tr_b16 v[124:125], v8 offset:1280
    ds_read_b64_tr_b16 v[126:127], v8 offset:1792
    ds_read_b64_tr_b16 v[128:129], v8 offset:5376
    ds_read_b64_tr_b16 v[130:131], v8 offset:5888
    ds_read_b64_tr_b16 v[132:133], v8 offset:9472
    ds_read_b64_tr_b16 v[134:135], v8 offset:9984
    ds_read_b64_tr_b16 v[136:137], v8 offset:13568
    ds_read_b64_tr_b16 v[138:139], v8 offset:14080
    s_nop 1
    v_mfma_f32_32x32x16_bf16 v[60:75], v[96:99], v[176:179], v[60:75]
    v_fma_f32 v44, -v253, v204, v44
    v_fma_f32 v45, -v253, v205, v45
    v_fma_f32 v46, -v253, v206, v46
    v_fma_f32 v47, -v253, v207, v47
    v_fma_f32 v48, -v253, v208, v48
    v_fma_f32 v49, -v253, v209, v49
    v_mfma_f32_32x32x16_bf16 v[60:75], v[100:103], v[180:183], v[60:75]
    v_fma_f32 v50, -v253, v210, v50
    v_fma_f32 v51, -v253, v211, v51
    v_fma_f32 v52, -v253, v212, v52
    v_fma_f32 v53, -v253, v213, v53
    v_fma_f32 v54, -v253, v214, v54
    v_fma_f32 v55, -v253, v215, v55
    v_mfma_f32_32x32x16_bf16 v[60:75], v[104:107], v[184:187], v[60:75]
    v_fma_f32 v56, -v253, v216, v56
    v_fma_f32 v57, -v253, v217, v57
    v_fma_f32 v58, -v253, v218, v58
    v_fma_f32 v59, -v253, v219, v59
    v_mul_f32 v44, v252, v44
    s_waitcnt lgkmcnt(8)
    v_mfma_f32_32x32x16_bf16 v[60:75], v[108:111], v[140:143], v[60:75]
    ds_read_b64_tr_b16 v[92:93], v6 offset:1280
    ds_read_b64_tr_b16 v[94:95], v6 offset:1792
    ds_read_b64_tr_b16 v[96:97], v6 offset:5376
    ds_read_b64_tr_b16 v[98:99], v6 offset:5888
    ds_read_b64_tr_b16 v[100:101], v6 offset:9472
    ds_read_b64_tr_b16 v[102:103], v6 offset:9984
    ds_read_b64_tr_b16 v[104:105], v6 offset:13568
    ds_read_b64_tr_b16 v[106:107], v6 offset:14080
    v_mfma_f32_32x32x16_bf16 v[60:75], v[112:115], v[144:147], v[60:75]
    v_mul_f32 v45, v252, v45
    v_mul_f32 v46, v252, v46
    v_mul_f32 v47, v252, v47
    v_mul_f32 v48, v252, v48
    v_mul_f32 v49, v252, v49
    v_mul_f32 v50, v252, v50
    v_mul_f32 v51, v252, v51
    v_mul_f32 v52, v252, v52
    v_mfma_f32_32x32x16_bf16 v[60:75], v[116:119], v[148:151], v[60:75]
    v_mul_f32 v53, v252, v53
    v_mul_f32 v54, v252, v54
    v_mul_f32 v55, v252, v55
    v_mul_f32 v56, v252, v56
    v_mul_f32 v57, v252, v57
    v_mul_f32 v58, v252, v58
    v_mul_f32 v59, v252, v59
    v_cvt_pk_bf16_f32 v36, v44, v45
    v_mfma_f32_32x32x16_bf16 v[60:75], v[120:123], v[152:155], v[60:75]
    v_cvt_pk_bf16_f32 v37, v46, v47
    v_cvt_pk_bf16_f32 v38, v48, v49
    v_cvt_pk_bf16_f32 v39, v50, v51
    v_cvt_pk_bf16_f32 v40, v52, v53
    v_cvt_pk_bf16_f32 v41, v54, v55
    v_cvt_pk_bf16_f32 v42, v56, v57
    v_cvt_pk_bf16_f32 v43, v58, v59
    s_nop 0
    s_mul_i32 s36, s42, 2
    s_add_u32 s37, s43, s36
    v_permlane32_swap_b32 v34, v36
    v_permlane32_swap_b32 v35, v37
    buffer_store_dwordx4 v[34:37], v9, s[12:15], s37 offen sc1
    s_mul_i32 s36, s42, 2
    s_add_u32 s37, s43, s36
    buffer_store_dwordx2 v[38:39], v13, s[12:15], s37 offen offset:1024 sc1
    s_mul_i32 s36, s42, 3
    s_add_u32 s37, s43, s36
    v_permlane32_swap_b32 v40, v42
    v_permlane32_swap_b32 v41, v43
    buffer_store_dwordx4 v[40:43], v9, s[12:15], s37 offen sc1
    s_waitcnt lgkmcnt(8)
    v_mfma_f32_32x32x16_bf16 v[76:91], v[124:127], v[172:175], v[76:91]
    s_nop 9
    v_mfma_f32_32x32x16_bf16 v[76:91], v[128:131], v[176:179], v[76:91]
    v_fma_f32 v60, -v253, v220, v60
    v_fma_f32 v61, -v253, v221, v61
    v_fma_f32 v62, -v253, v222, v62
    v_fma_f32 v63, -v253, v223, v63
    v_fma_f32 v64, -v253, v224, v64
    v_fma_f32 v65, -v253, v225, v65
    v_mfma_f32_32x32x16_bf16 v[76:91], v[132:135], v[180:183], v[76:91]
    v_fma_f32 v66, -v253, v226, v66
    v_fma_f32 v67, -v253, v227, v67
    v_fma_f32 v68, -v253, v228, v68
    v_fma_f32 v69, -v253, v229, v69
    v_fma_f32 v70, -v253, v230, v70
    v_fma_f32 v71, -v253, v231, v71
    v_mfma_f32_32x32x16_bf16 v[76:91], v[136:139], v[184:187], v[76:91]
    v_fma_f32 v72, -v253, v232, v72
    v_fma_f32 v73, -v253, v233, v73
    v_fma_f32 v74, -v253, v234, v74
    v_fma_f32 v75, -v253, v235, v75
    v_mul_f32 v60, v252, v60
    s_waitcnt lgkmcnt(0)
    v_mfma_f32_32x32x16_bf16 v[76:91], v[92:95], v[140:143], v[76:91]
    v_mul_f32 v61, v252, v61
    v_mul_f32 v62, v252, v62
    v_mul_f32 v63, v252, v63
    v_mul_f32 v64, v252, v64
    v_mul_f32 v65, v252, v65
    v_mul_f32 v66, v252, v66
    v_mfma_f32_32x32x16_bf16 v[76:91], v[96:99], v[144:147], v[76:91]
    v_mul_f32 v67, v252, v67
    v_mul_f32 v68, v252, v68
    v_mul_f32 v69, v252, v69
    v_mul_f32 v70, v252, v70
    v_mul_f32 v71, v252, v71
    v_mul_f32 v72, v252, v72
    v_mfma_f32_32x32x16_bf16 v[76:91], v[100:103], v[148:151], v[76:91]
    v_mul_f32 v73, v252, v73
    v_mul_f32 v74, v252, v74
    v_mul_f32 v75, v252, v75
    v_cvt_pk_bf16_f32 v44, v60, v61
    v_cvt_pk_bf16_f32 v45, v62, v63
    v_cvt_pk_bf16_f32 v46, v64, v65
    v_mfma_f32_32x32x16_bf16 v[76:91], v[104:107], v[152:155], v[76:91]
    v_cvt_pk_bf16_f32 v47, v66, v67
    v_cvt_pk_bf16_f32 v48, v68, v69
    v_cvt_pk_bf16_f32 v49, v70, v71
    v_cvt_pk_bf16_f32 v50, v72, v73
    v_cvt_pk_bf16_f32 v51, v74, v75
    s_nop 0
    s_mul_i32 s36, s42, 4
    s_add_u32 s37, s43, s36
    v_permlane32_swap_b32 v44, v46
    v_permlane32_swap_b32 v45, v47
    buffer_store_dwordx4 v[44:47], v9, s[12:15], s37 offen sc1
    s_mul_i32 s36, s42, 4
    s_add_u32 s37, s43, s36
    buffer_store_dwordx2 v[48:49], v13, s[12:15], s37 offen offset:1024 sc1
    s_nop 7
    v_pk_fma_f32 v[76:77], v[252:253], v[236:237], v[76:77] op_sel:[1,0,0] op_sel_hi:[1,1,1] neg_lo:[1,0,0] neg_hi:[1,0,0]
    v_pk_fma_f32 v[78:79], v[252:253], v[238:239], v[78:79] op_sel:[1,0,0] op_sel_hi:[1,1,1] neg_lo:[1,0,0] neg_hi:[1,0,0]
    v_pk_fma_f32 v[80:81], v[252:253], v[240:241], v[80:81] op_sel:[1,0,0] op_sel_hi:[1,1,1] neg_lo:[1,0,0] neg_hi:[1,0,0]
    v_pk_fma_f32 v[82:83], v[252:253], v[242:243], v[82:83] op_sel:[1,0,0] op_sel_hi:[1,1,1] neg_lo:[1,0,0] neg_hi:[1,0,0]
    v_pk_fma_f32 v[84:85], v[252:253], v[244:245], v[84:85] op_sel:[1,0,0] op_sel_hi:[1,1,1] neg_lo:[1,0,0] neg_hi:[1,0,0]
    v_pk_fma_f32 v[86:87], v[252:253], v[246:247], v[86:87] op_sel:[1,0,0] op_sel_hi:[1,1,1] neg_lo:[1,0,0] neg_hi:[1,0,0]
    v_pk_fma_f32 v[88:89], v[252:253], v[248:249], v[88:89] op_sel:[1,0,0] op_sel_hi:[1,1,1] neg_lo:[1,0,0] neg_hi:[1,0,0]
    v_pk_fma_f32 v[90:91], v[252:253], v[250:251], v[90:91] op_sel:[1,0,0] op_sel_hi:[1,1,1] neg_lo:[1,0,0] neg_hi:[1,0,0]
    v_pk_mul_f32 v[76:77], v[252:253], v[76:77] op_sel_hi:[0,1]
    v_pk_mul_f32 v[78:79], v[252:253], v[78:79] op_sel_hi:[0,1]
    v_pk_mul_f32 v[80:81], v[252:253], v[80:81] op_sel_hi:[0,1]
    v_pk_mul_f32 v[82:83], v[252:253], v[82:83] op_sel_hi:[0,1]
    v_pk_mul_f32 v[84:85], v[252:253], v[84:85] op_sel_hi:[0,1]
    v_pk_mul_f32 v[86:87], v[252:253], v[86:87] op_sel_hi:[0,1]
    v_pk_mul_f32 v[88:89], v[252:253], v[88:89] op_sel_hi:[0,1]
    v_pk_mul_f32 v[90:91], v[252:253], v[90:91] op_sel_hi:[0,1]
    v_cvt_pk_bf16_f32 v52, v76, v77
    v_cvt_pk_bf16_f32 v53, v78, v79
    v_cvt_pk_bf16_f32 v54, v80, v81
    v_cvt_pk_bf16_f32 v55, v82, v83
    v_cvt_pk_bf16_f32 v56, v84, v85
    v_cvt_pk_bf16_f32 v57, v86, v87
    v_cvt_pk_bf16_f32 v58, v88, v89
    v_cvt_pk_bf16_f32 v59, v90, v91
    s_nop 0
    s_mul_i32 s36, s42, 5
    s_add_u32 s37, s43, s36
    v_permlane32_swap_b32 v50, v52
    v_permlane32_swap_b32 v51, v53
    buffer_store_dwordx4 v[50:53], v9, s[12:15], s37 offen sc1
    s_mul_i32 s36, s42, 6
    s_add_u32 s37, s43, s36
    v_permlane32_swap_b32 v54, v56
    v_permlane32_swap_b32 v55, v57
    buffer_store_dwordx4 v[54:57], v9, s[12:15], s37 offen sc1
    s_mul_i32 s36, s42, 6
    s_add_u32 s37, s43, s36
    buffer_store_dwordx2 v[58:59], v13, s[12:15], s37 offen offset:1024 sc1
    s_branch tl_qsig
tl_qs_3:
    s_waitcnt lgkmcnt(8)
    v_mfma_f32_32x32x16_bf16 v[44:59], v[108:111], v[172:175], v[44:59]
    ds_read_b64_tr_b16 v[92:93], v8 offset:1024
    ds_read_b64_tr_b16 v[94:95], v8 offset:1536
    ds_read_b64_tr_b16 v[96:97], v8 offset:5120
    ds_read_b64_tr_b16 v[98:99], v8 offset:5632
    ds_read_b64_tr_b16 v[100:101], v8 offset:9216
    ds_read_b64_tr_b16 v[102:103], v8 offset:9728
    ds_read_b64_tr_b16 v[104:105], v8 offset:13312
    ds_read_b64_tr_b16 v[106:107], v8 offset:13824
    s_nop 1
    v_mfma_f32_32x32x16_bf16 v[44:59], v[112:115], v[176:179], v[44:59]
    v_fma_f32 v28, -v253, v188, v28
    v_fma_f32 v29, -v253, v189, v29
    v_fma_f32 v30, -v253, v190, v30
    v_fma_f32 v31, -v253, v191, v31
    v_fma_f32 v32, -v253, v192, v32
    v_fma_f32 v33, -v253, v193, v33
    v_mfma_f32_32x32x16_bf16 v[44:59], v[116:119], v[180:183], v[44:59]
    v_fma_f32 v34, -v253, v194, v34
    v_fma_f32 v35, -v253, v195, v35
    v_fma_f32 v36, -v253, v196, v36
    v_fma_f32 v37, -v253, v197, v37
    v_fma_f32 v38, -v253, v198, v38
    v_fma_f32 v39, -v253, v199, v39
    v_mfma_f32_32x32x16_bf16 v[44:59], v[120:123], v[184:187], v[44:59]
    v_fma_f32 v40, -v253, v200, v40
    v_fma_f32 v41, -v253, v201, v41
    v_fma_f32 v42, -v253, v202, v42
    v_fma_f32 v43, -v253, v203, v43
    v_mul_f32 v28, v252, v28
    s_waitcnt lgkmcnt(8)
    v_mfma_f32_32x32x16_bf16 v[44:59], v[124:127], v[140:143], v[44:59]
    ds_read_b64_tr_b16 v[108:109], v6 offset:1024
    ds_read_b64_tr_b16 v[110:111], v6 offset:1536
    ds_read_b64_tr_b16 v[112:113], v6 offset:5120
    ds_read_b64_tr_b16 v[114:115], v6 offset:5632
    ds_read_b64_tr_b16 v[116:117], v6 offset:9216
    ds_read_b64_tr_b16 v[118:119], v6 offset:9728
    ds_read_b64_tr_b16 v[120:121], v6 offset:13312
    ds_read_b64_tr_b16 v[122:123], v6 offset:13824
    v_mfma_f32_32x32x16_bf16 v[44:59], v[128:131], v[144:147], v[44:59]
    v_mul_f32 v29, v252, v29
    v_mul_f32 v30, v252, v30
    v_mul_f32 v31, v252, v31
    v_mul_f32 v32, v252, v32
    v_mul_f32 v33, v252, v33
    v_mul_f32 v34, v252, v34
    v_mul_f32 v35, v252, v35
    v_mul_f32 v36, v252, v36
    v_mfma_f32_32x32x16_bf16 v[44:59], v[132:135], v[148:151], v[44:59]
    v_mul_f32 v37, v252, v37
    v_mul_f32 v38, v252, v38
    v_mul_f32 v39, v252, v39
    v_mul_f32 v40, v252, v40
    v_mul_f32 v41, v252, v41
    v_mul_f32 v42, v252, v42
    v_mul_f32 v43, v252, v43
    v_cvt_pk_bf16_f32 v28, v28, v29
    v_mfma_f32_32x32x16_bf16 v[44:59], v[136:139], v[152:155], v[44:59]
    v_cvt_pk_bf16_f32 v29, v30, v31
    v_cvt_pk_bf16_f32 v30, v32, v33
    v_cvt_pk_bf16_f32 v31, v34, v35
    v_cvt_pk_bf16_f32 v32, v36, v37
    v_cvt_pk_bf16_f32 v33, v38, v39
    v_cvt_pk_bf16_f32 v34, v40, v41
    v_cvt_pk_bf16_f32 v35, v42, v43
    s_nop 0
    s_mul_i32 s36, s42, 1
    s_add_u32 s37, s43, s36
    v_permlane32_swap_b32 v28, v30
    v_permlane32_swap_b32 v29, v31
    buffer_store_dwordx4 v[28:31], v9, s[12:15], s37 offen sc1
    s_mul_i32 s36, s42, 2
    s_add_u32 s37, s43, s36
    v_permlane32_swap_b32 v32, v34
    v_permlane32_swap_b32 v33, v35
    buffer_store_dwordx4 v[32:35], v9, s[12:15], s37 offen sc1
    s_waitcnt lgkmcnt(8)
    v_mfma_f32_32x32x16_bf16 v[60:75], v[92:95], v[172:175], v[60:75]
    ds_read_b64_tr_b16 v[124:125], v8 offset:1280
    ds_read_b64_tr_b16 v[126:127], v8 offset:1792
    ds_read_b64_tr_b16 v[128:129], v8 offset:5376
    ds_read_b64_tr_b16 v[130:131], v8 offset:5888
    ds_read_b64_tr_b16 v[132:133], v8 offset:9472
    ds_read_b64_tr_b16 v[134:135], v8 offset:9984
    ds_read_b64_tr_b16 v[136:137], v8 offset:13568
    ds_read_b64_tr_b16 v[138:139], v8 offset:14080
    s_nop 1
    v_mfma_f32_32x32x16_bf16 v[60:75], v[96:99], v[176:179], v[60:75]
    v_fma_f32 v44, -v253, v204, v44
    v_fma_f32 v45, -v253, v205, v45
    v_fma_f32 v46, -v253, v206, v46
    v_fma_f32 v47, -v253, v207, v47
    v_fma_f32 v48, -v253, v208, v48
    v_fma_f32 v49, -v253, v209, v49
    v_mfma_f32_32x32x16_bf16 v[60:75], v[100:103], v[180:183], v[60:75]
    v_fma_f32 v50, -v253, v210, v50
    v_fma_f32 v51, -v253, v211, v51
    v_fma_f32 v52, -v253, v212, v52
    v_fma_f32 v53, -v253, v213, v53
    v_fma_f32 v54, -v253, v214, v54
    v_fma_f32 v55, -v253, v215, v55
    v_mfma_f32_32x32x16_bf16 v[60:75], v[104:107], v[184:187], v[60:75]
    v_fma_f32 v56, -v253, v216, v56
    v_fma_f32 v57, -v253, v217, v57
    v_fma_f32 v58, -v253, v218, v58
    v_fma_f32 v59, -v253, v219, v59
    v_mul_f32 v44, v252, v44
    s_waitcnt lgkmcnt(8)
    v_mfma_f32_32x32x16_bf16 v[60:75], v[108:111], v[140:143], v[60:75]
    ds_read_b64_tr_b16 v[92:93], v6 offset:1280
    ds_read_b64_tr_b16 v[94:95], v6 offset:1792
    ds_read_b64_tr_b16 v[96:97], v6 offset:5376
    ds_read_b64_tr_b16 v[98:99], v6 offset:5888
    ds_read_b64_tr_b16 v[100:101], v6 offset:9472
    ds_read_b64_tr_b16 v[102:103], v6 offset:9984
    ds_read_b64_tr_b16 v[104:105], v6 offset:13568
    ds_read_b64_tr_b16 v[106:107], v6 offset:14080
    v_mfma_f32_32x32x16_bf16 v[60:75], v[112:115], v[144:147], v[60:75]
    v_mul_f32 v45, v252, v45
    v_mul_f32 v46, v252, v46
    v_mul_f32 v47, v252, v47
    v_mul_f32 v48, v252, v48
    v_mul_f32 v49, v252, v49
    v_mul_f32 v50, v252, v50
    v_mul_f32 v51, v252, v51
    v_mul_f32 v52, v252, v52
    v_mfma_f32_32x32x16_bf16 v[60:75], v[116:119], v[148:151], v[60:75]
    v_mul_f32 v53, v252, v53
    v_mul_f32 v54, v252, v54
    v_mul_f32 v55, v252, v55
    v_mul_f32 v56, v252, v56
    v_mul_f32 v57, v252, v57
    v_mul_f32 v58, v252, v58
    v_mul_f32 v59, v252, v59
    v_cvt_pk_bf16_f32 v36, v44, v45
    v_mfma_f32_32x32x16_bf16 v[60:75], v[120:123], v[152:155], v[60:75]
    v_cvt_pk_bf16_f32 v37, v46, v47
    v_cvt_pk_bf16_f32 v38, v48, v49
    v_cvt_pk_bf16_f32 v39, v50, v51
    v_cvt_pk_bf16_f32 v40, v52, v53
    v_cvt_pk_bf16_f32 v41, v54, v55
    v_cvt_pk_bf16_f32 v42, v56, v57
    v_cvt_pk_bf16_f32 v43, v58, v59
    s_nop 0
    s_mul_i32 s36, s42, 2
    s_add_u32 s37, s43, s36
    buffer_store_dwordx2 v[36:37], v13, s[12:15], s37 offen offset:1024 sc1
    s_mul_i32 s36, s42, 3
    s_add_u32 s37, s43, s36
    v_permlane32_swap_b32 v38, v40
    v_permlane32_swap_b32 v39, v41
    buffer_store_dwordx4 v[38:41], v9, s[12:15], s37 offen sc1
    s_waitcnt lgkmcnt(8)
    v_mfma_f32_32x32x16_bf16 v[76:91], v[124:127], v[172:175], v[76:91]
    s_nop 9
    v_mfma_f32_32x32x16_bf16 v[76:91], v[128:131], v[176:179], v[76:91]
    v_fma_f32 v60, -v253, v220, v60
    v_fma_f32 v61, -v253, v221, v61
    v_fma_f32 v62, -v253, v222, v62
    v_fma_f32 v63, -v253, v223, v63
    v_fma_f32 v64, -v253, v224, v64
    v_fma_f32 v65, -v253, v225, v65
    v_mfma_f32_32x32x16_bf16 v[76:91], v[132:135], v[180:183], v[76:91]
    v_fma_f32 v66, -v253, v226, v66
    v_fma_f32 v67, -v253, v227, v67
    v_fma_f32 v68, -v253, v228, v68
    v_fma_f32 v69, -v253, v229, v69
    v_fma_f32 v70, -v253, v230, v70
    v_fma_f32 v71, -v253, v231, v71
    v_mfma_f32_32x32x16_bf16 v[76:91], v[136:139], v[184:187], v[76:91]
    v_fma_f32 v72, -v253, v232, v72
    v_fma_f32 v73, -v253, v233, v73
    v_fma_f32 v74, -v253, v234, v74
    v_fma_f32 v75, -v253, v235, v75
    v_mul_f32 v60, v252, v60
    s_waitcnt lgkmcnt(0)
    v_mfma_f32_32x32x16_bf16 v[76:91], v[92:95], v[140:143], v[76:91]
    v_mul_f32 v61, v252, v61
    v_mul_f32 v62, v252, v62
    v_mul_f32 v63, v252, v63
    v_mul_f32 v64, v252, v64
    v_mul_f32 v65, v252, v65
    v_mul_f32 v66, v252, v66
    v_mfma_f32_32x32x16_bf16 v[76:91], v[96:99], v[144:147], v[76:91]
    v_mul_f32 v67, v252, v67
    v_mul_f32 v68, v252, v68
    v_mul_f32 v69, v252, v69
    v_mul_f32 v70, v252, v70
    v_mul_f32 v71, v252, v71
    v_mul_f32 v72, v252, v72
    v_mfma_f32_32x32x16_bf16 v[76:91], v[100:103], v[148:151], v[76:91]
    v_mul_f32 v73, v252, v73
    v_mul_f32 v74, v252, v74
    v_mul_f32 v75, v252, v75
    v_cvt_pk_bf16_f32 v44, v60, v61
    v_cvt_pk_bf16_f32 v45, v62, v63
    v_cvt_pk_bf16_f32 v46, v64, v65
    v_mfma_f32_32x32x16_bf16 v[76:91], v[104:107], v[152:155], v[76:91]
    v_cvt_pk_bf16_f32 v47, v66, v67
    v_cvt_pk_bf16_f32 v48, v68, v69
    v_cvt_pk_bf16_f32 v49, v70, v71
    v_cvt_pk_bf16_f32 v50, v72, v73
    v_cvt_pk_bf16_f32 v51, v74, v75
    s_nop 0
    s_mul_i32 s36, s42, 4
    s_add_u32 s37, s43, s36
    v_permlane32_swap_b32 v42, v44
    v_permlane32_swap_b32 v43, v45
    buffer_store_dwordx4 v[42:45], v9, s[12:15], s37 offen sc1
    s_mul_i32 s36, s42, 4
    s_add_u32 s37, s43, s36
    buffer_store_dwordx2 v[46:47], v13, s[12:15], s37 offen offset:1024 sc1
    s_mul_i32 s36, s42, 5
    s_add_u32 s37, s43, s36
    v_permlane32_swap_b32 v48, v50
    v_permlane32_swap_b32 v49, v51
    buffer_store_dwordx4 v[48:51], v9, s[12:15], s37 offen sc1
    s_nop 7
    v_pk_fma_f32 v[76:77], v[252:253], v[236:237], v[76:77] op_sel:[1,0,0] op_sel_hi:[1,1,1] neg_lo:[1,0,0] neg_hi:[1,0,0]
    v_pk_fma_f32 v[78:79], v[252:253], v[238:239], v[78:79] op_sel:[1,0,0] op_sel_hi:[1,1,1] neg_lo:[1,0,0] neg_hi:[1,0,0]
    v_pk_fma_f32 v[80:81], v[252:253], v[240:241], v[80:81] op_sel:[1,0,0] op_sel_hi:[1,1,1] neg_lo:[1,0,0] neg_hi:[1,0,0]
    v_pk_fma_f32 v[82:83], v[252:253], v[242:243], v[82:83] op_sel:[1,0,0] op_sel_hi:[1,1,1] neg_lo:[1,0,0] neg_hi:[1,0,0]
    v_pk_fma_f32 v[84:85], v[252:253], v[244:245], v[84:85] op_sel:[1,0,0] op_sel_hi:[1,1,1] neg_lo:[1,0,0] neg_hi:[1,0,0]
    v_pk_fma_f32 v[86:87], v[252:253], v[246:247], v[86:87] op_sel:[1,0,0] op_sel_hi:[1,1,1] neg_lo:[1,0,0] neg_hi:[1,0,0]
    v_pk_fma_f32 v[88:89], v[252:253], v[248:249], v[88:89] op_sel:[1,0,0] op_sel_hi:[1,1,1] neg_lo:[1,0,0] neg_hi:[1,0,0]
    v_pk_fma_f32 v[90:91], v[252:253], v[250:251], v[90:91] op_sel:[1,0,0] op_sel_hi:[1,1,1] neg_lo:[1,0,0] neg_hi:[1,0,0]
    v_pk_mul_f32 v[76:77], v[252:253], v[76:77] op_sel_hi:[0,1]
    v_pk_mul_f32 v[78:79], v[252:253], v[78:79] op_sel_hi:[0,1]
    v_pk_mul_f32 v[80:81], v[252:253], v[80:81] op_sel_hi:[0,1]
    v_pk_mul_f32 v[82:83], v[252:253], v[82:83] op_sel_hi:[0,1]
    v_pk_mul_f32 v[84:85], v[252:253], v[84:85] op_sel_hi:[0,1]
    v_pk_mul_f32 v[86:87], v[252:253], v[86:87] op_sel_hi:[0,1]
    v_pk_mul_f32 v[88:89], v[252:253], v[88:89] op_sel_hi:[0,1]
    v_pk_mul_f32 v[90:91], v[252:253], v[90:91] op_sel_hi:[0,1]
    v_cvt_pk_bf16_f32 v52, v76, v77
    v_cvt_pk_bf16_f32 v53, v78, v79
    v_cvt_pk_bf16_f32 v54, v80, v81
    v_cvt_pk_bf16_f32 v55, v82, v83
    v_cvt_pk_bf16_f32 v56, v84, v85
    v_cvt_pk_bf16_f32 v57, v86, v87
    v_cvt_pk_bf16_f32 v58, v88, v89
    v_cvt_pk_bf16_f32 v59, v90, v91
    s_nop 0
    s_mul_i32 s36, s42, 6
    s_add_u32 s37, s43, s36
    v_permlane32_swap_b32 v52, v54
    v_permlane32_swap_b32 v53, v55
    buffer_store_dwordx4 v[52:55], v9, s[12:15], s37 offen sc1
    s_mul_i32 s36, s42, 6
    s_add_u32 s37, s43, s36
    buffer_store_dwordx2 v[56:57], v13, s[12:15], s37 offen offset:1024 sc1
    s_mul_i32 s36, s42, 7
    s_add_u32 s37, s43, s36
    v_mov_b32 v20, v58
    v_mov_b32 v21, v59
    v_mov_b32 v22, v58
    v_mov_b32 v23, v59
    s_nop 1
    v_permlane32_swap_b32 v20, v22
    v_permlane32_swap_b32 v21, v23
    buffer_store_dwordx4 v[20:23], v12, s[12:15], s37 offen offset:0 sc1
    s_branch tl_qsig
tl_qs_4:
    s_waitcnt lgkmcnt(8)
    v_mfma_f32_32x32x16_bf16 v[44:59], v[108:111], v[172:175], v[44:59]
    ds_read_b64_tr_b16 v[92:93], v8 offset:1024
    ds_read_b64_tr_b16 v[94:95], v8 offset:1536
    ds_read_b64_tr_b16 v[96:97], v8 offset:5120
    ds_read_b64_tr_b16 v[98:99], v8 offset:5632
    ds_read_b64_tr_b16 v[100:101], v8 offset:9216
    ds_read_b64_tr_b16 v[102:103], v8 offset:9728
    ds_read_b64_tr_b16 v[104:105], v8 offset:13312
    ds_read_b64_tr_b16 v[106:107], v8 offset:13824
    s_nop 1
    v_mfma_f32_32x32x16_bf16 v[44:59], v[112:115], v[176:179], v[44:59]
    v_fma_f32 v28, -v253, v188, v28
    v_fma_f32 v29, -v253, v189, v29
    v_fma_f32 v30, -v253, v190, v30
    v_fma_f32 v31, -v253, v191, v31
    v_fma_f32 v32, -v253, v192, v32
    v_fma_f32 v33, -v253, v193, v33
    v_mfma_f32_32x32x16_bf16 v[44:59], v[116:119], v[180:183], v[44:59]
    v_fma_f32 v34, -v253, v194, v34
    v_fma_f32 v35, -v253, v195, v35
    v_fma_f32 v36, -v253, v196, v36
    v_fma_f32 v37, -v253, v197, v37
    v_fma_f32 v38, -v253, v198, v38
    v_fma_f32 v39, -v253, v199, v39
    v_mfma_f32_32x32x16_bf16 v[44:59], v[120:123], v[184:187], v[44:59]
    v_fma_f32 v40, -v253, v200, v40
    v_fma_f32 v41, -v253, v201, v41
    v_fma_f32 v42, -v253, v202, v42
    v_fma_f32 v43, -v253, v203, v43
    v_mul_f32 v28, v252, v28
    s_waitcnt lgkmcnt(8)
    v_mfma_f32_32x32x16_bf16 v[44:59], v[124:127], v[140:143], v[44:59]
    ds_read_b64_tr_b16 v[108:109], v6 offset:1024
    ds_read_b64_tr_b16 v[110:111], v6 offset:1536
    ds_read_b64_tr_b16 v[112:113], v6 offset:5120
    ds_read_b64_tr_b16 v[114:115], v6 offset:5632
    ds_read_b64_tr_b16 v[116:117], v6 offset:9216
    ds_read_b64_tr_b16 v[118:119], v6 offset:9728
    ds_read_b64_tr_b16 v[120:121], v6 offset:13312
    ds_read_b64_tr_b16 v[122:123], v6 offset:13824
    v_mfma_f32_32x32x16_bf16 v[44:59], v[128:131], v[144:147], v[44:59]
    v_mul_f32 v29, v252, v29
    v_mul_f32 v30, v252, v30
    v_mul_f32 v31, v252, v31
    v_mul_f32 v32, v252, v32
    v_mul_f32 v33, v252, v33
    v_mul_f32 v34, v252, v34
    v_mul_f32 v35, v252, v35
    v_mul_f32 v36, v252, v36
    v_mfma_f32_32x32x16_bf16 v[44:59], v[132:135], v[148:151], v[44:59]
    v_mul_f32 v37, v252, v37
    v_mul_f32 v38, v252, v38
    v_mul_f32 v39, v252, v39
    v_mul_f32 v40, v252, v40
    v_mul_f32 v41, v252, v41
    v_mul_f32 v42, v252, v42
    v_mul_f32 v43, v252, v43
    v_cvt_pk_bf16_f32 v28, v28, v29
    v_mfma_f32_32x32x16_bf16 v[44:59], v[136:139], v[152:155], v[44:59]
    v_cvt_pk_bf16_f32 v29, v30, v31
    v_cvt_pk_bf16_f32 v30, v32, v33
    v_cvt_pk_bf16_f32 v31, v34, v35
    v_cvt_pk_bf16_f32 v32, v36, v37
    v_cvt_pk_bf16_f32 v33, v38, v39
    v_cvt_pk_bf16_f32 v34, v40, v41
    v_cvt_pk_bf16_f32 v35, v42, v43
    s_nop 0
    s_mul_i32 s36, s42, 1
    s_add_u32 s37, s43, s36
    v_mov_b32 v16, v28
    v_mov_b32 v17, v29
    v_mov_b32 v18, v28
    v_mov_b32 v19, v29
    s_nop 1
    v_permlane32_swap_b32 v16, v18
    v_permlane32_swap_b32 v17, v19
    buffer_store_dwordx4 v[16:19], v12, s[12:15], s37 offen offset:512 sc1
    s_mul_i32 s36, s42, 2
    s_add_u32 s37, s43, s36
    v_permlane32_swap_b32 v30, v32
    v_permlane32_swap_b32 v31, v33
    buffer_store_dwordx4 v[30:33], v9, s[12:15], s37 offen sc1
    s_mul_i32 s36, s42, 2
    s_add_u32 s37, s43, s36
    buffer_store_dwordx2 v[34:35], v13, s[12:15], s37 offen offset:1024 sc1
    s_waitcnt lgkmcnt(8)
    v_mfma_f32_32x32x16_bf16 v[60:75], v[92:95], v[172:175], v[60:75]
    ds_read_b64_tr_b16 v[124:125], v8 offset:1280
    ds_read_b64_tr_b16 v[126:127], v8 offset:1792
    ds_read_b64_tr_b16 v[128:129], v8 offset:5376
    ds_read_b64_tr_b16 v[130:131], v8 offset:5888
    ds_read_b64_tr_b16 v[132:133], v8 offset:9472
    ds_read_b64_tr_b16 v[134:135], v8 offset:9984
    ds_read_b64_tr_b16 v[136:137], v8 offset:13568
    ds_read_b64_tr_b16 v[138:139], v8 offset:14080
    s_nop 1
    v_mfma_f32_32x32x16_bf16 v[60:75], v[96:99], v[176:179], v[60:75]
    v_fma_f32 v44, -v253, v204, v44
    v_fma_f32 v45, -v253, v205, v45
    v_fma_f32 v46, -v253, v206, v46
    v_fma_f32 v47, -v253, v207, v47
    v_fma_f32 v48, -v253, v208, v48
    v_fma_f32 v49, -v253, v209, v49
    v_mfma_f32_32x32x16_bf16 v[60:75], v[100:103], v[180:183], v[60:75]
    v_fma_f32 v50, -v253, v210, v50
    v_fma_f32 v51, -v253, v211, v51
    v_fma_f32 v52, -v253, v212, v52
    v_fma_f32 v53, -v253, v213, v53
    v_fma_f32 v54, -v253, v214, v54
    v_fma_f32 v55, -v253, v215, v55
    v_mfma_f32_32x32x16_bf16 v[60:75], v[104:107], v[184:187], v[60:75]
    v_fma_f32 v56, -v253, v216, v56
    v_fma_f32 v57, -v253, v217, v57
    v_fma_f32 v58, -v253, v218, v58
    v_fma_f32 v59, -v253, v219, v59
    v_mul_f32 v44, v252, v44
    s_waitcnt lgkmcnt(8)
    v_mfma_f32_32x32x16_bf16 v[60:75], v[108:111], v[140:143], v[60:75]
    ds_read_b64_tr_b16 v[92:93], v6 offset:1280
    ds_read_b64_tr_b16 v[94:95], v6 offset:1792
    ds_read_b64_tr_b16 v[96:97], v6 offset:5376
    ds_read_b64_tr_b16 v[98:99], v6 offset:5888
    ds_read_b64_tr_b16 v[100:101], v6 offset:9472
    ds_read_b64_tr_b16 v[102:103], v6 offset:9984
    ds_read_b64_tr_b16 v[104:105], v6 offset:13568
    ds_read_b64_tr_b16 v[106:107], v6 offset:14080
    v_mfma_f32_32x32x16_bf16 v[60:75], v[112:115], v[144:147], v[60:75]
    v_mul_f32 v45, v252, v45
    v_mul_f32 v46, v252, v46
    v_mul_f32 v47, v252, v47
    v_mul_f32 v48, v252, v48
    v_mul_f32 v49, v252, v49
    v_mul_f32 v50, v252, v50
    v_mul_f32 v51, v252, v51
    v_mul_f32 v52, v252, v52
    v_mfma_f32_32x32x16_bf16 v[60:75], v[116:119], v[148:151], v[60:75]
    v_mul_f32 v53, v252, v53
    v_mul_f32 v54, v252, v54
    v_mul_f32 v55, v252, v55
    v_mul_f32 v56, v252, v56
    v_mul_f32 v57, v252, v57
    v_mul_f32 v58, v252, v58
    v_mul_f32 v59, v252, v59
    v_cvt_pk_bf16_f32 v36, v44, v45
    v_mfma_f32_32x32x16_bf16 v[60:75], v[120:123], v[152:155], v[60:75]
    v_cvt_pk_bf16_f32 v37, v46, v47
    v_cvt_pk_bf16_f32 v38, v48, v49
    v_cvt_pk_bf16_f32 v39, v50, v51
    v_cvt_pk_bf16_f32 v40, v52, v53
    v_cvt_pk_bf16_f32 v41, v54, v55
    v_cvt_pk_bf16_f32 v42, v56, v57
    v_cvt_pk_bf16_f32 v43, v58, v59
    s_nop 0
    s_mul_i32 s36, s42, 3
    s_add_u32 s37, s43, s36
    v_permlane32_swap_b32 v36, v38
    v_permlane32_swap_b32 v37, v39
    buffer_store_dwordx4 v[36:39], v9, s[12:15], s37 offen sc1
    s_mul_i32 s36, s42, 4
    s_add_u32 s37, s43, s36
    v_permlane32_swap_b32 v40, v42
    v_permlane32_swap_b32 v41, v43
    buffer_store_dwordx4 v[40:43], v9, s[12:15], s37 offen sc1
    s_waitcnt lgkmcnt(8)
    v_mfma_f32_32x32x16_bf16 v[76:91], v[124:127], v[172:175], v[76:91]
    s_nop 9
    v_mfma_f32_32x32x16_bf16 v[76:91], v[128:131], v[176:179], v[76:91]
    v_fma_f32 v60, -v253, v220, v60
    v_fma_f32 v61, -v253, v221, v61
    v_fma_f32 v62, -v253, v222, v62
    v_fma_f32 v63, -v253, v223, v63
    v_fma_f32 v64, -v253, v224, v64
    v_fma_f32 v65, -v253, v225, v65
    v_mfma_f32_32x32x16_bf16 v[76:91], v[132:135], v[180:183], v[76:91]
    v_fma_f32 v66, -v253, v226, v66
    v_fma_f32 v67, -v253, v227, v67
    v_fma_f32 v68, -v253, v228, v68
    v_fma_f32 v69, -v253, v229, v69
    v_fma_f32 v70, -v253, v230, v70
    v_fma_f32 v71, -v253, v231, v71
    v_mfma_f32_32x32x16_bf16 v[76:91], v[136:139], v[184:187], v[76:91]
    v_fma_f32 v72, -v253, v232, v72
    v_fma_f32 v73, -v253, v233, v73
    v_fma_f32 v74, -v253, v234, v74
    v_fma_f32 v75, -v253, v235, v75
    v_mul_f32 v60, v252, v60
    s_waitcnt lgkmcnt(0)
    v_mfma_f32_32x32x16_bf16 v[76:91], v[92:95], v[140:143], v[76:91]
    v_mul_f32 v61, v252, v61
    v_mul_f32 v62, v252, v62
    v_mul_f32 v63, v252, v63
    v_mul_f32 v64, v252, v64
    v_mul_f32 v65, v252, v65
    v_mul_f32 v66, v252, v66
    v_mfma_f32_32x32x16_bf16 v[76:91], v[96:99], v[144:147], v[76:91]
    v_mul_f32 v67, v252, v67
    v_mul_f32 v68, v252, v68
    v_mul_f32 v69, v252, v69
    v_mul_f32 v70, v252, v70
    v_mul_f32 v71, v252, v71
    v_mul_f32 v72, v252, v72
    v_mfma_f32_32x32x16_bf16 v[76:91], v[100:103], v[148:151], v[76:91]
    v_mul_f32 v73, v252, v73
    v_mul_f32 v74, v252, v74
    v_mul_f32 v75, v252, v75
    v_cvt_pk_bf16_f32 v44, v60, v61
    v_cvt_pk_bf16_f32 v45, v62, v63
    v_cvt_pk_bf16_f32 v46, v64, v65
    v_mfma_f32_32x32x16_bf16 v[76:91], v[104:107], v[152:155], v[76:91]
    v_cvt_pk_bf16_f32 v47, v66, v67
    v_cvt_pk_bf16_f32 v48, v68, v69
    v_cvt_pk_bf16_f32 v49, v70, v71
    v_cvt_pk_bf16_f32 v50, v72, v73
    v_cvt_pk_bf16_f32 v51, v74, v75
    s_nop 0
    s_mul_i32 s36, s42, 4
    s_add_u32 s37, s43, s36
    buffer_store_dwordx2 v[44:45], v13, s[12:15], s37 offen offset:1024 sc1
    s_mul_i32 s36, s42, 5
    s_add_u32 s37, s43, s36
    v_permlane32_swap_b32 v46, v48
    v_permlane32_swap_b32 v47, v49
    buffer_store_dwordx4 v[46:49], v9, s[12:15], s37 offen sc1
    s_nop 7
    v_pk_fma_f32 v[76:77], v[252:253], v[236:237], v[76:77] op_sel:[1,0,0] op_sel_hi:[1,1,1] neg_lo:[1,0,0] neg_hi:[1,0,0]
    v_pk_fma_f32 v[78:79], v[252:253], v[238:239], v[78:79] op_sel:[1,0,0] op_sel_hi:[1,1,1] neg_lo:[1,0,0] neg_hi:[1,0,0]
    v_pk_fma_f32 v[80:81], v[252:253], v[240:241], v[80:81] op_sel:[1,0,0] op_sel_hi:[1,1,1] neg_lo:[1,0,0] neg_hi:[1,0,0]
    v_pk_fma_f32 v[82:83], v[252:253], v[242:243], v[82:83] op_sel:[1,0,0] op_sel_hi:[1,1,1] neg_lo:[1,0,0] neg_hi:[1,0,0]
    v_pk_fma_f32 v[84:85], v[252:253], v[244:245], v[84:85] op_sel:[1,0,0] op_sel_hi:[1,1,1] neg_lo:[1,0,0] neg_hi:[1,0,0]
    v_pk_fma_f32 v[86:87], v[252:253], v[246:247], v[86:87] op_sel:[1,0,0] op_sel_hi:[1,1,1] neg_lo:[1,0,0] neg_hi:[1,0,0]
    v_pk_fma_f32 v[88:89], v[252:253], v[248:249], v[88:89] op_sel:[1,0,0] op_sel_hi:[1,1,1] neg_lo:[1,0,0] neg_hi:[1,0,0]
    v_pk_fma_f32 v[90:91], v[252:253], v[250:251], v[90:91] op_sel:[1,0,0] op_sel_hi:[1,1,1] neg_lo:[1,0,0] neg_hi:[1,0,0]
    v_pk_mul_f32 v[76:77], v[252:253], v[76:77] op_sel_hi:[0,1]
    v_pk_mul_f32 v[78:79], v[252:253], v[78:79] op_sel_hi:[0,1]
    v_pk_mul_f32 v[80:81], v[252:253], v[80:81] op_sel_hi:[0,1]
    v_pk_mul_f32 v[82:83], v[252:253], v[82:83] op_sel_hi:[0,1]
    v_pk_mul_f32 v[84:85], v[252:253], v[84:85] op_sel_hi:[0,1]
    v_pk_mul_f32 v[86:87], v[252:253], v[86:87] op_sel_hi:[0,1]
    v_pk_mul_f32 v[88:89], v[252:253], v[88:89] op_sel_hi:[0,1]
    v_pk_mul_f32 v[90:91], v[252:253], v[90:91] op_sel_hi:[0,1]
    v_cvt_pk_bf16_f32 v52, v76, v77
    v_cvt_pk_bf16_f32 v53, v78, v79
    v_cvt_pk_bf16_f32 v54, v80, v81
    v_cvt_pk_bf16_f32 v55, v82, v83
    v_cvt_pk_bf16_f32 v56, v84, v85
    v_cvt_pk_bf16_f32 v57, v86, v87
    v_cvt_pk_bf16_f32 v58, v88, v89
    v_cvt_pk_bf16_f32 v59, v90, v91
    s_nop 0
    s_mul_i32 s36, s42, 6
    s_add_u32 s37, s43, s36
    v_permlane32_swap_b32 v50, v52
    v_permlane32_swap_b32 v51, v53
    buffer_store_dwordx4 v[50:53], v9, s[12:15], s37 offen sc1
    s_mul_i32 s36, s42, 6
    s_add_u32 s37, s43, s36
    buffer_store_dwordx2 v[54:55], v13, s[12:15], s37 offen offset:1024 sc1
    s_mul_i32 s36, s42, 7
    s_add_u32 s37, s43, s36
    v_permlane32_swap_b32 v56, v58
    v_permlane32_swap_b32 v57, v59
    buffer_store_dwordx4 v[56:59], v9, s[12:15], s37 offen sc1
    s_branch tl_qsig
tl_p4v:
    s_sub_u32 s36, s61, 10
    s_lshl_b32 s36, s36, 7
    v_add_u32 v2, s36, v11
    v_mul_u32_u24 v4, 3277, v2
    v_lshrrev_b32 v4, 16, v4
    v_mul_u32_u24 v12, 20, v4
    v_sub_u32 v12, v2, v12
    v_mul_u32_u24 v4, 163840, v4
    v_lshl_add_u32 v12, v12, 4, v4
    v_mul_u32_u24 v4, 320, v10
    v_add_u32 v12, v12, v4
    v_add_u32 v2, s36, v11
    v_add_u32 v2, 32, v2
    v_mul_u32_u24 v4, 3277, v2
    v_lshrrev_b32 v4, 16, v4
    v_mul_u32_u24 v13, 20, v4
    v_sub_u32 v13, v2, v13
    v_mul_u32_u24 v4, 163840, v4
    v_lshl_add_u32 v13, v13, 4, v4
    v_mul_u32_u24 v4, 320, v10
    v_add_u32 v13, v13, v4
    v_add_u32 v2, s36, v11
    v_add_u32 v2, 64, v2
    v_mul_u32_u24 v4, 3277, v2
    v_lshrrev_b32 v4, 16, v4
    v_mul_u32_u24 v14, 20, v4
    v_sub_u32 v14, v2, v14
    v_mul_u32_u24 v4, 163840, v4
    v_lshl_add_u32 v14, v14, 4, v4
    v_mul_u32_u24 v4, 320, v10
    v_add_u32 v14, v14, v4
    v_add_u32 v2, s36, v11
    v_add_u32 v2, 96, v2
    v_mul_u32_u24 v4, 3277, v2
    v_lshrrev_b32 v4, 16, v4
    v_mul_u32_u24 v15, 20, v4
    v_sub_u32 v15, v2, v15
    v_mul_u32_u24 v4, 163840, v4
    v_lshl_add_u32 v15, v15, 4, v4
    v_mul_u32_u24 v4, 320, v10
    v_add_u32 v15, v15, v4
    s_mul_i32 s43, s41, 2560
    s_add_u32 s43, s43, 25691392
    s_lshl_b32 s36, s24, 7
    s_add_u32 s36, s36, 160768
    v_lshlrev_b32 v2, 2, v11
    v_add_u32 v2, 161792, v2
    v_lshl_add_u32 v3, v10, 4, s36
    s_barrier
    s_add_u32 s36, s28, 0
    buffer_load_dwordx4 v[140:143], v9, s[12:15], s36 offen sc1
    ds_read_b64_tr_b16 v[92:93], v6 offset:0
    ds_read_b64_tr_b16 v[94:95], v6 offset:512
    ds_read_b64_tr_b16 v[96:97], v6 offset:256
    ds_read_b64_tr_b16 v[98:99], v6 offset:768
    ds_read_b64_tr_b16 v[100:101], v6 offset:1024
    ds_read_b64_tr_b16 v[102:103], v6 offset:1536
    ds_read_b64_tr_b16 v[104:105], v6 offset:1280
    ds_read_b64_tr_b16 v[106:107], v6 offset:1792
    s_add_u32 s36, s28, 1024
    buffer_load_dwordx4 v[144:147], v9, s[12:15], s36 offen sc1
    ds_read_b64_tr_b16 v[108:109], v6 offset:4096
    ds_read_b64_tr_b16 v[110:111], v6 offset:4608
    ds_read_b64_tr_b16 v[112:113], v6 offset:4352
    ds_read_b64_tr_b16 v[114:115], v6 offset:4864
    ds_read_b64_tr_b16 v[116:117], v6 offset:5120
    ds_read_b64_tr_b16 v[118:119], v6 offset:5632
    ds_read_b64_tr_b16 v[120:121], v6 offset:5376
    ds_read_b64_tr_b16 v[122:123], v6 offset:5888
    s_add_u32 s36, s28, 2048
    buffer_load_dwordx4 v[148:151], v9, s[12:15], s36 offen sc1
    s_add_u32 s36, s28, 3072
    buffer_load_dwordx4 v[152:155], v9, s[12:15], s36 offen sc1
    s_add_u32 s36, s28, 4096
    buffer_load_dwordx4 v[156:159], v9, s[12:15], s36 offen sc1
    s_add_u32 s36, s28, 5120
    buffer_load_dwordx4 v[160:163], v9, s[12:15], s36 offen sc1
    s_add_u32 s36, s28, 6144
    buffer_load_dwordx4 v[164:167], v9, s[12:15], s36 offen sc1
    s_add_u32 s36, s28, 7168
    buffer_load_dwordx4 v[168:171], v9, s[12:15], s36 offen sc1
    s_waitcnt vmcnt(7) lgkmcnt(8)
    v_mfma_f32_32x32x16_bf16 v[28:43], v[140:143], v[92:95], v[28:43]
    s_add_u32 s36, s28, 8192
    buffer_load_dwordx4 v[172:175], v9, s[12:15], s36 offen sc1
    s_add_u32 s36, s28, 9216
    v_mfma_f32_32x32x16_bf16 v[44:59], v[140:143], v[96:99], v[44:59]
    buffer_load_dwordx4 v[176:179], v9, s[12:15], s36 offen sc1
    ds_read_b64_tr_b16 v[124:125], v6 offset:8192
    ds_read_b64_tr_b16 v[126:127], v6 offset:8704
    v_mfma_f32_32x32x16_bf16 v[60:75], v[140:143], v[100:103], v[60:75]
    ds_read_b64_tr_b16 v[128:129], v6 offset:8448
    ds_read_b64_tr_b16 v[130:131], v6 offset:8960
    ds_read_b64_tr_b16 v[132:133], v6 offset:9216
    v_mfma_f32_32x32x16_bf16 v[76:91], v[140:143], v[104:107], v[76:91]
    ds_read_b64_tr_b16 v[134:135], v6 offset:9728
    ds_read_b64_tr_b16 v[136:137], v6 offset:9472
    ds_read_b64_tr_b16 v[138:139], v6 offset:9984
    s_waitcnt vmcnt(8) lgkmcnt(8)
    v_mfma_f32_32x32x16_bf16 v[28:43], v[144:147], v[108:111], v[28:43]
    s_add_u32 s36, s28, 10240
    buffer_load_dwordx4 v[180:183], v9, s[12:15], s36 offen sc1
    s_add_u32 s36, s28, 11264
    v_mfma_f32_32x32x16_bf16 v[44:59], v[144:147], v[112:115], v[44:59]
    buffer_load_dwordx4 v[184:187], v9, s[12:15], s36 offen sc1
    ds_read_b64_tr_b16 v[92:93], v6 offset:12288
    ds_read_b64_tr_b16 v[94:95], v6 offset:12800
    v_mfma_f32_32x32x16_bf16 v[60:75], v[144:147], v[116:119], v[60:75]
    ds_read_b64_tr_b16 v[96:97], v6 offset:12544
    ds_read_b64_tr_b16 v[98:99], v6 offset:13056
    ds_read_b64_tr_b16 v[100:101], v6 offset:13312
    v_mfma_f32_32x32x16_bf16 v[76:91], v[144:147], v[120:123], v[76:91]
    ds_read_b64_tr_b16 v[102:103], v6 offset:13824
    ds_read_b64_tr_b16 v[104:105], v6 offset:13568
    ds_read_b64_tr_b16 v[106:107], v6 offset:14080
    s_waitcnt vmcnt(9) lgkmcnt(8)
    v_mfma_f32_32x32x16_bf16 v[28:43], v[148:151], v[124:127], v[28:43]
    s_add_u32 s36, s28, 12288
    buffer_load_dwordx4 v[140:143], v9, s[12:15], s36 offen sc1
    s_add_u32 s36, s28, 13312
    v_mfma_f32_32x32x16_bf16 v[44:59], v[148:151], v[128:131], v[44:59]
    buffer_load_dwordx4 v[144:147], v9, s[12:15], s36 offen sc1
    ds_read_b64_tr_b16 v[108:109], v6 offset:16384
    ds_read_b64_tr_b16 v[110:111], v6 offset:16896
    v_mfma_f32_32x32x16_bf16 v[60:75], v[148:151], v[132:135], v[60:75]
    ds_read_b64_tr_b16 v[112:113], v6 offset:16640
    ds_read_b64_tr_b16 v[114:115], v6 offset:17152
    ds_read_b64_tr_b16 v[116:117], v6 offset:17408
    v_mfma_f32_32x32x16_bf16 v[76:91], v[148:151], v[136:139], v[76:91]
    ds_read_b64_tr_b16 v[118:119], v6 offset:17920
    ds_read_b64_tr_b16 v[120:121], v6 offset:17664
    ds_read_b64_tr_b16 v[122:123], v6 offset:18176
    s_waitcnt vmcnt(10) lgkmcnt(8)
    v_mfma_f32_32x32x16_bf16 v[28:43], v[152:155], v[92:95], v[28:43]
    s_add_u32 s36, s28, 14336
    buffer_load_dwordx4 v[148:151], v9, s[12:15], s36 offen sc1
    ds_read_b64_tr_b16 v[124:125], v6 offset:20480
    v_mfma_f32_32x32x16_bf16 v[44:59], v[152:155], v[96:99], v[44:59]
    ds_read_b64_tr_b16 v[126:127], v6 offset:20992
    ds_read_b64_tr_b16 v[128:129], v6 offset:20736
    v_mfma_f32_32x32x16_bf16 v[60:75], v[152:155], v[100:103], v[60:75]
    ds_read_b64_tr_b16 v[130:131], v6 offset:21248
    ds_read_b64_tr_b16 v[132:133], v6 offset:21504
    ds_read_b64_tr_b16 v[134:135], v6 offset:22016
    v_mfma_f32_32x32x16_bf16 v[76:91], v[152:155], v[104:107], v[76:91]
    ds_read_b64_tr_b16 v[136:137], v6 offset:21760
    ds_read_b64_tr_b16 v[138:139], v6 offset:22272
    s_waitcnt vmcnt(10) lgkmcnt(8)
    v_mfma_f32_32x32x16_bf16 v[28:43], v[156:159], v[108:111], v[28:43]
    s_add_u32 s36, s28, 15360
    buffer_load_dwordx4 v[152:155], v9, s[12:15], s36 offen sc1
    ds_read_b64_tr_b16 v[92:93], v6 offset:24576
    v_mfma_f32_32x32x16_bf16 v[44:59], v[156:159], v[112:115], v[44:59]
    ds_read_b64_tr_b16 v[94:95], v6 offset:25088
    ds_read_b64_tr_b16 v[96:97], v6 offset:24832
    v_mfma_f32_32x32x16_bf16 v[60:75], v[156:159], v[116:119], v[60:75]
    ds_read_b64_tr_b16 v[98:99], v6 offset:25344
    ds_read_b64_tr_b16 v[100:101], v6 offset:25600
    ds_read_b64_tr_b16 v[102:103], v6 offset:26112
    v_mfma_f32_32x32x16_bf16 v[76:91], v[156:159], v[120:123], v[76:91]
    ds_read_b64_tr_b16 v[104:105], v6 offset:25856
    ds_read_b64_tr_b16 v[106:107], v6 offset:26368
    s_waitcnt vmcnt(10) lgkmcnt(8)
    v_mfma_f32_32x32x16_bf16 v[28:43], v[160:163], v[124:127], v[28:43]
    s_add_u32 s36, s28, 16384
    buffer_load_dwordx4 v[156:159], v9, s[12:15], s36 offen sc1
    ds_read_b64_tr_b16 v[108:109], v6 offset:28672
    v_mfma_f32_32x32x16_bf16 v[44:59], v[160:163], v[128:131], v[44:59]
    ds_read_b64_tr_b16 v[110:111], v6 offset:29184
    ds_read_b64_tr_b16 v[112:113], v6 offset:28928
    v_mfma_f32_32x32x16_bf16 v[60:75], v[160:163], v[132:135], v[60:75]
    ds_read_b64_tr_b16 v[114:115], v6 offset:29440
    ds_read_b64_tr_b16 v[116:117], v6 offset:29696
    ds_read_b64_tr_b16 v[118:119], v6 offset:30208
    v_mfma_f32_32x32x16_bf16 v[76:91], v[160:163], v[136:139], v[76:91]
    ds_read_b64_tr_b16 v[120:121], v6 offset:29952
    ds_read_b64_tr_b16 v[122:123], v6 offset:30464
    s_waitcnt vmcnt(10) lgkmcnt(8)
    v_mfma_f32_32x32x16_bf16 v[28:43], v[164:167], v[92:95], v[28:43]
    s_add_u32 s36, s28, 17408
    buffer_load_dwordx4 v[160:163], v9, s[12:15], s36 offen sc1
    ds_read_b64_tr_b16 v[124:125], v6 offset:32768
    v_mfma_f32_32x32x16_bf16 v[44:59], v[164:167], v[96:99], v[44:59]
    ds_read_b64_tr_b16 v[126:127], v6 offset:33280
    ds_read_b64_tr_b16 v[128:129], v6 offset:33024
    v_mfma_f32_32x32x16_bf16 v[60:75], v[164:167], v[100:103], v[60:75]
    ds_read_b64_tr_b16 v[130:131], v6 offset:33536
    ds_read_b64_tr_b16 v[132:133], v6 offset:33792
    ds_read_b64_tr_b16 v[134:135], v6 offset:34304
    v_mfma_f32_32x32x16_bf16 v[76:91], v[164:167], v[104:107], v[76:91]
    ds_read_b64_tr_b16 v[136:137], v6 offset:34048
    ds_read_b64_tr_b16 v[138:139], v6 offset:34560
    s_waitcnt vmcnt(10) lgkmcnt(8)
    v_mfma_f32_32x32x16_bf16 v[28:43], v[168:171], v[108:111], v[28:43]
    s_add_u32 s36, s28, 18432
    buffer_load_dwordx4 v[164:167], v9, s[12:15], s36 offen sc1
    ds_read_b64_tr_b16 v[92:93], v6 offset:36864
    v_mfma_f32_32x32x16_bf16 v[44:59], v[168:171], v[112:115], v[44:59]
    ds_read_b64_tr_b16 v[94:95], v6 offset:37376
    ds_read_b64_tr_b16 v[96:97], v6 offset:37120
    v_mfma_f32_32x32x16_bf16 v[60:75], v[168:171], v[116:119], v[60:75]
    ds_read_b64_tr_b16 v[98:99], v6 offset:37632
    ds_read_b64_tr_b16 v[100:101], v6 offset:37888
    ds_read_b64_tr_b16 v[102:103], v6 offset:38400
    v_mfma_f32_32x32x16_bf16 v[76:91], v[168:171], v[120:123], v[76:91]
    ds_read_b64_tr_b16 v[104:105], v6 offset:38144
    ds_read_b64_tr_b16 v[106:107], v6 offset:38656
    s_waitcnt vmcnt(10) lgkmcnt(8)
    v_mfma_f32_32x32x16_bf16 v[28:43], v[172:175], v[124:127], v[28:43]
    s_add_u32 s36, s28, 19456
    buffer_load_dwordx4 v[168:171], v9, s[12:15], s36 offen sc1
    ds_read_b64_tr_b16 v[108:109], v6 offset:40960
    v_mfma_f32_32x32x16_bf16 v[44:59], v[172:175], v[128:131], v[44:59]
    ds_read_b64_tr_b16 v[110:111], v6 offset:41472
    ds_read_b64_tr_b16 v[112:113], v6 offset:41216
    v_mfma_f32_32x32x16_bf16 v[60:75], v[172:175], v[132:135], v[60:75]
    ds_read_b64_tr_b16 v[114:115], v6 offset:41728
    ds_read_b64_tr_b16 v[116:117], v6 offset:41984
    ds_read_b64_tr_b16 v[118:119], v6 offset:42496
    v_mfma_f32_32x32x16_bf16 v[76:91], v[172:175], v[136:139], v[76:91]
    ds_read_b64_tr_b16 v[120:121], v6 offset:42240
    ds_read_b64_tr_b16 v[122:123], v6 offset:42752
    s_waitcnt vmcnt(10) lgkmcnt(8)
    v_mfma_f32_32x32x16_bf16 v[28:43], v[176:179], v[92:95], v[28:43]
    s_add_u32 s36, s28, 20480
    buffer_load_dwordx4 v[172:175], v9, s[12:15], s36 offen sc1
    ds_read_b64_tr_b16 v[124:125], v6 offset:45056
    v_mfma_f32_32x32x16_bf16 v[44:59], v[176:179], v[96:99], v[44:59]
    ds_read_b64_tr_b16 v[126:127], v6 offset:45568
    ds_read_b64_tr_b16 v[128:129], v6 offset:45312
    v_mfma_f32_32x32x16_bf16 v[60:75], v[176:179], v[100:103], v[60:75]
    ds_read_b64_tr_b16 v[130:131], v6 offset:45824
    ds_read_b64_tr_b16 v[132:133], v6 offset:46080
    ds_read_b64_tr_b16 v[134:135], v6 offset:46592
    v_mfma_f32_32x32x16_bf16 v[76:91], v[176:179], v[104:107], v[76:91]
    ds_read_b64_tr_b16 v[136:137], v6 offset:46336
    ds_read_b64_tr_b16 v[138:139], v6 offset:46848
    s_waitcnt vmcnt(10) lgkmcnt(8)
    v_mfma_f32_32x32x16_bf16 v[28:43], v[180:183], v[108:111], v[28:43]
    s_add_u32 s36, s28, 21504
    buffer_load_dwordx4 v[176:179], v9, s[12:15], s36 offen sc1
    ds_read_b64_tr_b16 v[92:93], v6 offset:49152
    v_mfma_f32_32x32x16_bf16 v[44:59], v[180:183], v[112:115], v[44:59]
    ds_read_b64_tr_b16 v[94:95], v6 offset:49664
    ds_read_b64_tr_b16 v[96:97], v6 offset:49408
    v_mfma_f32_32x32x16_bf16 v[60:75], v[180:183], v[116:119], v[60:75]
    ds_read_b64_tr_b16 v[98:99], v6 offset:49920
    ds_read_b64_tr_b16 v[100:101], v6 offset:50176
    ds_read_b64_tr_b16 v[102:103], v6 offset:50688
    v_mfma_f32_32x32x16_bf16 v[76:91], v[180:183], v[120:123], v[76:91]
    ds_read_b64_tr_b16 v[104:105], v6 offset:50432
    ds_read_b64_tr_b16 v[106:107], v6 offset:50944
    s_waitcnt vmcnt(10) lgkmcnt(8)
    v_mfma_f32_32x32x16_bf16 v[28:43], v[184:187], v[124:127], v[28:43]
    s_add_u32 s36, s28, 22528
    buffer_load_dwordx4 v[180:183], v9, s[12:15], s36 offen sc1
    ds_read_b64_tr_b16 v[108:109], v6 offset:53248
    v_mfma_f32_32x32x16_bf16 v[44:59], v[184:187], v[128:131], v[44:59]
    ds_read_b64_tr_b16 v[110:111], v6 offset:53760
    ds_read_b64_tr_b16 v[112:113], v6 offset:53504
    v_mfma_f32_32x32x16_bf16 v[60:75], v[184:187], v[132:135], v[60:75]
    ds_read_b64_tr_b16 v[114:115], v6 offset:54016
    ds_read_b64_tr_b16 v[116:117], v6 offset:54272
    ds_read_b64_tr_b16 v[118:119], v6 offset:54784
    v_mfma_f32_32x32x16_bf16 v[76:91], v[184:187], v[136:139], v[76:91]
    ds_read_b64_tr_b16 v[120:121], v6 offset:54528
    ds_read_b64_tr_b16 v[122:123], v6 offset:55040
    s_waitcnt vmcnt(10) lgkmcnt(8)
    v_mfma_f32_32x32x16_bf16 v[28:43], v[140:143], v[92:95], v[28:43]
    s_add_u32 s36, s28, 23552
    buffer_load_dwordx4 v[184:187], v9, s[12:15], s36 offen sc1
    ds_read_b64_tr_b16 v[124:125], v6 offset:57344
    v_mfma_f32_32x32x16_bf16 v[44:59], v[140:143], v[96:99], v[44:59]
    ds_read_b64_tr_b16 v[126:127], v6 offset:57856
    ds_read_b64_tr_b16 v[128:129], v6 offset:57600
    v_mfma_f32_32x32x16_bf16 v[60:75], v[140:143], v[100:103], v[60:75]
    ds_read_b64_tr_b16 v[130:131], v6 offset:58112
    ds_read_b64_tr_b16 v[132:133], v6 offset:58368
    ds_read_b64_tr_b16 v[134:135], v6 offset:58880
    v_mfma_f32_32x32x16_bf16 v[76:91], v[140:143], v[104:107], v[76:91]
    ds_read_b64_tr_b16 v[136:137], v6 offset:58624
    ds_read_b64_tr_b16 v[138:139], v6 offset:59136
    s_waitcnt vmcnt(10) lgkmcnt(8)
    v_mfma_f32_32x32x16_bf16 v[28:43], v[144:147], v[108:111], v[28:43]
    s_add_u32 s36, s28, 24576
    buffer_load_dwordx4 v[140:143], v9, s[12:15], s36 offen sc1
    ds_read_b64_tr_b16 v[92:93], v6 offset:61440
    v_mfma_f32_32x32x16_bf16 v[44:59], v[144:147], v[112:115], v[44:59]
    ds_read_b64_tr_b16 v[94:95], v6 offset:61952
    ds_read_b64_tr_b16 v[96:97], v6 offset:61696
    v_mfma_f32_32x32x16_bf16 v[60:75], v[144:147], v[116:119], v[60:75]
    ds_read_b64_tr_b16 v[98:99], v6 offset:62208
    ds_read_b64_tr_b16 v[100:101], v6 offset:62464
    ds_read_b64_tr_b16 v[102:103], v6 offset:62976
    v_mfma_f32_32x32x16_bf16 v[76:91], v[144:147], v[120:123], v[76:91]
    ds_read_b64_tr_b16 v[104:105], v6 offset:62720
    ds_read_b64_tr_b16 v[106:107], v6 offset:63232
    s_waitcnt vmcnt(10) lgkmcnt(8)
    v_mfma_f32_32x32x16_bf16 v[28:43], v[148:151], v[124:127], v[28:43]
    s_add_u32 s36, s28, 25600
    buffer_load_dwordx4 v[144:147], v9, s[12:15], s36 offen sc1
    ds_read_b64_tr_b16 v[108:109], v7 offset:0
    v_mfma_f32_32x32x16_bf16 v[44:59], v[148:151], v[128:131], v[44:59]
    ds_read_b64_tr_b16 v[110:111], v7 offset:512
    ds_read_b64_tr_b16 v[112:113], v7 offset:256
    v_mfma_f32_32x32x16_bf16 v[60:75], v[148:151], v[132:135], v[60:75]
    ds_read_b64_tr_b16 v[114:115], v7 offset:768
    ds_read_b64_tr_b16 v[116:117], v7 offset:1024
    ds_read_b64_tr_b16 v[118:119], v7 offset:1536
    v_mfma_f32_32x32x16_bf16 v[76:91], v[148:151], v[136:139], v[76:91]
    ds_read_b64_tr_b16 v[120:121], v7 offset:1280
    ds_read_b64_tr_b16 v[122:123], v7 offset:1792
    s_waitcnt vmcnt(10) lgkmcnt(8)
    v_mfma_f32_32x32x16_bf16 v[28:43], v[152:155], v[92:95], v[28:43]
    s_add_u32 s36, s28, 26624
    buffer_load_dwordx4 v[148:151], v9, s[12:15], s36 offen sc1
    ds_read_b64_tr_b16 v[124:125], v7 offset:4096
    v_mfma_f32_32x32x16_bf16 v[44:59], v[152:155], v[96:99], v[44:59]
    ds_read_b64_tr_b16 v[126:127], v7 offset:4608
    ds_read_b64_tr_b16 v[128:129], v7 offset:4352
    v_mfma_f32_32x32x16_bf16 v[60:75], v[152:155], v[100:103], v[60:75]
    ds_read_b64_tr_b16 v[130:131], v7 offset:4864
    ds_read_b64_tr_b16 v[132:133], v7 offset:5120
    ds_read_b64_tr_b16 v[134:135], v7 offset:5632
    v_mfma_f32_32x32x16_bf16 v[76:91], v[152:155], v[104:107], v[76:91]
    ds_read_b64_tr_b16 v[136:137], v7 offset:5376
    ds_read_b64_tr_b16 v[138:139], v7 offset:5888
    s_waitcnt vmcnt(10) lgkmcnt(8)
    v_mfma_f32_32x32x16_bf16 v[28:43], v[156:159], v[108:111], v[28:43]
    s_add_u32 s36, s28, 27648
    buffer_load_dwordx4 v[152:155], v9, s[12:15], s36 offen sc1
    ds_read_b64_tr_b16 v[92:93], v7 offset:8192
    v_mfma_f32_32x32x16_bf16 v[44:59], v[156:159], v[112:115], v[44:59]
    ds_read_b64_tr_b16 v[94:95], v7 offset:8704
    ds_read_b64_tr_b16 v[96:97], v7 offset:8448
    v_mfma_f32_32x32x16_bf16 v[60:75], v[156:159], v[116:119], v[60:75]
    ds_read_b64_tr_b16 v[98:99], v7 offset:8960
    ds_read_b64_tr_b16 v[100:101], v7 offset:9216
    ds_read_b64_tr_b16 v[102:103], v7 offset:9728
    v_mfma_f32_32x32x16_bf16 v[76:91], v[156:159], v[120:123], v[76:91]
    ds_read_b64_tr_b16 v[104:105], v7 offset:9472
    ds_read_b64_tr_b16 v[106:107], v7 offset:9984
    s_waitcnt vmcnt(10) lgkmcnt(8)
    v_mfma_f32_32x32x16_bf16 v[28:43], v[160:163], v[124:127], v[28:43]
    s_add_u32 s36, s28, 28672
    buffer_load_dwordx4 v[156:159], v9, s[12:15], s36 offen sc1
    ds_read_b64_tr_b16 v[108:109], v7 offset:12288
    v_mfma_f32_32x32x16_bf16 v[44:59], v[160:163], v[128:131], v[44:59]
    ds_read_b64_tr_b16 v[110:111], v7 offset:12800
    ds_read_b64_tr_b16 v[112:113], v7 offset:12544
    v_mfma_f32_32x32x16_bf16 v[60:75], v[160:163], v[132:135], v[60:75]
    ds_read_b64_tr_b16 v[114:115], v7 offset:13056
    ds_read_b64_tr_b16 v[116:117], v7 offset:13312
    ds_read_b64_tr_b16 v[118:119], v7 offset:13824
    v_mfma_f32_32x32x16_bf16 v[76:91], v[160:163], v[136:139], v[76:91]
    ds_read_b64_tr_b16 v[120:121], v7 offset:13568
    ds_read_b64_tr_b16 v[122:123], v7 offset:14080
    s_waitcnt lgkmcnt(0)
    s_barrier
    s_waitcnt vmcnt(10) lgkmcnt(8)
    v_mfma_f32_32x32x16_bf16 v[28:43], v[164:167], v[92:95], v[28:43]
    s_add_u32 s36, s28, 29696
    buffer_load_dwordx4 v[160:163], v9, s[12:15], s36 offen sc1
    ds_read_b64_tr_b16 v[124:125], v7 offset:16384
    v_mfma_f32_32x32x16_bf16 v[44:59], v[164:167], v[96:99], v[44:59]
    ds_read_b64_tr_b16 v[126:127], v7 offset:16896
    ds_read_b64_tr_b16 v[128:129], v7 offset:16640
    v_mfma_f32_32x32x16_bf16 v[60:75], v[164:167], v[100:103], v[60:75]
    ds_read_b64_tr_b16 v[130:131], v7 offset:17152
    ds_read_b64_tr_b16 v[132:133], v7 offset:17408
    ds_read_b64_tr_b16 v[134:135], v7 offset:17920
    v_mfma_f32_32x32x16_bf16 v[76:91], v[164:167], v[104:107], v[76:91]
    ds_read_b64_tr_b16 v[136:137], v7 offset:17664
    ds_read_b64_tr_b16 v[138:139], v7 offset:18176
    s_waitcnt vmcnt(10) lgkmcnt(8)
    v_mfma_f32_32x32x16_bf16 v[28:43], v[168:171], v[108:111], v[28:43]
    s_add_u32 s36, s28, 30720
    buffer_load_dwordx4 v[164:167], v9, s[12:15], s36 offen sc1
    ds_read_b64_tr_b16 v[92:93], v7 offset:20480
    v_mfma_f32_32x32x16_bf16 v[44:59], v[168:171], v[112:115], v[44:59]
    ds_read_b64_tr_b16 v[94:95], v7 offset:20992
    ds_read_b64_tr_b16 v[96:97], v7 offset:20736
    v_mfma_f32_32x32x16_bf16 v[60:75], v[168:171], v[116:119], v[60:75]
    ds_read_b64_tr_b16 v[98:99], v7 offset:21248
    ds_read_b64_tr_b16 v[100:101], v7 offset:21504
    ds_read_b64_tr_b16 v[102:103], v7 offset:22016
    v_mfma_f32_32x32x16_bf16 v[76:91], v[168:171], v[120:123], v[76:91]
    ds_read_b64_tr_b16 v[104:105], v7 offset:21760
    ds_read_b64_tr_b16 v[106:107], v7 offset:22272
    s_waitcnt vmcnt(10) lgkmcnt(8)
    v_mfma_f32_32x32x16_bf16 v[28:43], v[172:175], v[124:127], v[28:43]
    s_add_u32 s36, s28, 31744
    buffer_load_dwordx4 v[168:171], v9, s[12:15], s36 offen sc1
    ds_read_b64_tr_b16 v[108:109], v7 offset:24576
    v_mfma_f32_32x32x16_bf16 v[44:59], v[172:175], v[128:131], v[44:59]
    ds_read_b64_tr_b16 v[110:111], v7 offset:25088
    ds_read_b64_tr_b16 v[112:113], v7 offset:24832
    v_mfma_f32_32x32x16_bf16 v[60:75], v[172:175], v[132:135], v[60:75]
    ds_read_b64_tr_b16 v[114:115], v7 offset:25344
    ds_read_b64_tr_b16 v[116:117], v7 offset:25600
    ds_read_b64_tr_b16 v[118:119], v7 offset:26112
    v_mfma_f32_32x32x16_bf16 v[76:91], v[172:175], v[136:139], v[76:91]
    ds_read_b64_tr_b16 v[120:121], v7 offset:25856
    ds_read_b64_tr_b16 v[122:123], v7 offset:26368
    s_waitcnt vmcnt(10) lgkmcnt(8)
    v_mfma_f32_32x32x16_bf16 v[28:43], v[176:179], v[92:95], v[28:43]
    s_add_u32 s36, s28, 32768
    buffer_load_dwordx4 v[172:175], v9, s[12:15], s36 offen sc1
    ds_read_b64_tr_b16 v[124:125], v7 offset:28672
    v_mfma_f32_32x32x16_bf16 v[44:59], v[176:179], v[96:99], v[44:59]
    ds_read_b64_tr_b16 v[126:127], v7 offset:29184
    ds_read_b64_tr_b16 v[128:129], v7 offset:28928
    v_mfma_f32_32x32x16_bf16 v[60:75], v[176:179], v[100:103], v[60:75]
    ds_read_b64_tr_b16 v[130:131], v7 offset:29440
    ds_read_b64_tr_b16 v[132:133], v7 offset:29696
    ds_read_b64_tr_b16 v[134:135], v7 offset:30208
    v_mfma_f32_32x32x16_bf16 v[76:91], v[176:179], v[104:107], v[76:91]
    ds_read_b64_tr_b16 v[136:137], v7 offset:29952
    ds_read_b64_tr_b16 v[138:139], v7 offset:30464
    s_waitcnt vmcnt(10) lgkmcnt(8)
    v_mfma_f32_32x32x16_bf16 v[28:43], v[180:183], v[108:111], v[28:43]
    s_add_u32 s36, s28, 33792
    buffer_load_dwordx4 v[176:179], v9, s[12:15], s36 offen sc1
    ds_read_b32 v220, v2 offset:0
    ds_read_b32 v221, v2 offset:128
    v_mfma_f32_32x32x16_bf16 v[44:59], v[180:183], v[112:115], v[44:59]
    ds_read_b32 v222, v2 offset:256
    ds_read_b64_tr_b16 v[92:93], v7 offset:32768
    ds_read_b64_tr_b16 v[94:95], v7 offset:33280
    v_mfma_f32_32x32x16_bf16 v[60:75], v[180:183], v[116:119], v[60:75]
    ds_read_b64_tr_b16 v[96:97], v7 offset:33024
    ds_read_b64_tr_b16 v[98:99], v7 offset:33536
    ds_read_b64_tr_b16 v[100:101], v7 offset:33792
    v_mfma_f32_32x32x16_bf16 v[76:91], v[180:183], v[120:123], v[76:91]
    ds_read_b64_tr_b16 v[102:103], v7 offset:34304
    ds_read_b64_tr_b16 v[104:105], v7 offset:34048
    ds_read_b64_tr_b16 v[106:107], v7 offset:34560
    s_waitcnt vmcnt(10) lgkmcnt(8)
    v_mfma_f32_32x32x16_bf16 v[28:43], v[184:187], v[124:127], v[28:43]
    s_add_u32 s36, s28, 34816
    buffer_load_dwordx4 v[180:183], v9, s[12:15], s36 offen sc1
    ds_read_b32 v223, v2 offset:384
    ds_read_b128 v[188:191], v3 offset:0
    v_mfma_f32_32x32x16_bf16 v[44:59], v[184:187], v[128:131], v[44:59]
    ds_read_b128 v[204:207], v3 offset:512
    ds_read_b64_tr_b16 v[108:109], v7 offset:36864
    ds_read_b64_tr_b16 v[110:111], v7 offset:37376
    v_mfma_f32_32x32x16_bf16 v[60:75], v[184:187], v[132:135], v[60:75]
    ds_read_b64_tr_b16 v[112:113], v7 offset:37120
    ds_read_b64_tr_b16 v[114:115], v7 offset:37632
    ds_read_b64_tr_b16 v[116:117], v7 offset:37888
    v_mfma_f32_32x32x16_bf16 v[76:91], v[184:187], v[136:139], v[76:91]
    ds_read_b64_tr_b16 v[118:119], v7 offset:38400
    ds_read_b64_tr_b16 v[120:121], v7 offset:38144
    ds_read_b64_tr_b16 v[122:123], v7 offset:38656
    s_waitcnt vmcnt(10) lgkmcnt(8)
    v_mfma_f32_32x32x16_bf16 v[28:43], v[140:143], v[92:95], v[28:43]
    s_add_u32 s36, s28, 35840
    buffer_load_dwordx4 v[184:187], v9, s[12:15], s36 offen sc1
    ds_read_b128 v[192:195], v3 offset:32
    ds_read_b128 v[208:211], v3 offset:544
    v_mfma_f32_32x32x16_bf16 v[44:59], v[140:143], v[96:99], v[44:59]
    ds_read_b128 v[196:199], v3 offset:64
    ds_read_b64_tr_b16 v[124:125], v7 offset:40960
    ds_read_b64_tr_b16 v[126:127], v7 offset:41472
    v_mfma_f32_32x32x16_bf16 v[60:75], v[140:143], v[100:103], v[60:75]
    ds_read_b64_tr_b16 v[128:129], v7 offset:41216
    ds_read_b64_tr_b16 v[130:131], v7 offset:41728
    ds_read_b64_tr_b16 v[132:133], v7 offset:41984
    v_mfma_f32_32x32x16_bf16 v[76:91], v[140:143], v[104:107], v[76:91]
    ds_read_b64_tr_b16 v[134:135], v7 offset:42496
    ds_read_b64_tr_b16 v[136:137], v7 offset:42240
    ds_read_b64_tr_b16 v[138:139], v7 offset:42752
    s_waitcnt vmcnt(10) lgkmcnt(8)
    v_mfma_f32_32x32x16_bf16 v[28:43], v[144:147], v[108:111], v[28:43]
    s_add_u32 s36, s28, 36864
    buffer_load_dwordx4 v[140:143], v9, s[12:15], s36 offen sc1
    ds_read_b128 v[212:215], v3 offset:576
    ds_read_b128 v[200:203], v3 offset:96
    v_mfma_f32_32x32x16_bf16 v[44:59], v[144:147], v[112:115], v[44:59]
    ds_read_b128 v[216:219], v3 offset:608
    ds_read_b64_tr_b16 v[92:93], v7 offset:45056
    ds_read_b64_tr_b16 v[94:95], v7 offset:45568
    v_mfma_f32_32x32x16_bf16 v[60:75], v[144:147], v[116:119], v[60:75]
    ds_read_b64_tr_b16 v[96:97], v7 offset:45312
    ds_read_b64_tr_b16 v[98:99], v7 offset:45824
    ds_read_b64_tr_b16 v[100:101], v7 offset:46080
    v_mfma_f32_32x32x16_bf16 v[76:91], v[144:147], v[120:123], v[76:91]
    ds_read_b64_tr_b16 v[102:103], v7 offset:46592
    ds_read_b64_tr_b16 v[104:105], v7 offset:46336
    ds_read_b64_tr_b16 v[106:107], v7 offset:46848
    s_waitcnt vmcnt(10) lgkmcnt(8)
    v_mfma_f32_32x32x16_bf16 v[28:43], v[148:151], v[124:127], v[28:43]
    s_add_u32 s36, s28, 37888
    buffer_load_dwordx4 v[144:147], v9, s[12:15], s36 offen sc1
    ds_read_b64_tr_b16 v[108:109], v7 offset:49152
    v_mfma_f32_32x32x16_bf16 v[44:59], v[148:151], v[128:131], v[44:59]
    ds_read_b64_tr_b16 v[110:111], v7 offset:49664
    ds_read_b64_tr_b16 v[112:113], v7 offset:49408
    v_mfma_f32_32x32x16_bf16 v[60:75], v[148:151], v[132:135], v[60:75]
    ds_read_b64_tr_b16 v[114:115], v7 offset:49920
    ds_read_b64_tr_b16 v[116:117], v7 offset:50176
    ds_read_b64_tr_b16 v[118:119], v7 offset:50688
    v_mfma_f32_32x32x16_bf16 v[76:91], v[148:151], v[136:139], v[76:91]
    ds_read_b64_tr_b16 v[120:121], v7 offset:50432
    ds_read_b64_tr_b16 v[122:123], v7 offset:50944
    s_waitcnt vmcnt(10) lgkmcnt(8)
    v_mfma_f32_32x32x16_bf16 v[28:43], v[152:155], v[92:95], v[28:43]
    s_add_u32 s36, s28, 38912
    buffer_load_dwordx4 v[148:151], v9, s[12:15], s36 offen sc1
    ds_read_b64_tr_b16 v[124:125], v7 offset:53248
    v_mfma_f32_32x32x16_bf16 v[44:59], v[152:155], v[96:99], v[44:59]
    ds_read_b64_tr_b16 v[126:127], v7 offset:53760
    ds_read_b64_tr_b16 v[128:129], v7 offset:53504
    v_mfma_f32_32x32x16_bf16 v[60:75], v[152:155], v[100:103], v[60:75]
    ds_read_b64_tr_b16 v[130:131], v7 offset:54016
    ds_read_b64_tr_b16 v[132:133], v7 offset:54272
    ds_read_b64_tr_b16 v[134:135], v7 offset:54784
    v_mfma_f32_32x32x16_bf16 v[76:91], v[152:155], v[104:107], v[76:91]
    ds_read_b64_tr_b16 v[136:137], v7 offset:54528
    ds_read_b64_tr_b16 v[138:139], v7 offset:55040
    s_waitcnt vmcnt(10) lgkmcnt(8)
    v_mfma_f32_32x32x16_bf16 v[28:43], v[156:159], v[108:111], v[28:43]
    s_add_u32 s36, s28, 39936
    buffer_load_dwordx4 v[152:155], v9, s[12:15], s36 offen sc1
    ds_read_b64_tr_b16 v[92:93], v7 offset:57344
    v_mfma_f32_32x32x16_bf16 v[44:59], v[156:159], v[112:115], v[44:59]
    ds_read_b64_tr_b16 v[94:95], v7 offset:57856
    ds_read_b64_tr_b16 v[96:97], v7 offset:57600
    v_mfma_f32_32x32x16_bf16 v[60:75], v[156:159], v[116:119], v[60:75]
    ds_read_b64_tr_b16 v[98:99], v7 offset:58112
    ds_read_b64_tr_b16 v[100:101], v7 offset:58368
    ds_read_b64_tr_b16 v[102:103], v7 offset:58880
    v_mfma_f32_32x32x16_bf16 v[76:91], v[156:159], v[120:123], v[76:91]
    ds_read_b64_tr_b16 v[104:105], v7 offset:58624
    ds_read_b64_tr_b16 v[106:107], v7 offset:59136
    s_waitcnt vmcnt(10) lgkmcnt(8)
    v_mfma_f32_32x32x16_bf16 v[28:43], v[160:163], v[124:127], v[28:43]
    ds_read_b64_tr_b16 v[108:109], v7 offset:61440
    ds_read_b64_tr_b16 v[110:111], v7 offset:61952
    v_mfma_f32_32x32x16_bf16 v[44:59], v[160:163], v[128:131], v[44:59]
    ds_read_b64_tr_b16 v[112:113], v7 offset:61696
    ds_read_b64_tr_b16 v[114:115], v7 offset:62208
    v_mfma_f32_32x32x16_bf16 v[60:75], v[160:163], v[132:135], v[60:75]
    ds_read_b64_tr_b16 v[116:117], v7 offset:62464
    ds_read_b64_tr_b16 v[118:119], v7 offset:62976
    v_mfma_f32_32x32x16_bf16 v[76:91], v[160:163], v[136:139], v[76:91]
    ds_read_b64_tr_b16 v[120:121], v7 offset:62720
    ds_read_b64_tr_b16 v[122:123], v7 offset:63232
    s_waitcnt lgkmcnt(0)
    s_barrier
    s_waitcnt vmcnt(9) lgkmcnt(8)
    v_mfma_f32_32x32x16_bf16 v[28:43], v[164:167], v[92:95], v[28:43]
    ds_read_b64_tr_b16 v[124:125], v8 offset:0
    ds_read_b64_tr_b16 v[126:127], v8 offset:512
    v_mfma_f32_32x32x16_bf16 v[44:59], v[164:167], v[96:99], v[44:59]
    ds_read_b64_tr_b16 v[128:129], v8 offset:4096
    ds_read_b64_tr_b16 v[130:131], v8 offset:4608
    v_mfma_f32_32x32x16_bf16 v[60:75], v[164:167], v[100:103], v[60:75]
    ds_read_b64_tr_b16 v[132:133], v8 offset:8192
    ds_read_b64_tr_b16 v[134:135], v8 offset:8704
    v_mfma_f32_32x32x16_bf16 v[76:91], v[164:167], v[104:107], v[76:91]
    ds_read_b64_tr_b16 v[136:137], v8 offset:12288
    ds_read_b64_tr_b16 v[138:139], v8 offset:12800
    s_waitcnt vmcnt(8) lgkmcnt(8)
    v_mfma_f32_32x32x16_bf16 v[28:43], v[168:171], v[108:111], v[28:43]
    ds_read_b64_tr_b16 v[92:93], v6 offset:0
    ds_read_b64_tr_b16 v[94:95], v6 offset:512
    v_mfma_f32_32x32x16_bf16 v[44:59], v[168:171], v[112:115], v[44:59]
    ds_read_b64_tr_b16 v[96:97], v6 offset:4096
    ds_read_b64_tr_b16 v[98:99], v6 offset:4608
    v_mfma_f32_32x32x16_bf16 v[60:75], v[168:171], v[116:119], v[60:75]
    ds_read_b64_tr_b16 v[100:101], v6 offset:8192
    ds_read_b64_tr_b16 v[102:103], v6 offset:8704
    v_mfma_f32_32x32x16_bf16 v[76:91], v[168:171], v[120:123], v[76:91]
    ds_read_b64_tr_b16 v[104:105], v6 offset:12288
    ds_read_b64_tr_b16 v[106:107], v6 offset:12800
    s_waitcnt vmcnt(4) lgkmcnt(8)
    v_mfma_f32_32x32x16_bf16 v[28:43], v[172:175], v[124:127], v[28:43]
    ds_read_b64_tr_b16 v[108:109], v8 offset:256
    ds_read_b64_tr_b16 v[110:111], v8 offset:768
    v_mfma_f32_32x32x16_bf16 v[28:43], v[176:179], v[128:131], v[28:43]
    ds_read_b64_tr_b16 v[112:113], v8 offset:4352
    ds_read_b64_tr_b16 v[114:115], v8 offset:4864
    v_mfma_f32_32x32x16_bf16 v[28:43], v[180:183], v[132:135], v[28:43]
    ds_read_b64_tr_b16 v[116:117], v8 offset:8448
    ds_read_b64_tr_b16 v[118:119], v8 offset:8960
    v_mfma_f32_32x32x16_bf16 v[28:43], v[184:187], v[136:139], v[28:43]
    ds_read_b64_tr_b16 v[120:121], v8 offset:12544
    ds_read_b64_tr_b16 v[122:123], v8 offset:13056
    s_waitcnt vmcnt(0) lgkmcnt(8)
    v_mfma_f32_32x32x16_bf16 v[28:43], v[140:143], v[92:95], v[28:43]
    ds_read_b64_tr_b16 v[124:125], v6 offset:256
    ds_read_b64_tr_b16 v[126:127], v6 offset:768
    v_mfma_f32_32x32x16_bf16 v[28:43], v[144:147], v[96:99], v[28:43]
    ds_read_b64_tr_b16 v[128:129], v6 offset:4352
    ds_read_b64_tr_b16 v[130:131], v6 offset:4864
    v_mfma_f32_32x32x16_bf16 v[28:43], v[148:151], v[100:103], v[28:43]
    ds_read_b64_tr_b16 v[132:133], v6 offset:8448
    ds_read_b64_tr_b16 v[134:135], v6 offset:8960
    v_mfma_f32_32x32x16_bf16 v[28:43], v[152:155], v[104:107], v[28:43]
    ds_read_b64_tr_b16 v[136:137], v6 offset:12544
    ds_read_b64_tr_b16 v[138:139], v6 offset:13056
    s_waitcnt lgkmcnt(8)
    v_mfma_f32_32x32x16_bf16 v[44:59], v[172:175], v[108:111], v[44:59]
    ds_read_b64_tr_b16 v[92:93], v8 offset:1024
    ds_read_b64_tr_b16 v[94:95], v8 offset:1536
    ds_read_b64_tr_b16 v[96:97], v8 offset:5120
    ds_read_b64_tr_b16 v[98:99], v8 offset:5632
    ds_read_b64_tr_b16 v[100:101], v8 offset:9216
    ds_read_b64_tr_b16 v[102:103], v8 offset:9728
    ds_read_b64_tr_b16 v[104:105], v8 offset:13312
    ds_read_b64_tr_b16 v[106:107], v8 offset:13824
    s_nop 1
    v_mfma_f32_32x32x16_bf16 v[44:59], v[176:179], v[112:115], v[44:59]
    v_fma_f32 v28, -v204, v220, v28
    v_fma_f32 v29, -v205, v220, v29
    v_fma_f32 v30, -v206, v220, v30
    v_fma_f32 v31, -v207, v220, v31
    v_fma_f32 v32, -v208, v220, v32
    v_fma_f32 v33, -v209, v220, v33
    v_mfma_f32_32x32x16_bf16 v[44:59], v[180:183], v[116:119], v[44:59]
    v_fma_f32 v34, -v210, v220, v34
    v_fma_f32 v35, -v211, v220, v35
    v_fma_f32 v36, -v212, v220, v36
    v_fma_f32 v37, -v213, v220, v37
    v_fma_f32 v38, -v214, v220, v38
    v_fma_f32 v39, -v215, v220, v39
    v_mfma_f32_32x32x16_bf16 v[44:59], v[184:187], v[120:123], v[44:59]
    v_fma_f32 v40, -v216, v220, v40
    v_fma_f32 v41, -v217, v220, v41
    v_fma_f32 v42, -v218, v220, v42
    v_fma_f32 v43, -v219, v220, v43
    v_mul_f32 v28, v188, v28
    s_waitcnt lgkmcnt(8)
    v_mfma_f32_32x32x16_bf16 v[44:59], v[140:143], v[124:127], v[44:59]
    ds_read_b64_tr_b16 v[108:109], v6 offset:1024
    ds_read_b64_tr_b16 v[110:111], v6 offset:1536
    ds_read_b64_tr_b16 v[112:113], v6 offset:5120
    ds_read_b64_tr_b16 v[114:115], v6 offset:5632
    ds_read_b64_tr_b16 v[116:117], v6 offset:9216
    ds_read_b64_tr_b16 v[118:119], v6 offset:9728
    ds_read_b64_tr_b16 v[120:121], v6 offset:13312
    ds_read_b64_tr_b16 v[122:123], v6 offset:13824
    v_mfma_f32_32x32x16_bf16 v[44:59], v[144:147], v[128:131], v[44:59]
    v_mul_f32 v29, v189, v29
    v_mul_f32 v30, v190, v30
    v_mul_f32 v31, v191, v31
    v_mul_f32 v32, v192, v32
    v_mul_f32 v33, v193, v33
    v_mul_f32 v34, v194, v34
    v_mul_f32 v35, v195, v35
    v_mul_f32 v36, v196, v36
    v_mfma_f32_32x32x16_bf16 v[44:59], v[148:151], v[132:135], v[44:59]
    v_mul_f32 v37, v197, v37
    v_mul_f32 v38, v198, v38
    v_mul_f32 v39, v199, v39
    v_mul_f32 v40, v200, v40
    v_mul_f32 v41, v201, v41
    v_mul_f32 v42, v202, v42
    v_mul_f32 v43, v203, v43
    v_cvt_pk_bf16_f32 v28, v28, v29
    v_mfma_f32_32x32x16_bf16 v[44:59], v[152:155], v[136:139], v[44:59]
    v_cvt_pk_bf16_f32 v29, v30, v31
    v_cvt_pk_bf16_f32 v30, v32, v33
    v_cvt_pk_bf16_f32 v31, v34, v35
    v_cvt_pk_bf16_f32 v32, v36, v37
    v_cvt_pk_bf16_f32 v33, v38, v39
    v_cvt_pk_bf16_f32 v34, v40, v41
    v_cvt_pk_bf16_f32 v35, v42, v43
    s_nop 0
    buffer_store_dwordx4 v[28:31], v12, s[12:15], s43 offen offset:0 sc1
    buffer_store_dwordx4 v[32:35], v12, s[12:15], s43 offen offset:640 sc1
    s_waitcnt lgkmcnt(8)
    v_mfma_f32_32x32x16_bf16 v[60:75], v[172:175], v[92:95], v[60:75]
    ds_read_b64_tr_b16 v[124:125], v8 offset:1280
    ds_read_b64_tr_b16 v[126:127], v8 offset:1792
    ds_read_b64_tr_b16 v[128:129], v8 offset:5376
    ds_read_b64_tr_b16 v[130:131], v8 offset:5888
    ds_read_b64_tr_b16 v[132:133], v8 offset:9472
    ds_read_b64_tr_b16 v[134:135], v8 offset:9984
    ds_read_b64_tr_b16 v[136:137], v8 offset:13568
    ds_read_b64_tr_b16 v[138:139], v8 offset:14080
    s_nop 1
    v_mfma_f32_32x32x16_bf16 v[60:75], v[176:179], v[96:99], v[60:75]
    v_fma_f32 v44, -v204, v221, v44
    v_fma_f32 v45, -v205, v221, v45
    v_fma_f32 v46, -v206, v221, v46
    v_fma_f32 v47, -v207, v221, v47
    v_fma_f32 v48, -v208, v221, v48
    v_fma_f32 v49, -v209, v221, v49
    v_mfma_f32_32x32x16_bf16 v[60:75], v[180:183], v[100:103], v[60:75]
    v_fma_f32 v50, -v210, v221, v50
    v_fma_f32 v51, -v211, v221, v51
    v_fma_f32 v52, -v212, v221, v52
    v_fma_f32 v53, -v213, v221, v53
    v_fma_f32 v54, -v214, v221, v54
    v_fma_f32 v55, -v215, v221, v55
    v_mfma_f32_32x32x16_bf16 v[60:75], v[184:187], v[104:107], v[60:75]
    v_fma_f32 v56, -v216, v221, v56
    v_fma_f32 v57, -v217, v221, v57
    v_fma_f32 v58, -v218, v221, v58
    v_fma_f32 v59, -v219, v221, v59
    v_mul_f32 v44, v188, v44
    s_waitcnt lgkmcnt(8)
    v_mfma_f32_32x32x16_bf16 v[60:75], v[140:143], v[108:111], v[60:75]
    ds_read_b64_tr_b16 v[92:93], v6 offset:1280
    ds_read_b64_tr_b16 v[94:95], v6 offset:1792
    ds_read_b64_tr_b16 v[96:97], v6 offset:5376
    ds_read_b64_tr_b16 v[98:99], v6 offset:5888
    ds_read_b64_tr_b16 v[100:101], v6 offset:9472
    ds_read_b64_tr_b16 v[102:103], v6 offset:9984
    ds_read_b64_tr_b16 v[104:105], v6 offset:13568
    ds_read_b64_tr_b16 v[106:107], v6 offset:14080
    v_mfma_f32_32x32x16_bf16 v[60:75], v[144:147], v[112:115], v[60:75]
    v_mul_f32 v45, v189, v45
    v_mul_f32 v46, v190, v46
    v_mul_f32 v47, v191, v47
    v_mul_f32 v48, v192, v48
    v_mul_f32 v49, v193, v49
    v_mul_f32 v50, v194, v50
    v_mul_f32 v51, v195, v51
    v_mul_f32 v52, v196, v52
    v_mfma_f32_32x32x16_bf16 v[60:75], v[148:151], v[116:119], v[60:75]
    v_mul_f32 v53, v197, v53
    v_mul_f32 v54, v198, v54
    v_mul_f32 v55, v199, v55
    v_mul_f32 v56, v200, v56
    v_mul_f32 v57, v201, v57
    v_mul_f32 v58, v202, v58
    v_mul_f32 v59, v203, v59
    v_cvt_pk_bf16_f32 v36, v44, v45
    v_mfma_f32_32x32x16_bf16 v[60:75], v[152:155], v[120:123], v[60:75]
    v_cvt_pk_bf16_f32 v37, v46, v47
    v_cvt_pk_bf16_f32 v38, v48, v49
    v_cvt_pk_bf16_f32 v39, v50, v51
    v_cvt_pk_bf16_f32 v40, v52, v53
    v_cvt_pk_bf16_f32 v41, v54, v55
    v_cvt_pk_bf16_f32 v42, v56, v57
    v_cvt_pk_bf16_f32 v43, v58, v59
    s_nop 0
    buffer_store_dwordx4 v[36:39], v13, s[12:15], s43 offen offset:0 sc1
    buffer_store_dwordx4 v[40:43], v13, s[12:15], s43 offen offset:640 sc1
    s_waitcnt lgkmcnt(8)
    v_mfma_f32_32x32x16_bf16 v[76:91], v[172:175], v[124:127], v[76:91]
    s_nop 9
    v_mfma_f32_32x32x16_bf16 v[76:91], v[176:179], v[128:131], v[76:91]
    v_fma_f32 v60, -v204, v222, v60
    v_fma_f32 v61, -v205, v222, v61
    v_fma_f32 v62, -v206, v222, v62
    v_fma_f32 v63, -v207, v222, v63
    v_fma_f32 v64, -v208, v222, v64
    v_fma_f32 v65, -v209, v222, v65
    v_mfma_f32_32x32x16_bf16 v[76:91], v[180:183], v[132:135], v[76:91]
    v_fma_f32 v66, -v210, v222, v66
    v_fma_f32 v67, -v211, v222, v67
    v_fma_f32 v68, -v212, v222, v68
    v_fma_f32 v69, -v213, v222, v69
    v_fma_f32 v70, -v214, v222, v70
    v_fma_f32 v71, -v215, v222, v71
    v_mfma_f32_32x32x16_bf16 v[76:91], v[184:187], v[136:139], v[76:91]
    v_fma_f32 v72, -v216, v222, v72
    v_fma_f32 v73, -v217, v222, v73
    v_fma_f32 v74, -v218, v222, v74
    v_fma_f32 v75, -v219, v222, v75
    v_mul_f32 v60, v188, v60
    s_waitcnt lgkmcnt(0)
    v_mfma_f32_32x32x16_bf16 v[76:91], v[140:143], v[92:95], v[76:91]
    v_mul_f32 v61, v189, v61
    v_mul_f32 v62, v190, v62
    v_mul_f32 v63, v191, v63
    v_mul_f32 v64, v192, v64
    v_mul_f32 v65, v193, v65
    v_mul_f32 v66, v194, v66
    v_mfma_f32_32x32x16_bf16 v[76:91], v[144:147], v[96:99], v[76:91]
    v_mul_f32 v67, v195, v67
    v_mul_f32 v68, v196, v68
    v_mul_f32 v69, v197, v69
    v_mul_f32 v70, v198, v70
    v_mul_f32 v71, v199, v71
    v_mul_f32 v72, v200, v72
    v_mfma_f32_32x32x16_bf16 v[76:91], v[148:151], v[100:103], v[76:91]
    v_mul_f32 v73, v201, v73
    v_mul_f32 v74, v202, v74
    v_mul_f32 v75, v203, v75
    v_cvt_pk_bf16_f32 v44, v60, v61
    v_cvt_pk_bf16_f32 v45, v62, v63
    v_cvt_pk_bf16_f32 v46, v64, v65
    v_mfma_f32_32x32x16_bf16 v[76:91], v[152:155], v[104:107], v[76:91]
    v_cvt_pk_bf16_f32 v47, v66, v67
    v_cvt_pk_bf16_f32 v48, v68, v69
    v_cvt_pk_bf16_f32 v49, v70, v71
    v_cvt_pk_bf16_f32 v50, v72, v73
    v_cvt_pk_bf16_f32 v51, v74, v75
    s_nop 0
    buffer_store_dwordx4 v[44:47], v14, s[12:15], s43 offen offset:0 sc1
    buffer_store_dwordx4 v[48:51], v14, s[12:15], s43 offen offset:640 sc1
    s_nop 7
    v_pk_fma_f32 v[76:77], v[204:205], v[222:223], v[76:77] op_sel:[0,1,0] op_sel_hi:[1,1,1] neg_lo:[1,0,0] neg_hi:[1,0,0]
    v_pk_fma_f32 v[78:79], v[206:207], v[222:223], v[78:79] op_sel:[0,1,0] op_sel_hi:[1,1,1] neg_lo:[1,0,0] neg_hi:[1,0,0]
    v_pk_fma_f32 v[80:81], v[208:209], v[222:223], v[80:81] op_sel:[0,1,0] op_sel_hi:[1,1,1] neg_lo:[1,0,0] neg_hi:[1,0,0]
    v_pk_fma_f32 v[82:83], v[210:211], v[222:223], v[82:83] op_sel:[0,1,0] op_sel_hi:[1,1,1] neg_lo:[1,0,0] neg_hi:[1,0,0]
    v_pk_fma_f32 v[84:85], v[212:213], v[222:223], v[84:85] op_sel:[0,1,0] op_sel_hi:[1,1,1] neg_lo:[1,0,0] neg_hi:[1,0,0]
    v_pk_fma_f32 v[86:87], v[214:215], v[222:223], v[86:87] op_sel:[0,1,0] op_sel_hi:[1,1,1] neg_lo:[1,0,0] neg_hi:[1,0,0]
    v_pk_fma_f32 v[88:89], v[216:217], v[222:223], v[88:89] op_sel:[0,1,0] op_sel_hi:[1,1,1] neg_lo:[1,0,0] neg_hi:[1,0,0]
    v_pk_fma_f32 v[90:91], v[218:219], v[222:223], v[90:91] op_sel:[0,1,0] op_sel_hi:[1,1,1] neg_lo:[1,0,0] neg_hi:[1,0,0]
    v_pk_mul_f32 v[76:77], v[188:189], v[76:77]
    v_pk_mul_f32 v[78:79], v[190:191], v[78:79]
    v_pk_mul_f32 v[80:81], v[192:193], v[80:81]
    v_pk_mul_f32 v[82:83], v[194:195], v[82:83]
    v_pk_mul_f32 v[84:85], v[196:197], v[84:85]
    v_pk_mul_f32 v[86:87], v[198:199], v[86:87]
    v_pk_mul_f32 v[88:89], v[200:201], v[88:89]
    v_pk_mul_f32 v[90:91], v[202:203], v[90:91]
    v_cvt_pk_bf16_f32 v52, v76, v77
    v_cvt_pk_bf16_f32 v53, v78, v79
    v_cvt_pk_bf16_f32 v54, v80, v81
    v_cvt_pk_bf16_f32 v55, v82, v83
    v_cvt_pk_bf16_f32 v56, v84, v85
    v_cvt_pk_bf16_f32 v57, v86, v87
    v_cvt_pk_bf16_f32 v58, v88, v89
    v_cvt_pk_bf16_f32 v59, v90, v91
    s_nop 0
    buffer_store_dwordx4 v[52:55], v15, s[12:15], s43 offen offset:0 sc1
    buffer_store_dwordx4 v[56:59], v15, s[12:15], s43 offen offset:640 sc1
tl_qsig:
    s_mul_i32 s36, s61, 4096
    s_mul_i32 s37, s60, 32
    s_add_u32 s36, s36, s37
    s_add_u32 s36, s36, 20905984
    s_add_u32 s36, s36, s50
    v_mov_b32 v13, 1
    v_mov_b32 v12, 159824
    s_mov_b64 exec, 1
    s_waitcnt vmcnt(0)
    ds_add_rtn_u32 v12, v12, v13
    s_waitcnt lgkmcnt(0)
    v_readfirstlane_b32 s37, v12
    s_mov_b64 exec, -1
    s_nop 2
    s_cmp_lg_u32 s37, 3
    s_cbranch_scc1 L_sg_62
    v_mul_u32_u24 v12, 1024, v1
    s_mov_b64 exec, 0xf
    buffer_store_dword v13, v12, s[12:15], s36 offen sc1
    s_mov_b64 exec, -1
L_sg_62:
tl_again:
    s_mov_b32 s3, 1
    s_setprio 0
    s_branch aw_body
tl_done:
attn_exit:
    s_endpgm
code_end:
.section .rodata,"a"
.p2align 6
.amdhsa_kernel interleave_layers__softmax_full_mha__mixer_token_mlp__prompt_kernel
  .amdhsa_next_free_vgpr 256
  .amdhsa_next_free_sgpr 64
  .amdhsa_accum_offset 256
  .amdhsa_group_segment_fixed_size 0
  .amdhsa_kernarg_size 88
  .amdhsa_user_sgpr_count 2
  .amdhsa_user_sgpr_kernarg_segment_ptr 1
  .amdhsa_system_sgpr_workgroup_id_x 1
.end_amdhsa_kernel
```
